```python
import torch

def _softmax(x, axis=-1):
    return torch.softmax(x, dim=axis)
def _gelu(x):
    return torch.nn.functional.gelu(x, approximate="tanh")
def _silu(x):
    return torch.nn.functional.silu(x)
def _sigmoid(x):
    return torch.sigmoid(x)
def _layernorm(x, axis=-1, eps=1e-5):
    m = x.mean(dim=axis, keepdim=True)
    v = x.var(dim=axis, keepdim=True, unbiased=False)
    return (x - m) / torch.sqrt(v + eps)
def _scatter_add(tgt, idx, src, axis=0):
    return tgt.clone().index_add_(axis, idx, src)
def _segment_sum(src, seg, n):
    out = torch.zeros((n,) + src.shape[1:], dtype=src.dtype)
    return out.index_add_(0, seg, src)
def _pad(x, pw):
    flat = tuple(v for pair in reversed(pw) for v in pair)
    return torch.nn.functional.pad(x, flat)

kernel_name = 'concat_heads__softmax_full_mha__spectral_fnet__prompt'

def setup_inputs():

    _w = (lambda a: (lambda t: t.to(torch.bfloat16) if t.is_floating_point() else t)(torch.as_tensor(a)))
    def _A_setup():
        B, S, D = 1, 2048, 448
        return {
            "x": _w((lambda *s: torch.randn(*s, dtype=torch.bfloat16) * 0.2)(B, S, D)),
            "wqkv": _w((lambda *s: torch.randn(*s, dtype=torch.bfloat16) * 0.8)(D, 3 * D)),
            "wo": _w((lambda *s: torch.randn(*s, dtype=torch.bfloat16) * 0.2)(D, D)),
        }
    _A_in = _A_setup()

    def _B_setup():
        B, S, D = 1, 2048, 448
        ns = torch.arange(S)[:, None] * torch.arange(S)[None, :]
        nd = torch.arange(D)[:, None] * torch.arange(D)[None, :]
        Ws_re = torch.cos(-2.0 * torch.pi * ns / S).to(float)
        Ws_im = torch.sin(-2.0 * torch.pi * ns / S).to(float)
        Wd_re = torch.cos(-2.0 * torch.pi * nd / D).to(float)
        Wd_im = torch.sin(-2.0 * torch.pi * nd / D).to(float)
        return {
            "x": _w((lambda *s: torch.randn(*s, dtype=torch.bfloat16) * 0.05)(B, S, D)),
            "dft_seq_re": _w(Ws_re),
            "dft_seq_im": _w(Ws_im),
            "dft_hid_re": _w(Wd_re),
            "dft_hid_im": _w(Wd_im),
        }
    _B_in = _B_setup()

    return {
        "A_x": _A_in["x"],
        "A_wqkv": _A_in["wqkv"],
        "A_wo": _A_in["wo"],
        "B_x": _B_in["x"],
        "B_dft_seq_re": _B_in["dft_seq_re"],
        "B_dft_seq_im": _B_in["dft_seq_im"],
        "B_dft_hid_re": _B_in["dft_hid_re"],
        "B_dft_hid_im": _B_in["dft_hid_im"],
    }

def reference(A_x, A_wqkv, A_wo, B_x, B_dft_seq_re, B_dft_seq_im, B_dft_hid_re, B_dft_hid_im):
    def _A_ref(x, wqkv, wo):
        B, S, D = x.shape
        H = 16; Dh = D // H
        qkv = (lambda x, *d: x.permute(*d))((x @ wqkv).reshape(B, S, 3, H, Dh), 2, 0, 3, 1, 4)
        q, k, v = qkv[0], qkv[1], qkv[2]
        scale = Dh ** -0.5
        scores = torch.einsum("bhqd,bhkd->bhqk", q, k) * scale
        p = _softmax(scores, axis=-1)
        o = torch.einsum("bhqk,bhkd->bhqd", p, v)
        return (lambda x, *d: x.permute(*d))(o, 0, 2, 1, 3).reshape(B, S, D) @ wo

    def _B_ref(x, dft_seq_re, dft_seq_im, dft_hid_re, dft_hid_im):
        a = torch.einsum("bsd,ed->bse", x, dft_hid_re)
        b = torch.einsum("bsd,ed->bse", x, dft_hid_im)
        y = torch.einsum("ts,bse->bte", dft_seq_re, a) - torch.einsum("ts,bse->bte", dft_seq_im, b)
        return y

    a = _A_ref(A_x, A_wqkv, A_wo)
    b = _B_ref(B_x, B_dft_seq_re, B_dft_seq_im, B_dft_hid_re, B_dft_hid_im)
    return torch.concatenate([a, b], axis=-1)
```

```asm
; @launch kernel=k1_proj_kernel grid=(256,1,1) block=(512,1,1) lds=158848
.amdgcn_target "amdgcn-amd-amdhsa--gfx950"
.text
.globl k1_proj_kernel
.p2align 8
.type k1_proj_kernel,@function
k1_proj_kernel:
    s_cmp_ge_u32 s2, 256
    s_cbranch_scc1 K2_done
    s_mov_b32 s98, s2
    s_mov_b32 s99, 0
    s_load_dwordx2 s[18:19], s[0:1], 72
K1_item:
    s_load_dwordx4 s[4:7], s[0:1], 0
    s_load_dwordx4 s[8:11], s[0:1], 16
    s_load_dwordx4 s[12:15], s[0:1], 48
    s_load_dwordx2 s[16:17], s[0:1], 80
    s_load_dwordx4 s[72:75], s[0:1], 32
    v_lshrrev_b32 v2, 6, v0
    v_and_b32 v1, 63, v0
    s_nop 0
    v_readfirstlane_b32 s32, v2
    s_and_b32 s31, s32, 3
    s_mov_b32 s61, s31
    s_lshr_b32 s88, s32, 2
    s_cmp_ge_u32 s2, 144
    s_cbranch_scc1 K1_B
    s_and_b32 s33, s2, 7
    s_mul_i32 s33, s33, 18
    s_lshr_b32 s36, s2, 3
    s_add_u32 s36, s36, s33
    s_mul_i32 s37, s36, 171
    s_lshr_b32 s37, s37, 9
    s_mul_i32 s38, s37, 3
    s_sub_u32 s36, s36, s38
    s_and_b32 s33, s37, 15
    s_lshr_b32 s37, s37, 4
    s_mul_i32 s37, s37, 3
    s_add_u32 s36, s36, s37
    s_mul_i32 s34, s36, 43
    s_lshr_b32 s34, s34, 7
    s_mul_i32 s35, s34, 3
    s_sub_u32 s35, s36, s35
    s_lshl_b32 s37, s33, 7
    s_lshl_b32 s38, s61, 5
    s_add_u32 s37, s37, s38
    v_lshrrev_b32 v2, 3, v1
    v_add_u32 v2, s37, v2
    s_mov_b32 s60, 896
    v_mul_lo_u32 v2, v2, s60
    v_lshrrev_b32 v3, 4, v1
    v_and_b32 v4, 7, v1
    v_xor_b32 v5, v4, v3
    v_lshlrev_b32 v5, 4, v5
    v_add_u32 v10, v2, v5
    v_add_u32 v3, 4, v3
    v_xor_b32 v5, v4, v3
    v_lshlrev_b32 v5, 4, v5
    v_add_u32 v11, v2, v5
    v_add_u32 v11, 7168, v11
    v_subrev_u32 v11, 1024, v11
    s_mul_i32 s40, s34, 896
    s_lshl_b32 s38, s35, 8
    s_add_u32 s40, s40, s38
    s_mul_i32 s38, s32, 192
    s_mov_b32 s60, 2688
    v_add_u32 v2, 0, v1
    v_add_u32 v2, s38, v2
    v_mul_u32_u24 v3, 2731, v2
    v_lshrrev_b32 v3, 16, v3
    v_mul_u32_u24 v4, 24, v3
    v_sub_u32 v2, v2, v4
    v_and_b32 v4, 2, v3
    v_lshlrev_b32 v4, 1, v4
    v_xor_b32 v2, v2, v4
    v_mul_lo_u32 v3, v3, s60
    v_lshlrev_b32 v2, 4, v2
    v_add_u32 v7, v2, v3
    v_add_u32 v2, 64, v1
    v_add_u32 v2, s38, v2
    v_mul_u32_u24 v3, 2731, v2
    v_lshrrev_b32 v3, 16, v3
    v_mul_u32_u24 v4, 24, v3
    v_sub_u32 v2, v2, v4
    v_and_b32 v4, 2, v3
    v_lshlrev_b32 v4, 1, v4
    v_xor_b32 v2, v2, v4
    v_mul_lo_u32 v3, v3, s60
    v_lshlrev_b32 v2, 4, v2
    v_add_u32 v8, v2, v3
    v_subrev_u32 v8, 1024, v8
    v_add_u32 v2, 128, v1
    v_add_u32 v2, s38, v2
    v_mul_u32_u24 v3, 2731, v2
    v_lshrrev_b32 v3, 16, v3
    v_mul_u32_u24 v4, 24, v3
    v_sub_u32 v2, v2, v4
    v_and_b32 v4, 2, v3
    v_lshlrev_b32 v4, 1, v4
    v_xor_b32 v2, v2, v4
    v_mul_lo_u32 v3, v3, s60
    v_lshlrev_b32 v2, 4, v2
    v_add_u32 v9, v2, v3
    v_subrev_u32 v9, 2048, v9
    s_lshl_b32 s52, s61, 12
    s_mul_i32 s53, s32, 3072
    s_add_u32 s53, s53, 0
    s_mul_i32 s54, s88, 14336
    s_lshl_b32 s55, s88, 11
    s_add_u32 s55, s55, s52
    s_waitcnt lgkmcnt(0)
    s_mov_b32 s28, s16
    s_and_b32 s29, s17, 0xffff
    s_mov_b32 s30, 33554432
    s_mov_b32 s31, 0x00020000
    s_mov_b32 s20, s4
    s_and_b32 s21, s5, 0xffff
    s_mov_b32 s22, 1835008
    s_mov_b32 s23, 0x00020000
    s_mov_b32 s24, s6
    s_and_b32 s25, s7, 0xffff
    s_mov_b32 s26, 1204224
    s_mov_b32 s27, 0x00020000
    s_add_u32 m0, s55, 24576
    s_nop 0
    buffer_load_dwordx4 v10, s[20:23], s54 offen offset:0 lds
    buffer_load_dwordx4 v11, s[20:23], s54 offen offset:1024 lds
    s_add_u32 m0, s53, 0
    s_nop 0
    buffer_load_dwordx4 v7, s[24:27], s40 offen offset:0 lds
    buffer_load_dwordx4 v8, s[24:27], s40 offen offset:1024 lds
    buffer_load_dwordx4 v9, s[24:27], s40 offen offset:2048 lds
    s_add_u32 s54, s54, 128
    s_add_u32 s40, s40, 172032
    s_add_u32 m0, s55, 65536
    s_nop 0
    buffer_load_dwordx4 v10, s[20:23], s54 offen offset:0 lds
    buffer_load_dwordx4 v11, s[20:23], s54 offen offset:1024 lds
    s_add_u32 m0, s53, 40960
    s_nop 0
    buffer_load_dwordx4 v7, s[24:27], s40 offen offset:0 lds
    buffer_load_dwordx4 v8, s[24:27], s40 offen offset:1024 lds
    buffer_load_dwordx4 v9, s[24:27], s40 offen offset:2048 lds
    s_add_u32 s54, s54, 128
    s_add_u32 s40, s40, 172032
    v_and_b32 v2, 31, v1
    v_lshrrev_b32 v3, 1, v2
    v_and_b32 v3, 7, v3
    v_lshrrev_b32 v4, 5, v1
    v_lshlrev_b32 v2, 7, v2
    v_add_u32 v5, 0, v4
    v_xor_b32 v5, v5, v3
    v_lshlrev_b32 v5, 4, v5
    v_add_u32 v13, v5, v2
    v_add_u32 v5, 2, v4
    v_xor_b32 v5, v5, v3
    v_lshlrev_b32 v5, 4, v5
    v_add_u32 v14, v5, v2
    v_add_u32 v5, 4, v4
    v_xor_b32 v5, v5, v3
    v_lshlrev_b32 v5, 4, v5
    v_add_u32 v15, v5, v2
    v_add_u32 v5, 6, v4
    v_xor_b32 v5, v5, v3
    v_lshlrev_b32 v5, 4, v5
    v_add_u32 v16, v5, v2
    s_add_u32 s52, s52, 24576
    v_add_u32 v13, s52, v13
    v_add_u32 v17, 81920, v13
    v_add_u32 v14, s52, v14
    v_add_u32 v18, 81920, v14
    v_add_u32 v15, s52, v15
    v_add_u32 v19, 81920, v15
    v_add_u32 v16, s52, v16
    v_add_u32 v20, 81920, v16
    s_mul_i32 s59, s35, 11
    s_lshr_b32 s59, s59, 1
    s_cmp_eq_u32 s35, 1
    s_cselect_b32 s36, 3, 2
    s_cselect_b32 s89, 0, s88
    s_mul_i32 s36, s36, s88
    s_add_u32 s59, s59, s36
    s_mul_i32 s36, s59, 56
    s_lshl_b32 s37, s35, 8
    s_sub_u32 s36, s36, s37
    s_lshl_b32 s37, s34, 4
    s_add_u32 s59, s59, s37
    v_lshrrev_b32 v2, 5, v1
    v_lshlrev_b32 v2, 3, v2
    v_bfe_u32 v3, v1, 2, 2
    v_add_u32 v2, v2, v3
    v_mul_u32_u24 v2, 384, v2
    v_add_u32 v2, 0, v2
    v_bfe_u32 v3, v1, 4, 1
    v_lshlrev_b32 v3, 5, v3
    v_and_b32 v4, 3, v1
    v_lshlrev_b32 v4, 3, v4
    v_add_u32 v3, v3, v4
    v_add_u32 v3, s36, v3
    v_and_b32 v4, 8, v1
    v_lshlrev_b32 v4, 3, v4
    v_add_u32 v5, 0, v3
    v_xor_b32 v5, v5, v4
    v_add_u32 v25, v2, v5
    v_add_u32 v29, 81920, v25
    v_add_u32 v5, 56, v3
    v_xor_b32 v5, v5, v4
    v_add_u32 v26, v2, v5
    v_add_u32 v30, 81920, v26
    v_add_u32 v5, 112, v3
    v_xor_b32 v5, v5, v4
    v_add_u32 v27, v2, v5
    v_add_u32 v31, 81920, v27
    v_mov_b32 v64, 0
    v_mov_b32 v65, 0
    v_mov_b32 v66, 0
    v_mov_b32 v67, 0
    v_mov_b32 v68, 0
    v_mov_b32 v69, 0
    v_mov_b32 v70, 0
    v_mov_b32 v71, 0
    v_mov_b32 v72, 0
    v_mov_b32 v73, 0
    v_mov_b32 v74, 0
    v_mov_b32 v75, 0
    v_mov_b32 v76, 0
    v_mov_b32 v77, 0
    v_mov_b32 v78, 0
    v_mov_b32 v79, 0
    v_mov_b32 v80, 0
    v_mov_b32 v81, 0
    v_mov_b32 v82, 0
    v_mov_b32 v83, 0
    v_mov_b32 v84, 0
    v_mov_b32 v85, 0
    v_mov_b32 v86, 0
    v_mov_b32 v87, 0
    v_mov_b32 v88, 0
    v_mov_b32 v89, 0
    v_mov_b32 v90, 0
    v_mov_b32 v91, 0
    v_mov_b32 v92, 0
    v_mov_b32 v93, 0
    v_mov_b32 v94, 0
    v_mov_b32 v95, 0
    v_mov_b32 v96, 0
    v_mov_b32 v97, 0
    v_mov_b32 v98, 0
    v_mov_b32 v99, 0
    v_mov_b32 v100, 0
    v_mov_b32 v101, 0
    v_mov_b32 v102, 0
    v_mov_b32 v103, 0
    v_mov_b32 v104, 0
    v_mov_b32 v105, 0
    v_mov_b32 v106, 0
    v_mov_b32 v107, 0
    v_mov_b32 v108, 0
    v_mov_b32 v109, 0
    v_mov_b32 v110, 0
    v_mov_b32 v111, 0
    s_lshl_b32 s56, s59, 17
    s_lshl_b32 s57, s33, 2
    s_add_u32 s57, s57, s61
    s_lshl_b32 s57, s57, 11
    s_add_u32 s56, s56, s57
    v_lshlrev_b32 v28, 4, v1
    v_and_b32 v3, 31, v1
    v_cmp_eq_u32 s[62:63], 28, v3
    v_cmp_lt_u32 s[64:65], 28, v3
    v_cmp_gt_u32 s[82:83], 32, v1
    s_cmp_eq_u32 s34, 0
    s_cselect_b32 s58, 1049335798, 1.0
    s_cselect_b32 s68, 0, 0x3f803f80
    s_cselect_b32 s69, 0, 0x00003f80
    s_cmp_eq_u32 s34, 2
    s_cbranch_scc1 K1A_v1
    s_waitcnt vmcnt(5)
    s_barrier
    ds_read_b128 v[32:35], v13 offset:0
    ds_read_b64_tr_b16 v[36:37], v25 offset:0
    ds_read_b64_tr_b16 v[38:39], v25 offset:1536
    ds_read_b64_tr_b16 v[40:41], v26 offset:0
    ds_read_b64_tr_b16 v[42:43], v26 offset:1536
    ds_read_b64_tr_b16 v[44:45], v27 offset:0
    ds_read_b64_tr_b16 v[46:47], v27 offset:1536
    s_add_u32 m0, s55, 106496
    s_nop 0
    buffer_load_dwordx4 v10, s[20:23], s54 offen offset:0 lds
    buffer_load_dwordx4 v11, s[20:23], s54 offen offset:1024 lds
    s_add_u32 m0, s53, 81920
    s_nop 0
    buffer_load_dwordx4 v7, s[24:27], s40 offen offset:0 lds
    buffer_load_dwordx4 v8, s[24:27], s40 offen offset:1024 lds
    buffer_load_dwordx4 v9, s[24:27], s40 offen offset:2048 lds
    s_add_u32 s54, s54, 128
    s_add_u32 s40, s40, 172032
    ds_read_b128 v[48:51], v14 offset:0
    ds_read_b64_tr_b16 v[52:53], v25 offset:6144
    ds_read_b64_tr_b16 v[54:55], v25 offset:7680
    ds_read_b64_tr_b16 v[56:57], v26 offset:6144
    ds_read_b64_tr_b16 v[58:59], v26 offset:7680
    ds_read_b64_tr_b16 v[60:61], v27 offset:6144
    ds_read_b64_tr_b16 v[62:63], v27 offset:7680
    s_waitcnt lgkmcnt(7)
    v_mfma_f32_32x32x16_bf16 v[64:79], v[36:39], v[32:35], v[64:79]
    v_mfma_f32_32x32x16_bf16 v[80:95], v[40:43], v[32:35], v[80:95]
    v_mfma_f32_32x32x16_bf16 v[96:111], v[44:47], v[32:35], v[96:111]
    ds_read_b128 v[32:35], v15 offset:0
    ds_read_b64_tr_b16 v[36:37], v25 offset:12288
    ds_read_b64_tr_b16 v[38:39], v25 offset:13824
    ds_read_b64_tr_b16 v[40:41], v26 offset:12288
    ds_read_b64_tr_b16 v[42:43], v26 offset:13824
    ds_read_b64_tr_b16 v[44:45], v27 offset:12288
    ds_read_b64_tr_b16 v[46:47], v27 offset:13824
    s_waitcnt lgkmcnt(7)
    v_mfma_f32_32x32x16_bf16 v[64:79], v[52:55], v[48:51], v[64:79]
    v_mfma_f32_32x32x16_bf16 v[80:95], v[56:59], v[48:51], v[80:95]
    v_mfma_f32_32x32x16_bf16 v[96:111], v[60:63], v[48:51], v[96:111]
    ds_read_b128 v[48:51], v16 offset:0
    ds_read_b64_tr_b16 v[52:53], v25 offset:18432
    ds_read_b64_tr_b16 v[54:55], v25 offset:19968
    ds_read_b64_tr_b16 v[56:57], v26 offset:18432
    ds_read_b64_tr_b16 v[58:59], v26 offset:19968
    ds_read_b64_tr_b16 v[60:61], v27 offset:18432
    ds_read_b64_tr_b16 v[62:63], v27 offset:19968
    s_waitcnt lgkmcnt(7)
    v_mfma_f32_32x32x16_bf16 v[64:79], v[36:39], v[32:35], v[64:79]
    v_mfma_f32_32x32x16_bf16 v[80:95], v[40:43], v[32:35], v[80:95]
    v_mfma_f32_32x32x16_bf16 v[96:111], v[44:47], v[32:35], v[96:111]
    s_waitcnt lgkmcnt(0)
    v_mfma_f32_32x32x16_bf16 v[64:79], v[52:55], v[48:51], v[64:79]
    v_mfma_f32_32x32x16_bf16 v[80:95], v[56:59], v[48:51], v[80:95]
    v_mfma_f32_32x32x16_bf16 v[96:111], v[60:63], v[48:51], v[96:111]
    s_waitcnt vmcnt(5)
    s_barrier
    ds_read_b128 v[32:35], v13 offset:40960
    ds_read_b64_tr_b16 v[36:37], v25 offset:40960
    ds_read_b64_tr_b16 v[38:39], v25 offset:42496
    ds_read_b64_tr_b16 v[40:41], v26 offset:40960
    ds_read_b64_tr_b16 v[42:43], v26 offset:42496
    ds_read_b64_tr_b16 v[44:45], v27 offset:40960
    ds_read_b64_tr_b16 v[46:47], v27 offset:42496
    s_add_u32 m0, s55, 24576
    s_nop 0
    buffer_load_dwordx4 v10, s[20:23], s54 offen offset:0 lds
    buffer_load_dwordx4 v11, s[20:23], s54 offen offset:1024 lds
    s_add_u32 m0, s53, 0
    s_nop 0
    buffer_load_dwordx4 v7, s[24:27], s40 offen offset:0 lds
    buffer_load_dwordx4 v8, s[24:27], s40 offen offset:1024 lds
    buffer_load_dwordx4 v9, s[24:27], s40 offen offset:2048 lds
    s_add_u32 s54, s54, 128
    s_add_u32 s40, s40, 172032
    ds_read_b128 v[48:51], v14 offset:40960
    ds_read_b64_tr_b16 v[52:53], v25 offset:47104
    ds_read_b64_tr_b16 v[54:55], v25 offset:48640
    ds_read_b64_tr_b16 v[56:57], v26 offset:47104
    ds_read_b64_tr_b16 v[58:59], v26 offset:48640
    ds_read_b64_tr_b16 v[60:61], v27 offset:47104
    ds_read_b64_tr_b16 v[62:63], v27 offset:48640
    s_waitcnt lgkmcnt(7)
    v_mfma_f32_32x32x16_bf16 v[64:79], v[36:39], v[32:35], v[64:79]
    v_mfma_f32_32x32x16_bf16 v[80:95], v[40:43], v[32:35], v[80:95]
    v_mfma_f32_32x32x16_bf16 v[96:111], v[44:47], v[32:35], v[96:111]
    ds_read_b128 v[32:35], v15 offset:40960
    ds_read_b64_tr_b16 v[36:37], v25 offset:53248
    ds_read_b64_tr_b16 v[38:39], v25 offset:54784
    ds_read_b64_tr_b16 v[40:41], v26 offset:53248
    ds_read_b64_tr_b16 v[42:43], v26 offset:54784
    ds_read_b64_tr_b16 v[44:45], v27 offset:53248
    ds_read_b64_tr_b16 v[46:47], v27 offset:54784
    s_waitcnt lgkmcnt(7)
    v_mfma_f32_32x32x16_bf16 v[64:79], v[52:55], v[48:51], v[64:79]
    v_mfma_f32_32x32x16_bf16 v[80:95], v[56:59], v[48:51], v[80:95]
    v_mfma_f32_32x32x16_bf16 v[96:111], v[60:63], v[48:51], v[96:111]
    ds_read_b128 v[48:51], v16 offset:40960
    ds_read_b64_tr_b16 v[52:53], v25 offset:59392
    ds_read_b64_tr_b16 v[54:55], v25 offset:60928
    ds_read_b64_tr_b16 v[56:57], v26 offset:59392
    ds_read_b64_tr_b16 v[58:59], v26 offset:60928
    ds_read_b64_tr_b16 v[60:61], v27 offset:59392
    ds_read_b64_tr_b16 v[62:63], v27 offset:60928
    s_waitcnt lgkmcnt(7)
    v_mfma_f32_32x32x16_bf16 v[64:79], v[36:39], v[32:35], v[64:79]
    v_mfma_f32_32x32x16_bf16 v[80:95], v[40:43], v[32:35], v[80:95]
    v_mfma_f32_32x32x16_bf16 v[96:111], v[44:47], v[32:35], v[96:111]
    s_waitcnt lgkmcnt(0)
    v_mfma_f32_32x32x16_bf16 v[64:79], v[52:55], v[48:51], v[64:79]
    v_mfma_f32_32x32x16_bf16 v[80:95], v[56:59], v[48:51], v[80:95]
    v_mfma_f32_32x32x16_bf16 v[96:111], v[60:63], v[48:51], v[96:111]
    s_waitcnt vmcnt(5)
    s_barrier
    ds_read_b128 v[32:35], v17 offset:0
    ds_read_b64_tr_b16 v[36:37], v29 offset:0
    ds_read_b64_tr_b16 v[38:39], v29 offset:1536
    ds_read_b64_tr_b16 v[40:41], v30 offset:0
    ds_read_b64_tr_b16 v[42:43], v30 offset:1536
    ds_read_b64_tr_b16 v[44:45], v31 offset:0
    ds_read_b64_tr_b16 v[46:47], v31 offset:1536
    s_add_u32 m0, s55, 65536
    s_nop 0
    buffer_load_dwordx4 v10, s[20:23], s54 offen offset:0 lds
    buffer_load_dwordx4 v11, s[20:23], s54 offen offset:1024 lds
    s_add_u32 m0, s53, 40960
    s_nop 0
    buffer_load_dwordx4 v7, s[24:27], s40 offen offset:0 lds
    buffer_load_dwordx4 v8, s[24:27], s40 offen offset:1024 lds
    buffer_load_dwordx4 v9, s[24:27], s40 offen offset:2048 lds
    s_add_u32 s54, s54, 128
    s_add_u32 s40, s40, 172032
    ds_read_b128 v[48:51], v18 offset:0
    ds_read_b64_tr_b16 v[52:53], v29 offset:6144
    ds_read_b64_tr_b16 v[54:55], v29 offset:7680
    ds_read_b64_tr_b16 v[56:57], v30 offset:6144
    ds_read_b64_tr_b16 v[58:59], v30 offset:7680
    ds_read_b64_tr_b16 v[60:61], v31 offset:6144
    ds_read_b64_tr_b16 v[62:63], v31 offset:7680
    s_waitcnt lgkmcnt(7)
    v_mfma_f32_32x32x16_bf16 v[64:79], v[36:39], v[32:35], v[64:79]
    v_mfma_f32_32x32x16_bf16 v[80:95], v[40:43], v[32:35], v[80:95]
    v_mfma_f32_32x32x16_bf16 v[96:111], v[44:47], v[32:35], v[96:111]
    ds_read_b128 v[32:35], v19 offset:0
    ds_read_b64_tr_b16 v[36:37], v29 offset:12288
    ds_read_b64_tr_b16 v[38:39], v29 offset:13824
    ds_read_b64_tr_b16 v[40:41], v30 offset:12288
    ds_read_b64_tr_b16 v[42:43], v30 offset:13824
    ds_read_b64_tr_b16 v[44:45], v31 offset:12288
    ds_read_b64_tr_b16 v[46:47], v31 offset:13824
    s_waitcnt lgkmcnt(7)
    v_mfma_f32_32x32x16_bf16 v[64:79], v[52:55], v[48:51], v[64:79]
    v_mfma_f32_32x32x16_bf16 v[80:95], v[56:59], v[48:51], v[80:95]
    v_mfma_f32_32x32x16_bf16 v[96:111], v[60:63], v[48:51], v[96:111]
    ds_read_b128 v[48:51], v20 offset:0
    ds_read_b64_tr_b16 v[52:53], v29 offset:18432
    ds_read_b64_tr_b16 v[54:55], v29 offset:19968
    ds_read_b64_tr_b16 v[56:57], v30 offset:18432
    ds_read_b64_tr_b16 v[58:59], v30 offset:19968
    ds_read_b64_tr_b16 v[60:61], v31 offset:18432
    ds_read_b64_tr_b16 v[62:63], v31 offset:19968
    s_waitcnt lgkmcnt(7)
    v_mfma_f32_32x32x16_bf16 v[64:79], v[36:39], v[32:35], v[64:79]
    v_mfma_f32_32x32x16_bf16 v[80:95], v[40:43], v[32:35], v[80:95]
    v_mfma_f32_32x32x16_bf16 v[96:111], v[44:47], v[32:35], v[96:111]
    s_waitcnt lgkmcnt(0)
    v_mfma_f32_32x32x16_bf16 v[64:79], v[52:55], v[48:51], v[64:79]
    v_mfma_f32_32x32x16_bf16 v[80:95], v[56:59], v[48:51], v[80:95]
    v_mfma_f32_32x32x16_bf16 v[96:111], v[60:63], v[48:51], v[96:111]
    s_waitcnt vmcnt(5)
    s_barrier
    ds_read_b128 v[32:35], v13 offset:0
    ds_read_b64_tr_b16 v[36:37], v25 offset:0
    ds_read_b64_tr_b16 v[38:39], v25 offset:1536
    ds_read_b64_tr_b16 v[40:41], v26 offset:0
    ds_read_b64_tr_b16 v[42:43], v26 offset:1536
    ds_read_b64_tr_b16 v[44:45], v27 offset:0
    ds_read_b64_tr_b16 v[46:47], v27 offset:1536
    s_add_u32 m0, s55, 106496
    s_nop 0
    buffer_load_dwordx4 v10, s[20:23], s54 offen offset:0 lds
    buffer_load_dwordx4 v11, s[20:23], s54 offen offset:1024 lds
    s_add_u32 m0, s53, 81920
    s_nop 0
    buffer_load_dwordx4 v7, s[24:27], s40 offen offset:0 lds
    buffer_load_dwordx4 v8, s[24:27], s40 offen offset:1024 lds
    buffer_load_dwordx4 v9, s[24:27], s40 offen offset:2048 lds
    s_add_u32 s54, s54, 128
    s_add_u32 s40, s40, 172032
    ds_read_b128 v[48:51], v14 offset:0
    ds_read_b64_tr_b16 v[52:53], v25 offset:6144
    ds_read_b64_tr_b16 v[54:55], v25 offset:7680
    ds_read_b64_tr_b16 v[56:57], v26 offset:6144
    ds_read_b64_tr_b16 v[58:59], v26 offset:7680
    ds_read_b64_tr_b16 v[60:61], v27 offset:6144
    ds_read_b64_tr_b16 v[62:63], v27 offset:7680
    s_waitcnt lgkmcnt(7)
    v_mfma_f32_32x32x16_bf16 v[64:79], v[36:39], v[32:35], v[64:79]
    v_mfma_f32_32x32x16_bf16 v[80:95], v[40:43], v[32:35], v[80:95]
    v_mfma_f32_32x32x16_bf16 v[96:111], v[44:47], v[32:35], v[96:111]
    ds_read_b128 v[32:35], v15 offset:0
    ds_read_b64_tr_b16 v[36:37], v25 offset:12288
    ds_read_b64_tr_b16 v[38:39], v25 offset:13824
    ds_read_b64_tr_b16 v[40:41], v26 offset:12288
    ds_read_b64_tr_b16 v[42:43], v26 offset:13824
    ds_read_b64_tr_b16 v[44:45], v27 offset:12288
    ds_read_b64_tr_b16 v[46:47], v27 offset:13824
    s_waitcnt lgkmcnt(7)
    v_mfma_f32_32x32x16_bf16 v[64:79], v[52:55], v[48:51], v[64:79]
    v_mfma_f32_32x32x16_bf16 v[80:95], v[56:59], v[48:51], v[80:95]
    v_mfma_f32_32x32x16_bf16 v[96:111], v[60:63], v[48:51], v[96:111]
    ds_read_b128 v[48:51], v16 offset:0
    ds_read_b64_tr_b16 v[52:53], v25 offset:18432
    ds_read_b64_tr_b16 v[54:55], v25 offset:19968
    ds_read_b64_tr_b16 v[56:57], v26 offset:18432
    ds_read_b64_tr_b16 v[58:59], v26 offset:19968
    ds_read_b64_tr_b16 v[60:61], v27 offset:18432
    ds_read_b64_tr_b16 v[62:63], v27 offset:19968
    s_waitcnt lgkmcnt(7)
    v_mfma_f32_32x32x16_bf16 v[64:79], v[36:39], v[32:35], v[64:79]
    v_mfma_f32_32x32x16_bf16 v[80:95], v[40:43], v[32:35], v[80:95]
    v_mfma_f32_32x32x16_bf16 v[96:111], v[44:47], v[32:35], v[96:111]
    s_waitcnt lgkmcnt(0)
    v_mfma_f32_32x32x16_bf16 v[64:79], v[52:55], v[48:51], v[64:79]
    v_mfma_f32_32x32x16_bf16 v[80:95], v[56:59], v[48:51], v[80:95]
    v_mfma_f32_32x32x16_bf16 v[96:111], v[60:63], v[48:51], v[96:111]
    s_waitcnt vmcnt(5)
    s_barrier
    ds_read_b128 v[32:35], v13 offset:40960
    ds_read_b64_tr_b16 v[36:37], v25 offset:40960
    ds_read_b64_tr_b16 v[38:39], v25 offset:42496
    ds_read_b64_tr_b16 v[40:41], v26 offset:40960
    ds_read_b64_tr_b16 v[42:43], v26 offset:42496
    ds_read_b64_tr_b16 v[44:45], v27 offset:40960
    ds_read_b64_tr_b16 v[46:47], v27 offset:42496
    s_add_u32 m0, s55, 24576
    s_nop 0
    buffer_load_dwordx4 v10, s[20:23], s54 offen offset:0 lds
    buffer_load_dwordx4 v11, s[20:23], s54 offen offset:1024 lds
    s_add_u32 m0, s53, 0
    s_nop 0
    buffer_load_dwordx4 v7, s[24:27], s40 offen offset:0 lds
    buffer_load_dwordx4 v8, s[24:27], s40 offen offset:1024 lds
    buffer_load_dwordx4 v9, s[24:27], s40 offen offset:2048 lds
    s_add_u32 s54, s54, 128
    s_add_u32 s40, s40, 172032
    ds_read_b128 v[48:51], v14 offset:40960
    ds_read_b64_tr_b16 v[52:53], v25 offset:47104
    ds_read_b64_tr_b16 v[54:55], v25 offset:48640
    ds_read_b64_tr_b16 v[56:57], v26 offset:47104
    ds_read_b64_tr_b16 v[58:59], v26 offset:48640
    ds_read_b64_tr_b16 v[60:61], v27 offset:47104
    ds_read_b64_tr_b16 v[62:63], v27 offset:48640
    s_waitcnt lgkmcnt(7)
    v_mfma_f32_32x32x16_bf16 v[64:79], v[36:39], v[32:35], v[64:79]
    v_mfma_f32_32x32x16_bf16 v[80:95], v[40:43], v[32:35], v[80:95]
    v_mfma_f32_32x32x16_bf16 v[96:111], v[44:47], v[32:35], v[96:111]
    ds_read_b128 v[32:35], v15 offset:40960
    ds_read_b64_tr_b16 v[36:37], v25 offset:53248
    ds_read_b64_tr_b16 v[38:39], v25 offset:54784
    ds_read_b64_tr_b16 v[40:41], v26 offset:53248
    ds_read_b64_tr_b16 v[42:43], v26 offset:54784
    ds_read_b64_tr_b16 v[44:45], v27 offset:53248
    ds_read_b64_tr_b16 v[46:47], v27 offset:54784
    s_waitcnt lgkmcnt(7)
    v_mfma_f32_32x32x16_bf16 v[64:79], v[52:55], v[48:51], v[64:79]
    v_mfma_f32_32x32x16_bf16 v[80:95], v[56:59], v[48:51], v[80:95]
    v_mfma_f32_32x32x16_bf16 v[96:111], v[60:63], v[48:51], v[96:111]
    ds_read_b128 v[48:51], v16 offset:40960
    ds_read_b64_tr_b16 v[52:53], v25 offset:59392
    ds_read_b64_tr_b16 v[54:55], v25 offset:60928
    ds_read_b64_tr_b16 v[56:57], v26 offset:59392
    ds_read_b64_tr_b16 v[58:59], v26 offset:60928
    ds_read_b64_tr_b16 v[60:61], v27 offset:59392
    ds_read_b64_tr_b16 v[62:63], v27 offset:60928
    s_waitcnt lgkmcnt(7)
    v_mfma_f32_32x32x16_bf16 v[64:79], v[36:39], v[32:35], v[64:79]
    v_mfma_f32_32x32x16_bf16 v[80:95], v[40:43], v[32:35], v[80:95]
    v_mfma_f32_32x32x16_bf16 v[96:111], v[44:47], v[32:35], v[96:111]
    s_waitcnt lgkmcnt(0)
    v_mfma_f32_32x32x16_bf16 v[64:79], v[52:55], v[48:51], v[64:79]
    v_mfma_f32_32x32x16_bf16 v[80:95], v[56:59], v[48:51], v[80:95]
    v_mfma_f32_32x32x16_bf16 v[96:111], v[60:63], v[48:51], v[96:111]
    s_waitcnt vmcnt(5)
    s_barrier
    ds_read_b128 v[32:35], v17 offset:0
    ds_read_b64_tr_b16 v[36:37], v29 offset:0
    ds_read_b64_tr_b16 v[38:39], v29 offset:1536
    ds_read_b64_tr_b16 v[40:41], v30 offset:0
    ds_read_b64_tr_b16 v[42:43], v30 offset:1536
    ds_read_b64_tr_b16 v[44:45], v31 offset:0
    ds_read_b64_tr_b16 v[46:47], v31 offset:1536
    s_cmp_lt_u32 s32, 4
    s_cbranch_scc1 CE_skipa0
    s_bitcmp1_b32 s98, 1
    s_cselect_b32 s49, s74, s72
    s_cselect_b32 s50, s75, s73
    s_mov_b32 s44, s49
    s_and_b32 s45, s50, 0xffff
    s_mov_b32 s46, 8388608
    s_mov_b32 s47, 0x00020000
    s_bfe_u32 s48, s98, 0x10002
    s_lshl_b32 s48, s48, 3
    s_lshr_b32 s49, s98, 5
    s_add_u32 s48, s48, s49
    s_lshl_b32 s48, s48, 7
    s_sub_u32 s49, s32, 4
    s_lshl_b32 s50, s49, 5
    s_add_u32 s48, s48, s50
    s_lshl_b32 s49, s49, 12
    v_lshrrev_b32 v114, 3, v1
    v_add_u32 v114, s48, v114
    s_mov_b32 s60, 4096
    v_mul_lo_u32 v114, v114, s60
    v_lshrrev_b32 v115, 4, v1
    v_and_b32 v116, 7, v1
    v_xor_b32 v117, v116, v115
    v_lshlrev_b32 v117, 4, v117
    v_add_u32 v112, v114, v117
    v_add_u32 v115, 4, v115
    v_xor_b32 v117, v116, v115
    v_lshlrev_b32 v117, 4, v117
    v_add_u32 v113, v114, v117
    v_add_u32 v113, 32768, v113
    v_subrev_u32 v113, 1024, v113
    s_and_b32 s42, s98, 1
    s_lshl_b32 s42, s42, 11
    s_add_u32 s43, s42, 63488
    s_add_u32 m0, s49, 122880
    s_nop 0
    buffer_load_dwordx4 v112, s[44:47], s42 offen offset:0 lds
    buffer_load_dwordx4 v113, s[44:47], s42 offen offset:1024 lds
    buffer_load_dwordx4 v112, s[44:47], s43 offen offset:2048 lds
    buffer_load_dwordx4 v113, s[44:47], s43 offen offset:3072 lds
    s_add_u32 s42, s42, 128
    s_add_u32 s43, s43, 128
    s_add_u32 m0, s49, 139264
    s_nop 0
    buffer_load_dwordx4 v112, s[44:47], s42 offen offset:0 lds
    buffer_load_dwordx4 v113, s[44:47], s42 offen offset:1024 lds
    buffer_load_dwordx4 v112, s[44:47], s43 offen offset:2048 lds
    buffer_load_dwordx4 v113, s[44:47], s43 offen offset:3072 lds
CE_skipa0:
    ds_read_b128 v[48:51], v18 offset:0
    ds_read_b64_tr_b16 v[52:53], v29 offset:6144
    ds_read_b64_tr_b16 v[54:55], v29 offset:7680
    ds_read_b64_tr_b16 v[56:57], v30 offset:6144
    ds_read_b64_tr_b16 v[58:59], v30 offset:7680
    ds_read_b64_tr_b16 v[60:61], v31 offset:6144
    ds_read_b64_tr_b16 v[62:63], v31 offset:7680
    s_waitcnt lgkmcnt(7)
    v_mfma_f32_32x32x16_bf16 v[64:79], v[36:39], v[32:35], v[64:79]
    v_mfma_f32_32x32x16_bf16 v[80:95], v[40:43], v[32:35], v[80:95]
    v_mfma_f32_32x32x16_bf16 v[96:111], v[44:47], v[32:35], v[96:111]
    ds_read_b128 v[32:35], v19 offset:0
    ds_read_b64_tr_b16 v[36:37], v29 offset:12288
    ds_read_b64_tr_b16 v[38:39], v29 offset:13824
    ds_read_b64_tr_b16 v[40:41], v30 offset:12288
    ds_read_b64_tr_b16 v[42:43], v30 offset:13824
    ds_read_b64_tr_b16 v[44:45], v31 offset:12288
    ds_read_b64_tr_b16 v[46:47], v31 offset:13824
    s_waitcnt lgkmcnt(7)
    v_mfma_f32_32x32x16_bf16 v[64:79], v[52:55], v[48:51], v[64:79]
    v_mfma_f32_32x32x16_bf16 v[80:95], v[56:59], v[48:51], v[80:95]
    v_mfma_f32_32x32x16_bf16 v[96:111], v[60:63], v[48:51], v[96:111]
    ds_read_b128 v[48:51], v20 offset:0
    ds_read_b64_tr_b16 v[52:53], v29 offset:18432
    ds_read_b64_tr_b16 v[54:55], v29 offset:19968
    ds_read_b64_tr_b16 v[56:57], v30 offset:18432
    ds_read_b64_tr_b16 v[58:59], v30 offset:19968
    ds_read_b64_tr_b16 v[60:61], v31 offset:18432
    ds_read_b64_tr_b16 v[62:63], v31 offset:19968
    s_waitcnt lgkmcnt(7)
    v_mfma_f32_32x32x16_bf16 v[64:79], v[36:39], v[32:35], v[64:79]
    v_mfma_f32_32x32x16_bf16 v[80:95], v[40:43], v[32:35], v[80:95]
    v_mfma_f32_32x32x16_bf16 v[96:111], v[44:47], v[32:35], v[96:111]
    s_waitcnt lgkmcnt(0)
    v_mfma_f32_32x32x16_bf16 v[64:79], v[52:55], v[48:51], v[64:79]
    v_mfma_f32_32x32x16_bf16 v[80:95], v[56:59], v[48:51], v[80:95]
    v_mfma_f32_32x32x16_bf16 v[96:111], v[60:63], v[48:51], v[96:111]
    s_cmp_lt_u32 s32, 4
    s_cbranch_scc1 CE_wa0_6
    s_waitcnt vmcnt(8)
    s_branch CE_xa0_6
CE_wa0_6:
    s_waitcnt vmcnt(0)
CE_xa0_6:
    s_barrier
    ds_read_b128 v[32:35], v13 offset:0
    ds_read_b64_tr_b16 v[36:37], v25 offset:0
    ds_read_b64_tr_b16 v[38:39], v25 offset:1536
    ds_read_b64_tr_b16 v[40:41], v26 offset:0
    ds_read_b64_tr_b16 v[42:43], v26 offset:1536
    ds_read_b64_tr_b16 v[44:45], v27 offset:0
    ds_read_b64_tr_b16 v[46:47], v27 offset:1536
    ds_read_b128 v[48:51], v14 offset:0
    ds_read_b64_tr_b16 v[52:53], v25 offset:6144
    ds_read_b64_tr_b16 v[54:55], v25 offset:7680
    ds_read_b64_tr_b16 v[56:57], v26 offset:6144
    ds_read_b64_tr_b16 v[58:59], v26 offset:7680
    ds_read_b64_tr_b16 v[60:61], v27 offset:6144
    ds_read_b64_tr_b16 v[62:63], v27 offset:7680
    s_waitcnt lgkmcnt(7)
    v_mfma_f32_32x32x16_bf16 v[64:79], v[36:39], v[32:35], v[64:79]
    v_mfma_f32_32x32x16_bf16 v[80:95], v[40:43], v[32:35], v[80:95]
    v_mfma_f32_32x32x16_bf16 v[96:111], v[44:47], v[32:35], v[96:111]
    ds_read_b128 v[32:35], v15 offset:0
    ds_read_b64_tr_b16 v[36:37], v25 offset:12288
    ds_read_b64_tr_b16 v[38:39], v25 offset:13824
    ds_read_b64_tr_b16 v[40:41], v26 offset:12288
    ds_read_b64_tr_b16 v[42:43], v26 offset:13824
    ds_read_b64_tr_b16 v[44:45], v27 offset:12288
    ds_read_b64_tr_b16 v[46:47], v27 offset:13824
    s_waitcnt lgkmcnt(7)
    v_mfma_f32_32x32x16_bf16 v[64:79], v[52:55], v[48:51], v[64:79]
    v_mfma_f32_32x32x16_bf16 v[80:95], v[56:59], v[48:51], v[80:95]
    v_mfma_f32_32x32x16_bf16 v[96:111], v[60:63], v[48:51], v[96:111]
    ds_read_b128 v[48:51], v16 offset:0
    ds_read_b64_tr_b16 v[52:53], v25 offset:18432
    ds_read_b64_tr_b16 v[54:55], v25 offset:19968
    ds_read_b64_tr_b16 v[56:57], v26 offset:18432
    ds_read_b64_tr_b16 v[58:59], v26 offset:19968
    ds_read_b64_tr_b16 v[60:61], v27 offset:18432
    ds_read_b64_tr_b16 v[62:63], v27 offset:19968
    s_waitcnt lgkmcnt(7)
    v_mfma_f32_32x32x16_bf16 v[64:79], v[36:39], v[32:35], v[64:79]
    v_mfma_f32_32x32x16_bf16 v[80:95], v[40:43], v[32:35], v[80:95]
    v_mfma_f32_32x32x16_bf16 v[96:111], v[44:47], v[32:35], v[96:111]
    s_waitcnt lgkmcnt(0)
    v_mfma_f32_32x32x16_bf16 v[64:79], v[52:55], v[48:51], v[64:79]
    v_mfma_f32_32x32x16_bf16 v[80:95], v[56:59], v[48:51], v[80:95]
    v_mfma_f32_32x32x16_bf16 v[96:111], v[60:63], v[48:51], v[96:111]
    v_mov_b32 v4, 0x3f803f80
    v_mov_b32 v6, 0
    v_mov_b32 v2, s68
    v_mov_b32 v3, s69
    s_nop 7
    s_cmp_lg_u32 s89, 0
    s_cbranch_scc1 K1A_dup0
    v_mul_f32 v64, s58, v64
    v_mul_f32 v65, s58, v65
    v_mul_f32 v66, s58, v66
    v_mul_f32 v67, s58, v67
    v_mul_f32 v68, s58, v68
    v_mul_f32 v69, s58, v69
    v_mul_f32 v70, s58, v70
    v_mul_f32 v71, s58, v71
    v_mul_f32 v72, s58, v72
    v_mul_f32 v73, s58, v73
    v_mul_f32 v74, s58, v74
    v_mul_f32 v75, s58, v75
    v_mul_f32 v76, s58, v76
    v_mul_f32 v77, s58, v77
    v_mul_f32 v78, s58, v78
    v_mul_f32 v79, s58, v79
    v_cvt_pk_bf16_f32 v32, v64, v65
    v_cvt_pk_bf16_f32 v33, v66, v67
    v_cvt_pk_bf16_f32 v34, v68, v69
    v_cvt_pk_bf16_f32 v35, v70, v71
    v_cvt_pk_bf16_f32 v36, v72, v73
    v_cvt_pk_bf16_f32 v37, v74, v75
    v_cvt_pk_bf16_f32 v38, v76, v77
    v_cvt_pk_bf16_f32 v39, v78, v79
    v_cndmask_b32 v38, v2, v38, s[82:83]
    v_cndmask_b32 v39, v3, v39, s[82:83]
    buffer_store_dwordx4 v[32:35], v28, s[28:31], s56 offen sc0 sc1
    buffer_store_dwordx4 v[36:39], v28, s[28:31], s56 offen offset:1024 sc0 sc1
K1A_dup0:
    s_add_u32 s56, s56, 131072
    v_mul_f32 v80, s58, v80
    v_mul_f32 v81, s58, v81
    v_mul_f32 v82, s58, v82
    v_mul_f32 v83, s58, v83
    v_mul_f32 v84, s58, v84
    v_mul_f32 v85, s58, v85
    v_mul_f32 v86, s58, v86
    v_mul_f32 v87, s58, v87
    v_mul_f32 v88, s58, v88
    v_mul_f32 v89, s58, v89
    v_mul_f32 v90, s58, v90
    v_mul_f32 v91, s58, v91
    v_mul_f32 v92, s58, v92
    v_mul_f32 v93, s58, v93
    v_mul_f32 v94, s58, v94
    v_mul_f32 v95, s58, v95
    v_cvt_pk_bf16_f32 v40, v80, v81
    v_cvt_pk_bf16_f32 v41, v82, v83
    v_cvt_pk_bf16_f32 v42, v84, v85
    v_cvt_pk_bf16_f32 v43, v86, v87
    v_cvt_pk_bf16_f32 v44, v88, v89
    v_cvt_pk_bf16_f32 v45, v90, v91
    v_cvt_pk_bf16_f32 v46, v92, v93
    v_cvt_pk_bf16_f32 v47, v94, v95
    v_cndmask_b32 v46, v2, v46, s[82:83]
    v_cndmask_b32 v47, v3, v47, s[82:83]
    buffer_store_dwordx4 v[40:43], v28, s[28:31], s56 offen sc0 sc1
    buffer_store_dwordx4 v[44:47], v28, s[28:31], s56 offen offset:1024 sc0 sc1
    s_add_u32 s56, s56, 131072
    v_mul_f32 v96, s58, v96
    v_mul_f32 v97, s58, v97
    v_mul_f32 v98, s58, v98
    v_mul_f32 v99, s58, v99
    v_mul_f32 v100, s58, v100
    v_mul_f32 v101, s58, v101
    v_mul_f32 v102, s58, v102
    v_mul_f32 v103, s58, v103
    v_mul_f32 v104, s58, v104
    v_mul_f32 v105, s58, v105
    v_mul_f32 v106, s58, v106
    v_mul_f32 v107, s58, v107
    v_mul_f32 v108, s58, v108
    v_mul_f32 v109, s58, v109
    v_mul_f32 v110, s58, v110
    v_mul_f32 v111, s58, v111
    v_cvt_pk_bf16_f32 v48, v96, v97
    v_cvt_pk_bf16_f32 v49, v98, v99
    v_cvt_pk_bf16_f32 v50, v100, v101
    v_cvt_pk_bf16_f32 v51, v102, v103
    v_cvt_pk_bf16_f32 v52, v104, v105
    v_cvt_pk_bf16_f32 v53, v106, v107
    v_cvt_pk_bf16_f32 v54, v108, v109
    v_cvt_pk_bf16_f32 v55, v110, v111
    v_cndmask_b32 v54, v2, v54, s[82:83]
    v_cndmask_b32 v55, v3, v55, s[82:83]
    buffer_store_dwordx4 v[48:51], v28, s[28:31], s56 offen sc0 sc1
    buffer_store_dwordx4 v[52:55], v28, s[28:31], s56 offen offset:1024 sc0 sc1
    s_branch K1_done
K1A_v1:
    s_waitcnt vmcnt(5)
    s_barrier
    ds_read_b128 v[32:35], v13 offset:0
    ds_read_b64_tr_b16 v[36:37], v25 offset:0
    ds_read_b64_tr_b16 v[38:39], v25 offset:1536
    ds_read_b64_tr_b16 v[40:41], v26 offset:0
    ds_read_b64_tr_b16 v[42:43], v26 offset:1536
    ds_read_b64_tr_b16 v[44:45], v27 offset:0
    ds_read_b64_tr_b16 v[46:47], v27 offset:1536
    s_add_u32 m0, s55, 106496
    s_nop 0
    buffer_load_dwordx4 v10, s[20:23], s54 offen offset:0 lds
    buffer_load_dwordx4 v11, s[20:23], s54 offen offset:1024 lds
    s_add_u32 m0, s53, 81920
    s_nop 0
    buffer_load_dwordx4 v7, s[24:27], s40 offen offset:0 lds
    buffer_load_dwordx4 v8, s[24:27], s40 offen offset:1024 lds
    buffer_load_dwordx4 v9, s[24:27], s40 offen offset:2048 lds
    s_add_u32 s54, s54, 128
    s_add_u32 s40, s40, 172032
    ds_read_b128 v[48:51], v14 offset:0
    ds_read_b64_tr_b16 v[52:53], v25 offset:6144
    ds_read_b64_tr_b16 v[54:55], v25 offset:7680
    ds_read_b64_tr_b16 v[56:57], v26 offset:6144
    ds_read_b64_tr_b16 v[58:59], v26 offset:7680
    ds_read_b64_tr_b16 v[60:61], v27 offset:6144
    ds_read_b64_tr_b16 v[62:63], v27 offset:7680
    s_waitcnt lgkmcnt(7)
    v_mfma_f32_32x32x16_bf16 v[64:79], v[32:35], v[36:39], v[64:79]
    v_mfma_f32_32x32x16_bf16 v[80:95], v[32:35], v[40:43], v[80:95]
    v_mfma_f32_32x32x16_bf16 v[96:111], v[32:35], v[44:47], v[96:111]
    ds_read_b128 v[32:35], v15 offset:0
    ds_read_b64_tr_b16 v[36:37], v25 offset:12288
    ds_read_b64_tr_b16 v[38:39], v25 offset:13824
    ds_read_b64_tr_b16 v[40:41], v26 offset:12288
    ds_read_b64_tr_b16 v[42:43], v26 offset:13824
    ds_read_b64_tr_b16 v[44:45], v27 offset:12288
    ds_read_b64_tr_b16 v[46:47], v27 offset:13824
    s_waitcnt lgkmcnt(7)
    v_mfma_f32_32x32x16_bf16 v[64:79], v[48:51], v[52:55], v[64:79]
    v_mfma_f32_32x32x16_bf16 v[80:95], v[48:51], v[56:59], v[80:95]
    v_mfma_f32_32x32x16_bf16 v[96:111], v[48:51], v[60:63], v[96:111]
    ds_read_b128 v[48:51], v16 offset:0
    ds_read_b64_tr_b16 v[52:53], v25 offset:18432
    ds_read_b64_tr_b16 v[54:55], v25 offset:19968
    ds_read_b64_tr_b16 v[56:57], v26 offset:18432
    ds_read_b64_tr_b16 v[58:59], v26 offset:19968
    ds_read_b64_tr_b16 v[60:61], v27 offset:18432
    ds_read_b64_tr_b16 v[62:63], v27 offset:19968
    s_waitcnt lgkmcnt(7)
    v_mfma_f32_32x32x16_bf16 v[64:79], v[32:35], v[36:39], v[64:79]
    v_mfma_f32_32x32x16_bf16 v[80:95], v[32:35], v[40:43], v[80:95]
    v_mfma_f32_32x32x16_bf16 v[96:111], v[32:35], v[44:47], v[96:111]
    s_waitcnt lgkmcnt(0)
    v_mfma_f32_32x32x16_bf16 v[64:79], v[48:51], v[52:55], v[64:79]
    v_mfma_f32_32x32x16_bf16 v[80:95], v[48:51], v[56:59], v[80:95]
    v_mfma_f32_32x32x16_bf16 v[96:111], v[48:51], v[60:63], v[96:111]
    s_waitcnt vmcnt(5)
    s_barrier
    ds_read_b128 v[32:35], v13 offset:40960
    ds_read_b64_tr_b16 v[36:37], v25 offset:40960
    ds_read_b64_tr_b16 v[38:39], v25 offset:42496
    ds_read_b64_tr_b16 v[40:41], v26 offset:40960
    ds_read_b64_tr_b16 v[42:43], v26 offset:42496
    ds_read_b64_tr_b16 v[44:45], v27 offset:40960
    ds_read_b64_tr_b16 v[46:47], v27 offset:42496
    s_add_u32 m0, s55, 24576
    s_nop 0
    buffer_load_dwordx4 v10, s[20:23], s54 offen offset:0 lds
    buffer_load_dwordx4 v11, s[20:23], s54 offen offset:1024 lds
    s_add_u32 m0, s53, 0
    s_nop 0
    buffer_load_dwordx4 v7, s[24:27], s40 offen offset:0 lds
    buffer_load_dwordx4 v8, s[24:27], s40 offen offset:1024 lds
    buffer_load_dwordx4 v9, s[24:27], s40 offen offset:2048 lds
    s_add_u32 s54, s54, 128
    s_add_u32 s40, s40, 172032
    ds_read_b128 v[48:51], v14 offset:40960
    ds_read_b64_tr_b16 v[52:53], v25 offset:47104
    ds_read_b64_tr_b16 v[54:55], v25 offset:48640
    ds_read_b64_tr_b16 v[56:57], v26 offset:47104
    ds_read_b64_tr_b16 v[58:59], v26 offset:48640
    ds_read_b64_tr_b16 v[60:61], v27 offset:47104
    ds_read_b64_tr_b16 v[62:63], v27 offset:48640
    s_waitcnt lgkmcnt(7)
    v_mfma_f32_32x32x16_bf16 v[64:79], v[32:35], v[36:39], v[64:79]
    v_mfma_f32_32x32x16_bf16 v[80:95], v[32:35], v[40:43], v[80:95]
    v_mfma_f32_32x32x16_bf16 v[96:111], v[32:35], v[44:47], v[96:111]
    ds_read_b128 v[32:35], v15 offset:40960
    ds_read_b64_tr_b16 v[36:37], v25 offset:53248
    ds_read_b64_tr_b16 v[38:39], v25 offset:54784
    ds_read_b64_tr_b16 v[40:41], v26 offset:53248
    ds_read_b64_tr_b16 v[42:43], v26 offset:54784
    ds_read_b64_tr_b16 v[44:45], v27 offset:53248
    ds_read_b64_tr_b16 v[46:47], v27 offset:54784
    s_waitcnt lgkmcnt(7)
    v_mfma_f32_32x32x16_bf16 v[64:79], v[48:51], v[52:55], v[64:79]
    v_mfma_f32_32x32x16_bf16 v[80:95], v[48:51], v[56:59], v[80:95]
    v_mfma_f32_32x32x16_bf16 v[96:111], v[48:51], v[60:63], v[96:111]
    ds_read_b128 v[48:51], v16 offset:40960
    ds_read_b64_tr_b16 v[52:53], v25 offset:59392
    ds_read_b64_tr_b16 v[54:55], v25 offset:60928
    ds_read_b64_tr_b16 v[56:57], v26 offset:59392
    ds_read_b64_tr_b16 v[58:59], v26 offset:60928
    ds_read_b64_tr_b16 v[60:61], v27 offset:59392
    ds_read_b64_tr_b16 v[62:63], v27 offset:60928
    s_waitcnt lgkmcnt(7)
    v_mfma_f32_32x32x16_bf16 v[64:79], v[32:35], v[36:39], v[64:79]
    v_mfma_f32_32x32x16_bf16 v[80:95], v[32:35], v[40:43], v[80:95]
    v_mfma_f32_32x32x16_bf16 v[96:111], v[32:35], v[44:47], v[96:111]
    s_waitcnt lgkmcnt(0)
    v_mfma_f32_32x32x16_bf16 v[64:79], v[48:51], v[52:55], v[64:79]
    v_mfma_f32_32x32x16_bf16 v[80:95], v[48:51], v[56:59], v[80:95]
    v_mfma_f32_32x32x16_bf16 v[96:111], v[48:51], v[60:63], v[96:111]
    s_waitcnt vmcnt(5)
    s_barrier
    ds_read_b128 v[32:35], v17 offset:0
    ds_read_b64_tr_b16 v[36:37], v29 offset:0
    ds_read_b64_tr_b16 v[38:39], v29 offset:1536
    ds_read_b64_tr_b16 v[40:41], v30 offset:0
    ds_read_b64_tr_b16 v[42:43], v30 offset:1536
    ds_read_b64_tr_b16 v[44:45], v31 offset:0
    ds_read_b64_tr_b16 v[46:47], v31 offset:1536
    s_add_u32 m0, s55, 65536
    s_nop 0
    buffer_load_dwordx4 v10, s[20:23], s54 offen offset:0 lds
    buffer_load_dwordx4 v11, s[20:23], s54 offen offset:1024 lds
    s_add_u32 m0, s53, 40960
    s_nop 0
    buffer_load_dwordx4 v7, s[24:27], s40 offen offset:0 lds
    buffer_load_dwordx4 v8, s[24:27], s40 offen offset:1024 lds
    buffer_load_dwordx4 v9, s[24:27], s40 offen offset:2048 lds
    s_add_u32 s54, s54, 128
    s_add_u32 s40, s40, 172032
    ds_read_b128 v[48:51], v18 offset:0
    ds_read_b64_tr_b16 v[52:53], v29 offset:6144
    ds_read_b64_tr_b16 v[54:55], v29 offset:7680
    ds_read_b64_tr_b16 v[56:57], v30 offset:6144
    ds_read_b64_tr_b16 v[58:59], v30 offset:7680
    ds_read_b64_tr_b16 v[60:61], v31 offset:6144
    ds_read_b64_tr_b16 v[62:63], v31 offset:7680
    s_waitcnt lgkmcnt(7)
    v_mfma_f32_32x32x16_bf16 v[64:79], v[32:35], v[36:39], v[64:79]
    v_mfma_f32_32x32x16_bf16 v[80:95], v[32:35], v[40:43], v[80:95]
    v_mfma_f32_32x32x16_bf16 v[96:111], v[32:35], v[44:47], v[96:111]
    ds_read_b128 v[32:35], v19 offset:0
    ds_read_b64_tr_b16 v[36:37], v29 offset:12288
    ds_read_b64_tr_b16 v[38:39], v29 offset:13824
    ds_read_b64_tr_b16 v[40:41], v30 offset:12288
    ds_read_b64_tr_b16 v[42:43], v30 offset:13824
    ds_read_b64_tr_b16 v[44:45], v31 offset:12288
    ds_read_b64_tr_b16 v[46:47], v31 offset:13824
    s_waitcnt lgkmcnt(7)
    v_mfma_f32_32x32x16_bf16 v[64:79], v[48:51], v[52:55], v[64:79]
    v_mfma_f32_32x32x16_bf16 v[80:95], v[48:51], v[56:59], v[80:95]
    v_mfma_f32_32x32x16_bf16 v[96:111], v[48:51], v[60:63], v[96:111]
    ds_read_b128 v[48:51], v20 offset:0
    ds_read_b64_tr_b16 v[52:53], v29 offset:18432
    ds_read_b64_tr_b16 v[54:55], v29 offset:19968
    ds_read_b64_tr_b16 v[56:57], v30 offset:18432
    ds_read_b64_tr_b16 v[58:59], v30 offset:19968
    ds_read_b64_tr_b16 v[60:61], v31 offset:18432
    ds_read_b64_tr_b16 v[62:63], v31 offset:19968
    s_waitcnt lgkmcnt(7)
    v_mfma_f32_32x32x16_bf16 v[64:79], v[32:35], v[36:39], v[64:79]
    v_mfma_f32_32x32x16_bf16 v[80:95], v[32:35], v[40:43], v[80:95]
    v_mfma_f32_32x32x16_bf16 v[96:111], v[32:35], v[44:47], v[96:111]
    s_waitcnt lgkmcnt(0)
    v_mfma_f32_32x32x16_bf16 v[64:79], v[48:51], v[52:55], v[64:79]
    v_mfma_f32_32x32x16_bf16 v[80:95], v[48:51], v[56:59], v[80:95]
    v_mfma_f32_32x32x16_bf16 v[96:111], v[48:51], v[60:63], v[96:111]
    s_waitcnt vmcnt(5)
    s_barrier
    ds_read_b128 v[32:35], v13 offset:0
    ds_read_b64_tr_b16 v[36:37], v25 offset:0
    ds_read_b64_tr_b16 v[38:39], v25 offset:1536
    ds_read_b64_tr_b16 v[40:41], v26 offset:0
    ds_read_b64_tr_b16 v[42:43], v26 offset:1536
    ds_read_b64_tr_b16 v[44:45], v27 offset:0
    ds_read_b64_tr_b16 v[46:47], v27 offset:1536
    s_add_u32 m0, s55, 106496
    s_nop 0
    buffer_load_dwordx4 v10, s[20:23], s54 offen offset:0 lds
    buffer_load_dwordx4 v11, s[20:23], s54 offen offset:1024 lds
    s_add_u32 m0, s53, 81920
    s_nop 0
    buffer_load_dwordx4 v7, s[24:27], s40 offen offset:0 lds
    buffer_load_dwordx4 v8, s[24:27], s40 offen offset:1024 lds
    buffer_load_dwordx4 v9, s[24:27], s40 offen offset:2048 lds
    s_add_u32 s54, s54, 128
    s_add_u32 s40, s40, 172032
    ds_read_b128 v[48:51], v14 offset:0
    ds_read_b64_tr_b16 v[52:53], v25 offset:6144
    ds_read_b64_tr_b16 v[54:55], v25 offset:7680
    ds_read_b64_tr_b16 v[56:57], v26 offset:6144
    ds_read_b64_tr_b16 v[58:59], v26 offset:7680
    ds_read_b64_tr_b16 v[60:61], v27 offset:6144
    ds_read_b64_tr_b16 v[62:63], v27 offset:7680
    s_waitcnt lgkmcnt(7)
    v_mfma_f32_32x32x16_bf16 v[64:79], v[32:35], v[36:39], v[64:79]
    v_mfma_f32_32x32x16_bf16 v[80:95], v[32:35], v[40:43], v[80:95]
    v_mfma_f32_32x32x16_bf16 v[96:111], v[32:35], v[44:47], v[96:111]
    ds_read_b128 v[32:35], v15 offset:0
    ds_read_b64_tr_b16 v[36:37], v25 offset:12288
    ds_read_b64_tr_b16 v[38:39], v25 offset:13824
    ds_read_b64_tr_b16 v[40:41], v26 offset:12288
    ds_read_b64_tr_b16 v[42:43], v26 offset:13824
    ds_read_b64_tr_b16 v[44:45], v27 offset:12288
    ds_read_b64_tr_b16 v[46:47], v27 offset:13824
    s_waitcnt lgkmcnt(7)
    v_mfma_f32_32x32x16_bf16 v[64:79], v[48:51], v[52:55], v[64:79]
    v_mfma_f32_32x32x16_bf16 v[80:95], v[48:51], v[56:59], v[80:95]
    v_mfma_f32_32x32x16_bf16 v[96:111], v[48:51], v[60:63], v[96:111]
    ds_read_b128 v[48:51], v16 offset:0
    ds_read_b64_tr_b16 v[52:53], v25 offset:18432
    ds_read_b64_tr_b16 v[54:55], v25 offset:19968
    ds_read_b64_tr_b16 v[56:57], v26 offset:18432
    ds_read_b64_tr_b16 v[58:59], v26 offset:19968
    ds_read_b64_tr_b16 v[60:61], v27 offset:18432
    ds_read_b64_tr_b16 v[62:63], v27 offset:19968
    s_waitcnt lgkmcnt(7)
    v_mfma_f32_32x32x16_bf16 v[64:79], v[32:35], v[36:39], v[64:79]
    v_mfma_f32_32x32x16_bf16 v[80:95], v[32:35], v[40:43], v[80:95]
    v_mfma_f32_32x32x16_bf16 v[96:111], v[32:35], v[44:47], v[96:111]
    s_waitcnt lgkmcnt(0)
    v_mfma_f32_32x32x16_bf16 v[64:79], v[48:51], v[52:55], v[64:79]
    v_mfma_f32_32x32x16_bf16 v[80:95], v[48:51], v[56:59], v[80:95]
    v_mfma_f32_32x32x16_bf16 v[96:111], v[48:51], v[60:63], v[96:111]
    s_waitcnt vmcnt(5)
    s_barrier
    ds_read_b128 v[32:35], v13 offset:40960
    ds_read_b64_tr_b16 v[36:37], v25 offset:40960
    ds_read_b64_tr_b16 v[38:39], v25 offset:42496
    ds_read_b64_tr_b16 v[40:41], v26 offset:40960
    ds_read_b64_tr_b16 v[42:43], v26 offset:42496
    ds_read_b64_tr_b16 v[44:45], v27 offset:40960
    ds_read_b64_tr_b16 v[46:47], v27 offset:42496
    s_add_u32 m0, s55, 24576
    s_nop 0
    buffer_load_dwordx4 v10, s[20:23], s54 offen offset:0 lds
    buffer_load_dwordx4 v11, s[20:23], s54 offen offset:1024 lds
    s_add_u32 m0, s53, 0
    s_nop 0
    buffer_load_dwordx4 v7, s[24:27], s40 offen offset:0 lds
    buffer_load_dwordx4 v8, s[24:27], s40 offen offset:1024 lds
    buffer_load_dwordx4 v9, s[24:27], s40 offen offset:2048 lds
    s_add_u32 s54, s54, 128
    s_add_u32 s40, s40, 172032
    ds_read_b128 v[48:51], v14 offset:40960
    ds_read_b64_tr_b16 v[52:53], v25 offset:47104
    ds_read_b64_tr_b16 v[54:55], v25 offset:48640
    ds_read_b64_tr_b16 v[56:57], v26 offset:47104
    ds_read_b64_tr_b16 v[58:59], v26 offset:48640
    ds_read_b64_tr_b16 v[60:61], v27 offset:47104
    ds_read_b64_tr_b16 v[62:63], v27 offset:48640
    s_waitcnt lgkmcnt(7)
    v_mfma_f32_32x32x16_bf16 v[64:79], v[32:35], v[36:39], v[64:79]
    v_mfma_f32_32x32x16_bf16 v[80:95], v[32:35], v[40:43], v[80:95]
    v_mfma_f32_32x32x16_bf16 v[96:111], v[32:35], v[44:47], v[96:111]
    ds_read_b128 v[32:35], v15 offset:40960
    ds_read_b64_tr_b16 v[36:37], v25 offset:53248
    ds_read_b64_tr_b16 v[38:39], v25 offset:54784
    ds_read_b64_tr_b16 v[40:41], v26 offset:53248
    ds_read_b64_tr_b16 v[42:43], v26 offset:54784
    ds_read_b64_tr_b16 v[44:45], v27 offset:53248
    ds_read_b64_tr_b16 v[46:47], v27 offset:54784
    s_waitcnt lgkmcnt(7)
    v_mfma_f32_32x32x16_bf16 v[64:79], v[48:51], v[52:55], v[64:79]
    v_mfma_f32_32x32x16_bf16 v[80:95], v[48:51], v[56:59], v[80:95]
    v_mfma_f32_32x32x16_bf16 v[96:111], v[48:51], v[60:63], v[96:111]
    ds_read_b128 v[48:51], v16 offset:40960
    ds_read_b64_tr_b16 v[52:53], v25 offset:59392
    ds_read_b64_tr_b16 v[54:55], v25 offset:60928
    ds_read_b64_tr_b16 v[56:57], v26 offset:59392
    ds_read_b64_tr_b16 v[58:59], v26 offset:60928
    ds_read_b64_tr_b16 v[60:61], v27 offset:59392
    ds_read_b64_tr_b16 v[62:63], v27 offset:60928
    s_waitcnt lgkmcnt(7)
    v_mfma_f32_32x32x16_bf16 v[64:79], v[32:35], v[36:39], v[64:79]
    v_mfma_f32_32x32x16_bf16 v[80:95], v[32:35], v[40:43], v[80:95]
    v_mfma_f32_32x32x16_bf16 v[96:111], v[32:35], v[44:47], v[96:111]
    s_waitcnt lgkmcnt(0)
    v_mfma_f32_32x32x16_bf16 v[64:79], v[48:51], v[52:55], v[64:79]
    v_mfma_f32_32x32x16_bf16 v[80:95], v[48:51], v[56:59], v[80:95]
    v_mfma_f32_32x32x16_bf16 v[96:111], v[48:51], v[60:63], v[96:111]
    s_waitcnt vmcnt(5)
    s_barrier
    ds_read_b128 v[32:35], v17 offset:0
    ds_read_b64_tr_b16 v[36:37], v29 offset:0
    ds_read_b64_tr_b16 v[38:39], v29 offset:1536
    ds_read_b64_tr_b16 v[40:41], v30 offset:0
    ds_read_b64_tr_b16 v[42:43], v30 offset:1536
    ds_read_b64_tr_b16 v[44:45], v31 offset:0
    ds_read_b64_tr_b16 v[46:47], v31 offset:1536
    s_cmp_lt_u32 s32, 4
    s_cbranch_scc1 CE_skipa1
    s_bitcmp1_b32 s98, 1
    s_cselect_b32 s49, s74, s72
    s_cselect_b32 s50, s75, s73
    s_mov_b32 s44, s49
    s_and_b32 s45, s50, 0xffff
    s_mov_b32 s46, 8388608
    s_mov_b32 s47, 0x00020000
    s_bfe_u32 s48, s98, 0x10002
    s_lshl_b32 s48, s48, 3
    s_lshr_b32 s49, s98, 5
    s_add_u32 s48, s48, s49
    s_lshl_b32 s48, s48, 7
    s_sub_u32 s49, s32, 4
    s_lshl_b32 s50, s49, 5
    s_add_u32 s48, s48, s50
    s_lshl_b32 s49, s49, 12
    v_lshrrev_b32 v114, 3, v1
    v_add_u32 v114, s48, v114
    s_mov_b32 s60, 4096
    v_mul_lo_u32 v114, v114, s60
    v_lshrrev_b32 v115, 4, v1
    v_and_b32 v116, 7, v1
    v_xor_b32 v117, v116, v115
    v_lshlrev_b32 v117, 4, v117
    v_add_u32 v112, v114, v117
    v_add_u32 v115, 4, v115
    v_xor_b32 v117, v116, v115
    v_lshlrev_b32 v117, 4, v117
    v_add_u32 v113, v114, v117
    v_add_u32 v113, 32768, v113
    v_subrev_u32 v113, 1024, v113
    s_and_b32 s42, s98, 1
    s_lshl_b32 s42, s42, 11
    s_add_u32 s43, s42, 63488
    s_add_u32 m0, s49, 122880
    s_nop 0
    buffer_load_dwordx4 v112, s[44:47], s42 offen offset:0 lds
    buffer_load_dwordx4 v113, s[44:47], s42 offen offset:1024 lds
    buffer_load_dwordx4 v112, s[44:47], s43 offen offset:2048 lds
    buffer_load_dwordx4 v113, s[44:47], s43 offen offset:3072 lds
    s_add_u32 s42, s42, 128
    s_add_u32 s43, s43, 128
    s_add_u32 m0, s49, 139264
    s_nop 0
    buffer_load_dwordx4 v112, s[44:47], s42 offen offset:0 lds
    buffer_load_dwordx4 v113, s[44:47], s42 offen offset:1024 lds
    buffer_load_dwordx4 v112, s[44:47], s43 offen offset:2048 lds
    buffer_load_dwordx4 v113, s[44:47], s43 offen offset:3072 lds
CE_skipa1:
    ds_read_b128 v[48:51], v18 offset:0
    ds_read_b64_tr_b16 v[52:53], v29 offset:6144
    ds_read_b64_tr_b16 v[54:55], v29 offset:7680
    ds_read_b64_tr_b16 v[56:57], v30 offset:6144
    ds_read_b64_tr_b16 v[58:59], v30 offset:7680
    ds_read_b64_tr_b16 v[60:61], v31 offset:6144
    ds_read_b64_tr_b16 v[62:63], v31 offset:7680
    s_waitcnt lgkmcnt(7)
    v_mfma_f32_32x32x16_bf16 v[64:79], v[32:35], v[36:39], v[64:79]
    v_mfma_f32_32x32x16_bf16 v[80:95], v[32:35], v[40:43], v[80:95]
    v_mfma_f32_32x32x16_bf16 v[96:111], v[32:35], v[44:47], v[96:111]
    ds_read_b128 v[32:35], v19 offset:0
    ds_read_b64_tr_b16 v[36:37], v29 offset:12288
    ds_read_b64_tr_b16 v[38:39], v29 offset:13824
    ds_read_b64_tr_b16 v[40:41], v30 offset:12288
    ds_read_b64_tr_b16 v[42:43], v30 offset:13824
    ds_read_b64_tr_b16 v[44:45], v31 offset:12288
    ds_read_b64_tr_b16 v[46:47], v31 offset:13824
    s_waitcnt lgkmcnt(7)
    v_mfma_f32_32x32x16_bf16 v[64:79], v[48:51], v[52:55], v[64:79]
    v_mfma_f32_32x32x16_bf16 v[80:95], v[48:51], v[56:59], v[80:95]
    v_mfma_f32_32x32x16_bf16 v[96:111], v[48:51], v[60:63], v[96:111]
    ds_read_b128 v[48:51], v20 offset:0
    ds_read_b64_tr_b16 v[52:53], v29 offset:18432
    ds_read_b64_tr_b16 v[54:55], v29 offset:19968
    ds_read_b64_tr_b16 v[56:57], v30 offset:18432
    ds_read_b64_tr_b16 v[58:59], v30 offset:19968
    ds_read_b64_tr_b16 v[60:61], v31 offset:18432
    ds_read_b64_tr_b16 v[62:63], v31 offset:19968
    s_waitcnt lgkmcnt(7)
    v_mfma_f32_32x32x16_bf16 v[64:79], v[32:35], v[36:39], v[64:79]
    v_mfma_f32_32x32x16_bf16 v[80:95], v[32:35], v[40:43], v[80:95]
    v_mfma_f32_32x32x16_bf16 v[96:111], v[32:35], v[44:47], v[96:111]
    s_waitcnt lgkmcnt(0)
    v_mfma_f32_32x32x16_bf16 v[64:79], v[48:51], v[52:55], v[64:79]
    v_mfma_f32_32x32x16_bf16 v[80:95], v[48:51], v[56:59], v[80:95]
    v_mfma_f32_32x32x16_bf16 v[96:111], v[48:51], v[60:63], v[96:111]
    s_cmp_lt_u32 s32, 4
    s_cbranch_scc1 CE_wa1_6
    s_waitcnt vmcnt(8)
    s_branch CE_xa1_6
CE_wa1_6:
    s_waitcnt vmcnt(0)
CE_xa1_6:
    s_barrier
    ds_read_b128 v[32:35], v13 offset:0
    ds_read_b64_tr_b16 v[36:37], v25 offset:0
    ds_read_b64_tr_b16 v[38:39], v25 offset:1536
    ds_read_b64_tr_b16 v[40:41], v26 offset:0
    ds_read_b64_tr_b16 v[42:43], v26 offset:1536
    ds_read_b64_tr_b16 v[44:45], v27 offset:0
    ds_read_b64_tr_b16 v[46:47], v27 offset:1536
    ds_read_b128 v[48:51], v14 offset:0
    ds_read_b64_tr_b16 v[52:53], v25 offset:6144
    ds_read_b64_tr_b16 v[54:55], v25 offset:7680
    ds_read_b64_tr_b16 v[56:57], v26 offset:6144
    ds_read_b64_tr_b16 v[58:59], v26 offset:7680
    ds_read_b64_tr_b16 v[60:61], v27 offset:6144
    ds_read_b64_tr_b16 v[62:63], v27 offset:7680
    s_waitcnt lgkmcnt(7)
    v_mfma_f32_32x32x16_bf16 v[64:79], v[32:35], v[36:39], v[64:79]
    v_mfma_f32_32x32x16_bf16 v[80:95], v[32:35], v[40:43], v[80:95]
    v_mfma_f32_32x32x16_bf16 v[96:111], v[32:35], v[44:47], v[96:111]
    ds_read_b128 v[32:35], v15 offset:0
    ds_read_b64_tr_b16 v[36:37], v25 offset:12288
    ds_read_b64_tr_b16 v[38:39], v25 offset:13824
    ds_read_b64_tr_b16 v[40:41], v26 offset:12288
    ds_read_b64_tr_b16 v[42:43], v26 offset:13824
    ds_read_b64_tr_b16 v[44:45], v27 offset:12288
    ds_read_b64_tr_b16 v[46:47], v27 offset:13824
    s_waitcnt lgkmcnt(7)
    v_mfma_f32_32x32x16_bf16 v[64:79], v[48:51], v[52:55], v[64:79]
    v_mfma_f32_32x32x16_bf16 v[80:95], v[48:51], v[56:59], v[80:95]
    v_mfma_f32_32x32x16_bf16 v[96:111], v[48:51], v[60:63], v[96:111]
    ds_read_b128 v[48:51], v16 offset:0
    ds_read_b64_tr_b16 v[52:53], v25 offset:18432
    ds_read_b64_tr_b16 v[54:55], v25 offset:19968
    ds_read_b64_tr_b16 v[56:57], v26 offset:18432
    ds_read_b64_tr_b16 v[58:59], v26 offset:19968
    ds_read_b64_tr_b16 v[60:61], v27 offset:18432
    ds_read_b64_tr_b16 v[62:63], v27 offset:19968
    s_waitcnt lgkmcnt(7)
    v_mfma_f32_32x32x16_bf16 v[64:79], v[32:35], v[36:39], v[64:79]
    v_mfma_f32_32x32x16_bf16 v[80:95], v[32:35], v[40:43], v[80:95]
    v_mfma_f32_32x32x16_bf16 v[96:111], v[32:35], v[44:47], v[96:111]
    s_waitcnt lgkmcnt(0)
    v_mfma_f32_32x32x16_bf16 v[64:79], v[48:51], v[52:55], v[64:79]
    v_mfma_f32_32x32x16_bf16 v[80:95], v[48:51], v[56:59], v[80:95]
    v_mfma_f32_32x32x16_bf16 v[96:111], v[48:51], v[60:63], v[96:111]
    v_mov_b32 v4, 0x3f803f80
    v_mov_b32 v6, 0
    v_mov_b32 v2, s68
    v_mov_b32 v3, s69
    s_nop 7
    s_cmp_lg_u32 s89, 0
    s_cbranch_scc1 K1A_dup1
    v_cvt_pk_bf16_f32 v32, v64, v65
    v_cvt_pk_bf16_f32 v33, v66, v67
    v_cvt_pk_bf16_f32 v34, v68, v69
    v_cvt_pk_bf16_f32 v35, v70, v71
    v_cvt_pk_bf16_f32 v36, v72, v73
    v_cvt_pk_bf16_f32 v37, v74, v75
    v_cvt_pk_bf16_f32 v38, v76, v77
    v_cvt_pk_bf16_f32 v39, v78, v79
    v_cndmask_b32 v32, v32, v4, s[62:63]
    v_cndmask_b32 v32, v32, v6, s[64:65]
    v_cndmask_b32 v33, v33, v4, s[62:63]
    v_cndmask_b32 v33, v33, v6, s[64:65]
    v_cndmask_b32 v34, v34, v4, s[62:63]
    v_cndmask_b32 v34, v34, v6, s[64:65]
    v_cndmask_b32 v35, v35, v4, s[62:63]
    v_cndmask_b32 v35, v35, v6, s[64:65]
    v_cndmask_b32 v36, v36, v4, s[62:63]
    v_cndmask_b32 v36, v36, v6, s[64:65]
    v_cndmask_b32 v37, v37, v4, s[62:63]
    v_cndmask_b32 v37, v37, v6, s[64:65]
    v_cndmask_b32 v38, v38, v4, s[62:63]
    v_cndmask_b32 v38, v38, v6, s[64:65]
    v_cndmask_b32 v39, v39, v4, s[62:63]
    v_cndmask_b32 v39, v39, v6, s[64:65]
    buffer_store_dwordx4 v[32:35], v28, s[28:31], s56 offen sc0 sc1
    buffer_store_dwordx4 v[36:39], v28, s[28:31], s56 offen offset:1024 sc0 sc1
K1A_dup1:
    s_add_u32 s56, s56, 131072
    v_cvt_pk_bf16_f32 v40, v80, v81
    v_cvt_pk_bf16_f32 v41, v82, v83
    v_cvt_pk_bf16_f32 v42, v84, v85
    v_cvt_pk_bf16_f32 v43, v86, v87
    v_cvt_pk_bf16_f32 v44, v88, v89
    v_cvt_pk_bf16_f32 v45, v90, v91
    v_cvt_pk_bf16_f32 v46, v92, v93
    v_cvt_pk_bf16_f32 v47, v94, v95
    v_cndmask_b32 v40, v40, v4, s[62:63]
    v_cndmask_b32 v40, v40, v6, s[64:65]
    v_cndmask_b32 v41, v41, v4, s[62:63]
    v_cndmask_b32 v41, v41, v6, s[64:65]
    v_cndmask_b32 v42, v42, v4, s[62:63]
    v_cndmask_b32 v42, v42, v6, s[64:65]
    v_cndmask_b32 v43, v43, v4, s[62:63]
    v_cndmask_b32 v43, v43, v6, s[64:65]
    v_cndmask_b32 v44, v44, v4, s[62:63]
    v_cndmask_b32 v44, v44, v6, s[64:65]
    v_cndmask_b32 v45, v45, v4, s[62:63]
    v_cndmask_b32 v45, v45, v6, s[64:65]
    v_cndmask_b32 v46, v46, v4, s[62:63]
    v_cndmask_b32 v46, v46, v6, s[64:65]
    v_cndmask_b32 v47, v47, v4, s[62:63]
    v_cndmask_b32 v47, v47, v6, s[64:65]
    buffer_store_dwordx4 v[40:43], v28, s[28:31], s56 offen sc0 sc1
    buffer_store_dwordx4 v[44:47], v28, s[28:31], s56 offen offset:1024 sc0 sc1
    s_add_u32 s56, s56, 131072
    v_cvt_pk_bf16_f32 v48, v96, v97
    v_cvt_pk_bf16_f32 v49, v98, v99
    v_cvt_pk_bf16_f32 v50, v100, v101
    v_cvt_pk_bf16_f32 v51, v102, v103
    v_cvt_pk_bf16_f32 v52, v104, v105
    v_cvt_pk_bf16_f32 v53, v106, v107
    v_cvt_pk_bf16_f32 v54, v108, v109
    v_cvt_pk_bf16_f32 v55, v110, v111
    v_cndmask_b32 v48, v48, v4, s[62:63]
    v_cndmask_b32 v48, v48, v6, s[64:65]
    v_cndmask_b32 v49, v49, v4, s[62:63]
    v_cndmask_b32 v49, v49, v6, s[64:65]
    v_cndmask_b32 v50, v50, v4, s[62:63]
    v_cndmask_b32 v50, v50, v6, s[64:65]
    v_cndmask_b32 v51, v51, v4, s[62:63]
    v_cndmask_b32 v51, v51, v6, s[64:65]
    v_cndmask_b32 v52, v52, v4, s[62:63]
    v_cndmask_b32 v52, v52, v6, s[64:65]
    v_cndmask_b32 v53, v53, v4, s[62:63]
    v_cndmask_b32 v53, v53, v6, s[64:65]
    v_cndmask_b32 v54, v54, v4, s[62:63]
    v_cndmask_b32 v54, v54, v6, s[64:65]
    v_cndmask_b32 v55, v55, v4, s[62:63]
    v_cndmask_b32 v55, v55, v6, s[64:65]
    buffer_store_dwordx4 v[48:51], v28, s[28:31], s56 offen sc0 sc1
    buffer_store_dwordx4 v[52:55], v28, s[28:31], s56 offen offset:1024 sc0 sc1
    s_branch K1_done
K1_B:
    s_and_b32 s33, s2, 7
    s_lshl_b32 s33, s33, 1
    s_bfe_u32 s34, s2, 0x10003
    s_or_b32 s33, s33, s34
    s_sub_u32 s34, s2, 144
    s_lshr_b32 s34, s34, 4
    s_lshl_b32 s34, s34, 1
    s_add_u32 s34, s34, s88
    s_cmp_ge_u32 s34, 7
    s_cselect_b32 s35, 1, 0
    s_mul_i32 s36, s35, 7
    s_sub_u32 s36, s34, s36
    s_lshl_b32 s37, s33, 7
    s_lshl_b32 s38, s61, 5
    s_add_u32 s37, s37, s38
    v_lshrrev_b32 v2, 3, v1
    v_add_u32 v2, s37, v2
    s_mov_b32 s60, 896
    v_mul_lo_u32 v2, v2, s60
    v_lshrrev_b32 v3, 4, v1
    v_and_b32 v4, 7, v1
    v_xor_b32 v5, v4, v3
    v_lshlrev_b32 v5, 4, v5
    v_add_u32 v10, v2, v5
    v_add_u32 v3, 4, v3
    v_xor_b32 v5, v4, v3
    v_lshlrev_b32 v5, 4, v5
    v_add_u32 v11, v2, v5
    v_add_u32 v11, 7168, v11
    v_subrev_u32 v11, 1024, v11
    s_lshl_b32 s37, s36, 6
    s_lshl_b32 s38, s61, 4
    s_add_u32 s37, s37, s38
    v_lshrrev_b32 v2, 3, v1
    v_add_u32 v2, s37, v2
    s_mov_b32 s60, 896
    v_mul_lo_u32 v2, v2, s60
    v_lshrrev_b32 v3, 4, v1
    v_and_b32 v4, 7, v1
    v_xor_b32 v5, v4, v3
    v_lshlrev_b32 v5, 4, v5
    v_add_u32 v8, v2, v5
    v_add_u32 v3, 4, v3
    v_xor_b32 v5, v4, v3
    v_lshlrev_b32 v5, 4, v5
    v_add_u32 v9, v2, v5
    v_add_u32 v9, 7168, v9
    v_subrev_u32 v9, 1024, v9
    s_lshl_b32 s52, s61, 12
    s_add_u32 s52, s52, 0
    s_lshl_b32 s53, s61, 11
    s_add_u32 s53, s53, 16384
    s_mov_b32 s40, 0
    s_mov_b32 s41, 12288
    s_mul_i32 s41, s88, 14336
    s_lshl_b32 s89, s88, 13
    s_add_u32 s53, s53, s89
    s_lshl_b32 s87, s88, 11
    s_add_u32 s52, s52, s87
    s_waitcnt lgkmcnt(0)
    s_cmp_eq_u32 s35, 1
    s_cselect_b32 s38, s14, s12
    s_cselect_b32 s39, s15, s13
    s_mov_b32 s28, s16
    s_and_b32 s29, s17, 0xffff
    s_mov_b32 s30, 33554432
    s_mov_b32 s31, 0x00020000
    s_mov_b32 s20, s10
    s_and_b32 s21, s11, 0xffff
    s_mov_b32 s22, 1835008
    s_mov_b32 s23, 0x00020000
    s_mov_b32 s24, s38
    s_and_b32 s25, s39, 0xffff
    s_mov_b32 s26, 401408
    s_mov_b32 s27, 0x00020000
    s_mov_b32 s80, s18
    s_and_b32 s81, s19, 0xffff
    s_mov_b32 s82, 256
    s_mov_b32 s83, 0x00020000
    v_lshrrev_b32 v2, 3, v1
    v_lshlrev_b32 v2, 8, v2
    v_and_b32 v3, 7, v1
    v_lshlrev_b32 v3, 4, v3
    v_add_u32 v105, v2, v3
    v_lshlrev_b32 v107, 7, v1
    v_mov_b32 v100, 0
    v_mov_b32 v101, 0
    v_mov_b32 v102, 0
    v_mov_b32 v103, 0
    v_mov_b32 v106, 0
    v_mov_b32 v108, 0
    v_mov_b32 v104, 1
    v_mov_b32 v109, 3
    s_and_b32 s69, s2, 63
    s_lshl_b32 s68, s69, 11
    s_add_u32 s68, s68, 14680064
    s_lshl_b32 s70, s69, 9
    s_add_u32 s70, s70, 32505856
    s_lshl_b32 s69, s69, 2
    s_sub_u32 s66, s2, 144
    s_mov_b32 s67, 0
    s_cmp_lt_u32 s32, 6
    s_cbranch_scc1 K1B_nox
    s_cmp_eq_u32 s32, 6
    s_cbranch_scc1 K1B_zero
    s_cmp_ge_u32 s66, 56
    s_cbranch_scc1 K1B_nox
    s_mov_b32 s67, 1
    s_mov_b32 s76, s8
    s_and_b32 s77, s9, 0xffff
    s_mov_b32 s78, 401408
    s_mov_b32 s79, 0x00020000
    v_lshrrev_b32 v2, 2, v1
    s_mov_b32 s60, 896
    v_mul_lo_u32 v2, v2, s60
    v_and_b32 v3, 3, v1
    v_lshlrev_b32 v3, 4, v3
    v_add_u32 v100, v2, v3
    s_and_b32 s68, s66, 3
    s_mul_i32 s68, s68, 100352
    s_lshr_b32 s69, s66, 2
    s_lshl_b32 s69, s69, 6
    s_add_u32 s68, s68, s69
    s_mov_b32 m0, 32768
    s_nop 0
    buffer_load_dwordx4 v100, s[76:79], s68 offen lds
    s_add_u32 s68, s68, 14336
    s_mov_b32 m0, 33792
    s_nop 0
    buffer_load_dwordx4 v100, s[76:79], s68 offen lds
    s_add_u32 s68, s68, 14336
    s_mov_b32 m0, 34816
    s_nop 0
    buffer_load_dwordx4 v100, s[76:79], s68 offen lds
    s_add_u32 s68, s68, 14336
    s_mov_b32 m0, 35840
    s_nop 0
    buffer_load_dwordx4 v100, s[76:79], s68 offen lds
    s_add_u32 s68, s68, 14336
    s_mov_b32 m0, 36864
    s_nop 0
    buffer_load_dwordx4 v100, s[76:79], s68 offen lds
    s_add_u32 s68, s68, 14336
    s_mov_b32 m0, 37888
    s_nop 0
    buffer_load_dwordx4 v100, s[76:79], s68 offen lds
    s_add_u32 s68, s68, 14336
    s_mov_b32 m0, 38912
    s_nop 0
    buffer_load_dwordx4 v100, s[76:79], s68 offen lds
    s_add_u32 s68, s68, 14336
    s_branch K1B_nox
K1B_zero:
    s_cmp_lt_u32 s66, 48
    s_cbranch_scc1 K1B_nox
    s_mov_b32 s67, 2
K1B_nox:
    s_add_u32 m0, s52, 0
    s_nop 0
    buffer_load_dwordx4 v10, s[20:23], s41 offen offset:0 lds
    buffer_load_dwordx4 v11, s[20:23], s41 offen offset:1024 lds
    s_add_u32 m0, s53, 0
    s_nop 0
    buffer_load_dwordx4 v8, s[24:27], s40 offen offset:0 lds
    buffer_load_dwordx4 v9, s[24:27], s40 offen offset:1024 lds
    s_add_u32 s40, s40, 128
    s_add_u32 s41, s41, 128
    s_add_u32 m0, s52, 40960
    s_nop 0
    buffer_load_dwordx4 v10, s[20:23], s41 offen offset:0 lds
    buffer_load_dwordx4 v11, s[20:23], s41 offen offset:1024 lds
    s_add_u32 m0, s53, 40960
    s_nop 0
    buffer_load_dwordx4 v8, s[24:27], s40 offen offset:0 lds
    buffer_load_dwordx4 v9, s[24:27], s40 offen offset:1024 lds
    s_add_u32 s40, s40, 128
    s_add_u32 s41, s41, 128
    s_cmp_lg_u32 s67, 2
    s_cbranch_scc1 Z_n0
    s_mov_b64 exec, 1
    buffer_atomic_or v104, v108, s[80:83], s69 offen sc0 sc1
    s_mov_b64 exec, -1
Z_n0:
    v_and_b32 v2, 31, v1
    v_lshrrev_b32 v3, 1, v2
    v_and_b32 v3, 7, v3
    v_lshrrev_b32 v4, 5, v1
    v_lshlrev_b32 v2, 7, v2
    v_add_u32 v5, 0, v4
    v_xor_b32 v5, v5, v3
    v_lshlrev_b32 v5, 4, v5
    v_add_u32 v12, v5, v2
    v_add_u32 v5, 2, v4
    v_xor_b32 v5, v5, v3
    v_lshlrev_b32 v5, 4, v5
    v_add_u32 v13, v5, v2
    v_add_u32 v5, 4, v4
    v_xor_b32 v5, v5, v3
    v_lshlrev_b32 v5, 4, v5
    v_add_u32 v14, v5, v2
    v_add_u32 v5, 6, v4
    v_xor_b32 v5, v5, v3
    v_lshlrev_b32 v5, 4, v5
    v_add_u32 v15, v5, v2
    s_and_b32 s56, s61, 1
    s_lshl_b32 s56, s56, 13
    s_add_u32 s56, s56, 0
    s_lshr_b32 s57, s61, 1
    s_lshl_b32 s57, s57, 12
    s_add_u32 s57, s57, 16384
    s_add_u32 s57, s57, s89
    v_add_u32 v24, s57, v12
    v_add_u32 v12, s56, v12
    v_add_u32 v16, 40960, v12
    v_add_u32 v20, 81920, v12
    v_add_u32 v28, 40960, v24
    v_add_u32 v32, 81920, v24
    v_add_u32 v25, s57, v13
    v_add_u32 v13, s56, v13
    v_add_u32 v17, 40960, v13
    v_add_u32 v21, 81920, v13
    v_add_u32 v29, 40960, v25
    v_add_u32 v33, 81920, v25
    v_add_u32 v26, s57, v14
    v_add_u32 v14, s56, v14
    v_add_u32 v18, 40960, v14
    v_add_u32 v22, 81920, v14
    v_add_u32 v30, 40960, v26
    v_add_u32 v34, 81920, v26
    v_add_u32 v27, s57, v15
    v_add_u32 v15, s56, v15
    v_add_u32 v19, 40960, v15
    v_add_u32 v23, 81920, v15
    v_add_u32 v31, 40960, v27
    v_add_u32 v35, 81920, v27
    v_mov_b32 v64, 0
    v_mov_b32 v65, 0
    v_mov_b32 v66, 0
    v_mov_b32 v67, 0
    v_mov_b32 v68, 0
    v_mov_b32 v69, 0
    v_mov_b32 v70, 0
    v_mov_b32 v71, 0
    v_mov_b32 v72, 0
    v_mov_b32 v73, 0
    v_mov_b32 v74, 0
    v_mov_b32 v75, 0
    v_mov_b32 v76, 0
    v_mov_b32 v77, 0
    v_mov_b32 v78, 0
    v_mov_b32 v79, 0
    v_mov_b32 v80, 0
    v_mov_b32 v81, 0
    v_mov_b32 v82, 0
    v_mov_b32 v83, 0
    v_mov_b32 v84, 0
    v_mov_b32 v85, 0
    v_mov_b32 v86, 0
    v_mov_b32 v87, 0
    v_mov_b32 v88, 0
    v_mov_b32 v89, 0
    v_mov_b32 v90, 0
    v_mov_b32 v91, 0
    v_mov_b32 v92, 0
    v_mov_b32 v93, 0
    v_mov_b32 v94, 0
    v_mov_b32 v95, 0
    s_lshl_b32 s58, s36, 1
    s_lshr_b32 s59, s61, 1
    s_add_u32 s58, s58, s59
    s_cmp_ge_u32 s58, 7
    s_cselect_b32 s59, 1, 0
    s_mul_i32 s60, s59, 7
    s_sub_u32 s58, s58, s60
    s_lshl_b32 s60, s35, 1
    s_add_u32 s59, s59, s60
    s_lshl_b32 s59, s59, 5
    s_lshl_b32 s60, s33, 1
    s_add_u32 s59, s59, s60
    s_and_b32 s60, s61, 1
    s_add_u32 s59, s59, s60
    s_mul_i32 s59, s59, 7
    s_add_u32 s59, s59, s58
    s_lshl_b32 s59, s59, 12
    s_add_u32 s84, s59, 6291456
    v_and_b32 v2, 31, v1
    v_lshlrev_b32 v37, 7, v2
    v_lshlrev_b32 v2, 4, v2
    v_lshrrev_b32 v3, 5, v1
    v_lshlrev_b32 v3, 3, v3
    v_add_u32 v36, v2, v3
    s_and_b32 s85, s33, 3
    s_lshl_b32 s58, s36, 1
    s_lshr_b32 s59, s61, 1
    s_add_u32 s58, s58, s59
    s_lshl_b32 s58, s58, 1
    s_lshl_b32 s60, s33, 1
    s_and_b32 s59, s61, 1
    s_add_u32 s60, s60, s59
    s_lshl_b32 s59, s35, 7
    s_add_u32 s60, s60, s59
    s_mul_i32 s59, s58, 37
    s_lshr_b32 s59, s59, 8
    s_mul_i32 s86, s59, 7
    s_sub_u32 s86, s58, s86
    s_lshl_b32 s59, s59, 5
    s_add_u32 s59, s59, s60
    s_mul_i32 s59, s59, 14336
    s_lshl_b32 s86, s86, 11
    s_add_u32 s84, s59, s86
    s_add_u32 s58, s58, 1
    s_mul_i32 s59, s58, 37
    s_lshr_b32 s59, s59, 8
    s_mul_i32 s86, s59, 7
    s_sub_u32 s86, s58, s86
    s_lshl_b32 s59, s59, 5
    s_add_u32 s59, s59, s60
    s_mul_i32 s59, s59, 14336
    s_lshl_b32 s86, s86, 11
    s_add_u32 s85, s59, s86
    s_add_u32 s58, s58, 1
    s_sub_u32 s85, s85, s84
    s_add_u32 s84, s84, 6291456
    v_and_b32 v2, 15, v1
    v_lshlrev_b32 v2, 4, v2
    v_lshrrev_b32 v3, 5, v1
    v_lshlrev_b32 v3, 3, v3
    v_add_u32 v2, v2, v3
    v_bfe_u32 v3, v1, 4, 1
    v_mul_lo_u32 v3, v3, s85
    v_add_u32 v36, v2, v3
    s_cmp_lg_u32 s67, 2
    s_cbranch_scc1 Z_w0
    s_waitcnt vmcnt(5)
    s_branch Z_x0
Z_w0:
    s_waitcnt vmcnt(4)
Z_x0:
    s_barrier
    ds_read_b128 v[40:43], v12 offset:0
    ds_read_b128 v[44:47], v12 offset:4096
    ds_read_b128 v[48:51], v24
    s_add_u32 m0, s52, 81920
    s_nop 0
    buffer_load_dwordx4 v10, s[20:23], s41 offen offset:0 lds
    buffer_load_dwordx4 v11, s[20:23], s41 offen offset:1024 lds
    s_add_u32 m0, s53, 81920
    s_nop 0
    buffer_load_dwordx4 v8, s[24:27], s40 offen offset:0 lds
    buffer_load_dwordx4 v9, s[24:27], s40 offen offset:1024 lds
    s_add_u32 s40, s40, 128
    s_add_u32 s41, s41, 128
    ds_read_b128 v[52:55], v13 offset:0
    ds_read_b128 v[56:59], v13 offset:4096
    ds_read_b128 v[60:63], v25
    s_waitcnt lgkmcnt(3)
    v_mfma_f32_32x32x16_bf16 v[64:79], v[40:43], v[48:51], v[64:79]
    v_mfma_f32_32x32x16_bf16 v[80:95], v[44:47], v[48:51], v[80:95]
    ds_read_b128 v[40:43], v14 offset:0
    ds_read_b128 v[44:47], v14 offset:4096
    ds_read_b128 v[48:51], v26
    s_waitcnt lgkmcnt(3)
    v_mfma_f32_32x32x16_bf16 v[64:79], v[52:55], v[60:63], v[64:79]
    v_mfma_f32_32x32x16_bf16 v[80:95], v[56:59], v[60:63], v[80:95]
    ds_read_b128 v[52:55], v15 offset:0
    ds_read_b128 v[56:59], v15 offset:4096
    ds_read_b128 v[60:63], v27
    s_waitcnt lgkmcnt(3)
    v_mfma_f32_32x32x16_bf16 v[64:79], v[40:43], v[48:51], v[64:79]
    v_mfma_f32_32x32x16_bf16 v[80:95], v[44:47], v[48:51], v[80:95]
    s_waitcnt lgkmcnt(0)
    v_mfma_f32_32x32x16_bf16 v[64:79], v[52:55], v[60:63], v[64:79]
    v_mfma_f32_32x32x16_bf16 v[80:95], v[56:59], v[60:63], v[80:95]
    s_cmp_lg_u32 s67, 2
    s_cbranch_scc1 Z_w1
    s_waitcnt vmcnt(5)
    s_branch Z_x1
Z_w1:
    s_waitcnt vmcnt(4)
Z_x1:
    s_barrier
    ds_read_b128 v[40:43], v16 offset:0
    ds_read_b128 v[44:47], v16 offset:4096
    ds_read_b128 v[48:51], v28
    s_add_u32 m0, s52, 0
    s_nop 0
    buffer_load_dwordx4 v10, s[20:23], s41 offen offset:0 lds
    buffer_load_dwordx4 v11, s[20:23], s41 offen offset:1024 lds
    s_add_u32 m0, s53, 0
    s_nop 0
    buffer_load_dwordx4 v8, s[24:27], s40 offen offset:0 lds
    buffer_load_dwordx4 v9, s[24:27], s40 offen offset:1024 lds
    s_add_u32 s40, s40, 128
    s_add_u32 s41, s41, 128
    ds_read_b128 v[52:55], v17 offset:0
    ds_read_b128 v[56:59], v17 offset:4096
    ds_read_b128 v[60:63], v29
    s_waitcnt lgkmcnt(3)
    v_mfma_f32_32x32x16_bf16 v[64:79], v[40:43], v[48:51], v[64:79]
    v_mfma_f32_32x32x16_bf16 v[80:95], v[44:47], v[48:51], v[80:95]
    ds_read_b128 v[40:43], v18 offset:0
    ds_read_b128 v[44:47], v18 offset:4096
    ds_read_b128 v[48:51], v30
    s_waitcnt lgkmcnt(3)
    v_mfma_f32_32x32x16_bf16 v[64:79], v[52:55], v[60:63], v[64:79]
    v_mfma_f32_32x32x16_bf16 v[80:95], v[56:59], v[60:63], v[80:95]
    ds_read_b128 v[52:55], v19 offset:0
    ds_read_b128 v[56:59], v19 offset:4096
    ds_read_b128 v[60:63], v31
    s_waitcnt lgkmcnt(3)
    v_mfma_f32_32x32x16_bf16 v[64:79], v[40:43], v[48:51], v[64:79]
    v_mfma_f32_32x32x16_bf16 v[80:95], v[44:47], v[48:51], v[80:95]
    s_waitcnt lgkmcnt(0)
    v_mfma_f32_32x32x16_bf16 v[64:79], v[52:55], v[60:63], v[64:79]
    v_mfma_f32_32x32x16_bf16 v[80:95], v[56:59], v[60:63], v[80:95]
    s_waitcnt vmcnt(4)
    s_barrier
    ds_read_b128 v[40:43], v20 offset:0
    ds_read_b128 v[44:47], v20 offset:4096
    ds_read_b128 v[48:51], v32
    s_add_u32 m0, s52, 40960
    s_nop 0
    buffer_load_dwordx4 v10, s[20:23], s41 offen offset:0 lds
    buffer_load_dwordx4 v11, s[20:23], s41 offen offset:1024 lds
    s_add_u32 m0, s53, 40960
    s_nop 0
    buffer_load_dwordx4 v8, s[24:27], s40 offen offset:0 lds
    buffer_load_dwordx4 v9, s[24:27], s40 offen offset:1024 lds
    s_add_u32 s40, s40, 128
    s_add_u32 s41, s41, 128
    s_cmp_lg_u32 s67, 2
    s_cbranch_scc1 Z_n1
    v_readfirstlane_b32 s71, v104
    s_cmp_lg_u32 s71, 0
    s_cselect_b32 s67, 0, 2
    s_cbranch_scc1 Z_n1
    buffer_atomic_swap_x2 v[100:101], v105, s[28:31], s68 offen sc0 sc1
    buffer_atomic_swap_x2 v[102:103], v105, s[28:31], s68 offen offset:8 sc0 sc1
    s_mov_b64 exec, 15
    buffer_atomic_swap v106, v107, s[28:31], s70 offen sc0 sc1
    s_mov_b64 exec, -1
Z_n1:
    ds_read_b128 v[52:55], v21 offset:0
    ds_read_b128 v[56:59], v21 offset:4096
    ds_read_b128 v[60:63], v33
    s_waitcnt lgkmcnt(3)
    v_mfma_f32_32x32x16_bf16 v[64:79], v[40:43], v[48:51], v[64:79]
    v_mfma_f32_32x32x16_bf16 v[80:95], v[44:47], v[48:51], v[80:95]
    ds_read_b128 v[40:43], v22 offset:0
    ds_read_b128 v[44:47], v22 offset:4096
    ds_read_b128 v[48:51], v34
    s_waitcnt lgkmcnt(3)
    v_mfma_f32_32x32x16_bf16 v[64:79], v[52:55], v[60:63], v[64:79]
    v_mfma_f32_32x32x16_bf16 v[80:95], v[56:59], v[60:63], v[80:95]
    ds_read_b128 v[52:55], v23 offset:0
    ds_read_b128 v[56:59], v23 offset:4096
    ds_read_b128 v[60:63], v35
    s_waitcnt lgkmcnt(3)
    v_mfma_f32_32x32x16_bf16 v[64:79], v[40:43], v[48:51], v[64:79]
    v_mfma_f32_32x32x16_bf16 v[80:95], v[44:47], v[48:51], v[80:95]
    s_waitcnt lgkmcnt(0)
    v_mfma_f32_32x32x16_bf16 v[64:79], v[52:55], v[60:63], v[64:79]
    v_mfma_f32_32x32x16_bf16 v[80:95], v[56:59], v[60:63], v[80:95]
    s_cmp_lg_u32 s67, 2
    s_cbranch_scc1 Z_w3
    s_waitcnt vmcnt(7)
    s_branch Z_x3
Z_w3:
    s_waitcnt vmcnt(4)
Z_x3:
    s_barrier
    ds_read_b128 v[40:43], v12 offset:0
    ds_read_b128 v[44:47], v12 offset:4096
    ds_read_b128 v[48:51], v24
    s_add_u32 m0, s52, 81920
    s_nop 0
    buffer_load_dwordx4 v10, s[20:23], s41 offen offset:0 lds
    buffer_load_dwordx4 v11, s[20:23], s41 offen offset:1024 lds
    s_add_u32 m0, s53, 81920
    s_nop 0
    buffer_load_dwordx4 v8, s[24:27], s40 offen offset:0 lds
    buffer_load_dwordx4 v9, s[24:27], s40 offen offset:1024 lds
    s_add_u32 s40, s40, 128
    s_add_u32 s41, s41, 128
    ds_read_b128 v[52:55], v13 offset:0
    ds_read_b128 v[56:59], v13 offset:4096
    ds_read_b128 v[60:63], v25
    s_waitcnt lgkmcnt(3)
    v_mfma_f32_32x32x16_bf16 v[64:79], v[40:43], v[48:51], v[64:79]
    v_mfma_f32_32x32x16_bf16 v[80:95], v[44:47], v[48:51], v[80:95]
    ds_read_b128 v[40:43], v14 offset:0
    ds_read_b128 v[44:47], v14 offset:4096
    ds_read_b128 v[48:51], v26
    s_waitcnt lgkmcnt(3)
    v_mfma_f32_32x32x16_bf16 v[64:79], v[52:55], v[60:63], v[64:79]
    v_mfma_f32_32x32x16_bf16 v[80:95], v[56:59], v[60:63], v[80:95]
    ds_read_b128 v[52:55], v15 offset:0
    ds_read_b128 v[56:59], v15 offset:4096
    ds_read_b128 v[60:63], v27
    s_waitcnt lgkmcnt(3)
    v_mfma_f32_32x32x16_bf16 v[64:79], v[40:43], v[48:51], v[64:79]
    v_mfma_f32_32x32x16_bf16 v[80:95], v[44:47], v[48:51], v[80:95]
    s_waitcnt lgkmcnt(0)
    v_mfma_f32_32x32x16_bf16 v[64:79], v[52:55], v[60:63], v[64:79]
    v_mfma_f32_32x32x16_bf16 v[80:95], v[56:59], v[60:63], v[80:95]
    s_cmp_lg_u32 s67, 2
    s_cbranch_scc1 Z_w4
    s_waitcnt vmcnt(7)
    s_branch Z_x4
Z_w4:
    s_waitcnt vmcnt(4)
Z_x4:
    s_barrier
    ds_read_b128 v[40:43], v16 offset:0
    ds_read_b128 v[44:47], v16 offset:4096
    ds_read_b128 v[48:51], v28
    s_add_u32 m0, s52, 0
    s_nop 0
    buffer_load_dwordx4 v10, s[20:23], s41 offen offset:0 lds
    buffer_load_dwordx4 v11, s[20:23], s41 offen offset:1024 lds
    s_add_u32 m0, s53, 0
    s_nop 0
    buffer_load_dwordx4 v8, s[24:27], s40 offen offset:0 lds
    buffer_load_dwordx4 v9, s[24:27], s40 offen offset:1024 lds
    s_add_u32 s40, s40, 128
    s_add_u32 s41, s41, 128
    ds_read_b128 v[52:55], v17 offset:0
    ds_read_b128 v[56:59], v17 offset:4096
    ds_read_b128 v[60:63], v29
    s_waitcnt lgkmcnt(3)
    v_mfma_f32_32x32x16_bf16 v[64:79], v[40:43], v[48:51], v[64:79]
    v_mfma_f32_32x32x16_bf16 v[80:95], v[44:47], v[48:51], v[80:95]
    ds_read_b128 v[40:43], v18 offset:0
    ds_read_b128 v[44:47], v18 offset:4096
    ds_read_b128 v[48:51], v30
    s_waitcnt lgkmcnt(3)
    v_mfma_f32_32x32x16_bf16 v[64:79], v[52:55], v[60:63], v[64:79]
    v_mfma_f32_32x32x16_bf16 v[80:95], v[56:59], v[60:63], v[80:95]
    ds_read_b128 v[52:55], v19 offset:0
    ds_read_b128 v[56:59], v19 offset:4096
    ds_read_b128 v[60:63], v31
    s_waitcnt lgkmcnt(3)
    v_mfma_f32_32x32x16_bf16 v[64:79], v[40:43], v[48:51], v[64:79]
    v_mfma_f32_32x32x16_bf16 v[80:95], v[44:47], v[48:51], v[80:95]
    s_waitcnt lgkmcnt(0)
    v_mfma_f32_32x32x16_bf16 v[64:79], v[52:55], v[60:63], v[64:79]
    v_mfma_f32_32x32x16_bf16 v[80:95], v[56:59], v[60:63], v[80:95]
    s_waitcnt vmcnt(4)
    s_barrier
    ds_read_b128 v[40:43], v20 offset:0
    ds_read_b128 v[44:47], v20 offset:4096
    ds_read_b128 v[48:51], v32
    s_cmp_lg_u32 s67, 2
    s_cbranch_scc1 Z_n3
    s_mov_b64 exec, 1
    buffer_store_dword v109, v108, s[80:83], s69 offen sc0 sc1
    s_mov_b64 exec, -1
Z_n3:
    s_cmp_lt_u32 s32, 4
    s_cbranch_scc1 CE_skipb
    s_bitcmp1_b32 s98, 1
    s_cselect_b32 s49, s74, s72
    s_cselect_b32 s50, s75, s73
    s_mov_b32 s44, s49
    s_and_b32 s45, s50, 0xffff
    s_mov_b32 s46, 8388608
    s_mov_b32 s47, 0x00020000
    s_bfe_u32 s48, s98, 0x10002
    s_lshl_b32 s48, s48, 3
    s_lshr_b32 s49, s98, 5
    s_add_u32 s48, s48, s49
    s_lshl_b32 s48, s48, 7
    s_sub_u32 s49, s32, 4
    s_lshl_b32 s50, s49, 5
    s_add_u32 s48, s48, s50
    s_lshl_b32 s49, s49, 12
    v_lshrrev_b32 v114, 3, v1
    v_add_u32 v114, s48, v114
    s_mov_b32 s60, 4096
    v_mul_lo_u32 v114, v114, s60
    v_lshrrev_b32 v115, 4, v1
    v_and_b32 v116, 7, v1
    v_xor_b32 v117, v116, v115
    v_lshlrev_b32 v117, 4, v117
    v_add_u32 v112, v114, v117
    v_add_u32 v115, 4, v115
    v_xor_b32 v117, v116, v115
    v_lshlrev_b32 v117, 4, v117
    v_add_u32 v113, v114, v117
    v_add_u32 v113, 32768, v113
    v_subrev_u32 v113, 1024, v113
    s_and_b32 s42, s98, 1
    s_lshl_b32 s42, s42, 11
    s_add_u32 s43, s42, 63488
    s_add_u32 m0, s49, 122880
    s_nop 0
    buffer_load_dwordx4 v112, s[44:47], s42 offen offset:0 lds
    buffer_load_dwordx4 v113, s[44:47], s42 offen offset:1024 lds
    buffer_load_dwordx4 v112, s[44:47], s43 offen offset:2048 lds
    buffer_load_dwordx4 v113, s[44:47], s43 offen offset:3072 lds
    s_add_u32 s42, s42, 128
    s_add_u32 s43, s43, 128
    s_add_u32 m0, s49, 139264
    s_nop 0
    buffer_load_dwordx4 v112, s[44:47], s42 offen offset:0 lds
    buffer_load_dwordx4 v113, s[44:47], s42 offen offset:1024 lds
    buffer_load_dwordx4 v112, s[44:47], s43 offen offset:2048 lds
    buffer_load_dwordx4 v113, s[44:47], s43 offen offset:3072 lds
CE_skipb:
    ds_read_b128 v[52:55], v21 offset:0
    ds_read_b128 v[56:59], v21 offset:4096
    ds_read_b128 v[60:63], v33
    s_waitcnt lgkmcnt(3)
    v_mfma_f32_32x32x16_bf16 v[64:79], v[40:43], v[48:51], v[64:79]
    v_mfma_f32_32x32x16_bf16 v[80:95], v[44:47], v[48:51], v[80:95]
    ds_read_b128 v[40:43], v22 offset:0
    ds_read_b128 v[44:47], v22 offset:4096
    ds_read_b128 v[48:51], v34
    s_waitcnt lgkmcnt(3)
    v_mfma_f32_32x32x16_bf16 v[64:79], v[52:55], v[60:63], v[64:79]
    v_mfma_f32_32x32x16_bf16 v[80:95], v[56:59], v[60:63], v[80:95]
    ds_read_b128 v[52:55], v23 offset:0
    ds_read_b128 v[56:59], v23 offset:4096
    ds_read_b128 v[60:63], v35
    s_waitcnt lgkmcnt(3)
    v_mfma_f32_32x32x16_bf16 v[64:79], v[40:43], v[48:51], v[64:79]
    v_mfma_f32_32x32x16_bf16 v[80:95], v[44:47], v[48:51], v[80:95]
    s_waitcnt lgkmcnt(0)
    v_mfma_f32_32x32x16_bf16 v[64:79], v[52:55], v[60:63], v[64:79]
    v_mfma_f32_32x32x16_bf16 v[80:95], v[56:59], v[60:63], v[80:95]
    s_cmp_lt_u32 s32, 4
    s_cbranch_scc1 CE_wb_6
    s_waitcnt vmcnt(8)
    s_branch CE_xb_6
CE_wb_6:
    s_waitcnt vmcnt(0)
CE_xb_6:
    s_barrier
    ds_read_b128 v[40:43], v12 offset:0
    ds_read_b128 v[44:47], v12 offset:4096
    ds_read_b128 v[48:51], v24
    ds_read_b128 v[52:55], v13 offset:0
    ds_read_b128 v[56:59], v13 offset:4096
    ds_read_b128 v[60:63], v25
    s_waitcnt lgkmcnt(3)
    v_mfma_f32_32x32x16_bf16 v[64:79], v[40:43], v[48:51], v[64:79]
    v_mfma_f32_32x32x16_bf16 v[80:95], v[44:47], v[48:51], v[80:95]
    ds_read_b128 v[40:43], v14 offset:0
    ds_read_b128 v[44:47], v14 offset:4096
    ds_read_b128 v[48:51], v26
    s_waitcnt lgkmcnt(3)
    v_mfma_f32_32x32x16_bf16 v[64:79], v[52:55], v[60:63], v[64:79]
    v_mfma_f32_32x32x16_bf16 v[80:95], v[56:59], v[60:63], v[80:95]
    ds_read_b128 v[52:55], v15 offset:0
    ds_read_b128 v[56:59], v15 offset:4096
    ds_read_b128 v[60:63], v27
    s_waitcnt lgkmcnt(3)
    v_mfma_f32_32x32x16_bf16 v[64:79], v[40:43], v[48:51], v[64:79]
    v_mfma_f32_32x32x16_bf16 v[80:95], v[44:47], v[48:51], v[80:95]
    s_waitcnt lgkmcnt(0)
    v_mfma_f32_32x32x16_bf16 v[64:79], v[52:55], v[60:63], v[64:79]
    v_mfma_f32_32x32x16_bf16 v[80:95], v[56:59], v[60:63], v[80:95]
    s_nop 15
    v_cvt_pk_bf16_f32 v40, v64, v65
    v_cvt_pk_bf16_f32 v41, v66, v67
    v_cvt_pk_bf16_f32 v42, v68, v69
    v_cvt_pk_bf16_f32 v43, v70, v71
    v_cvt_pk_bf16_f32 v44, v72, v73
    v_cvt_pk_bf16_f32 v45, v74, v75
    v_cvt_pk_bf16_f32 v46, v76, v77
    v_cvt_pk_bf16_f32 v47, v78, v79
    buffer_store_dwordx2 v[40:41], v36, s[28:31], s84 offen offset:0 sc0 sc1
    buffer_store_dwordx2 v[42:43], v36, s[28:31], s84 offen offset:256 sc0 sc1
    buffer_store_dwordx2 v[44:45], v36, s[28:31], s84 offen offset:512 sc0 sc1
    buffer_store_dwordx2 v[46:47], v36, s[28:31], s84 offen offset:768 sc0 sc1
    v_cvt_pk_bf16_f32 v48, v80, v81
    v_cvt_pk_bf16_f32 v49, v82, v83
    v_cvt_pk_bf16_f32 v50, v84, v85
    v_cvt_pk_bf16_f32 v51, v86, v87
    v_cvt_pk_bf16_f32 v52, v88, v89
    v_cvt_pk_bf16_f32 v53, v90, v91
    v_cvt_pk_bf16_f32 v54, v92, v93
    v_cvt_pk_bf16_f32 v55, v94, v95
    buffer_store_dwordx2 v[48:49], v36, s[28:31], s84 offen offset:1024 sc0 sc1
    buffer_store_dwordx2 v[50:51], v36, s[28:31], s84 offen offset:1280 sc0 sc1
    buffer_store_dwordx2 v[52:53], v36, s[28:31], s84 offen offset:1536 sc0 sc1
    buffer_store_dwordx2 v[54:55], v36, s[28:31], s84 offen offset:1792 sc0 sc1
    s_cmp_lg_u32 s67, 1
    s_cbranch_scc1 K1_done
    v_lshrrev_b32 v2, 5, v1
    v_lshlrev_b32 v2, 9, v2
    v_bfe_u32 v3, v1, 2, 2
    v_lshlrev_b32 v3, 6, v3
    v_add_u32 v2, v2, v3
    v_bfe_u32 v3, v1, 4, 1
    v_lshlrev_b32 v3, 5, v3
    v_add_u32 v2, v2, v3
    v_and_b32 v3, 3, v1
    v_lshlrev_b32 v3, 3, v3
    v_add_u32 v21, v2, v3
    v_lshrrev_b32 v2, 5, v1
    v_lshlrev_b32 v2, 8, v2
    v_sub_u32 v21, v21, v2
    v_add_u32 v21, 32768, v21
    v_lshlrev_b32 v2, 4, v1
    s_lshl_b32 s37, s66, 13
    s_add_u32 s37, s37, 12582912
    v_cmp_gt_u32 vcc, 32, v1
    ds_read_b64_tr_b16 v[64:65], v21 offset:0
    ds_read_b64_tr_b16 v[66:67], v21 offset:512
    ds_read_b64_tr_b16 v[68:69], v21 offset:1024
    ds_read_b64_tr_b16 v[70:71], v21 offset:1536
    ds_read_b64_tr_b16 v[72:73], v21 offset:1792
    ds_read_b64_tr_b16 v[74:75], v21 offset:2304
    ds_read_b64_tr_b16 v[76:77], v21 offset:2816
    ds_read_b64_tr_b16 v[78:79], v21 offset:3328
    ds_read_b64_tr_b16 v[80:81], v21 offset:3584
    ds_read_b64_tr_b16 v[82:83], v21 offset:4096
    ds_read_b64_tr_b16 v[84:85], v21 offset:4608
    ds_read_b64_tr_b16 v[86:87], v21 offset:5120
    ds_read_b64_tr_b16 v[88:89], v21 offset:5376
    ds_read_b64_tr_b16 v[90:91], v21 offset:5888
    ds_read_b64_tr_b16 v[92:93], v21 offset:6400
    ds_read_b64_tr_b16 v[94:95], v21 offset:6912
    s_waitcnt lgkmcnt(0)
    v_cndmask_b32 v70, 0, v70, vcc
    v_cndmask_b32 v71, 0, v71, vcc
    v_cndmask_b32 v78, 0, v78, vcc
    v_cndmask_b32 v79, 0, v79, vcc
    v_cndmask_b32 v86, 0, v86, vcc
    v_cndmask_b32 v87, 0, v87, vcc
    v_cndmask_b32 v94, 0, v94, vcc
    v_cndmask_b32 v95, 0, v95, vcc
    buffer_store_dwordx4 v[64:67], v2, s[28:31], s37 offen sc0 sc1
    s_add_u32 s37, s37, 1024
    buffer_store_dwordx4 v[68:71], v2, s[28:31], s37 offen sc0 sc1
    s_add_u32 s37, s37, 1024
    buffer_store_dwordx4 v[72:75], v2, s[28:31], s37 offen sc0 sc1
    s_add_u32 s37, s37, 1024
    buffer_store_dwordx4 v[76:79], v2, s[28:31], s37 offen sc0 sc1
    s_add_u32 s37, s37, 1024
    buffer_store_dwordx4 v[80:83], v2, s[28:31], s37 offen sc0 sc1
    s_add_u32 s37, s37, 1024
    buffer_store_dwordx4 v[84:87], v2, s[28:31], s37 offen sc0 sc1
    s_add_u32 s37, s37, 1024
    buffer_store_dwordx4 v[88:91], v2, s[28:31], s37 offen sc0 sc1
    s_add_u32 s37, s37, 1024
    buffer_store_dwordx4 v[92:95], v2, s[28:31], s37 offen sc0 sc1
    s_add_u32 s37, s37, 1024
    s_branch K1_done
K1_done:
k2_main_part:
    s_load_dwordx4 s[4:7], s[0:1], 32
    s_load_dwordx2 s[16:17], s[0:1], 80
    s_load_dwordx2 s[14:15], s[0:1], 64
    v_lshrrev_b32 v2, 6, v0
    v_and_b32 v1, 63, v0
    s_nop 0
    v_readfirstlane_b32 s32, v2
    s_mov_b32 s55, 0
    v_lshlrev_b32 v2, 2, v1
    v_add_u32 v2, 155648, v2
    v_mov_b32 v3, 0
    s_mov_b32 exec_hi, 0
    ds_write_b32 v2, v3
    s_mov_b64 exec, -1
    s_waitcnt lgkmcnt(0)
    s_mov_b32 s28, s16
    s_and_b32 s29, s17, 0xffff
    s_mov_b32 s30, 33554432
    s_mov_b32 s31, 0x00020000
    s_mov_b32 s24, s14
    s_and_b32 s25, s15, 0xffff
    s_mov_b32 s26, 3670016
    s_mov_b32 s27, 0x00020000
    s_mov_b32 s8, s18
    s_and_b32 s9, s19, 0xffff
    s_mov_b32 s10, 256
    s_mov_b32 s11, 0x00020000
    s_and_b32 s47, s2, 7
    s_mul_i32 s47, s47, 18
    s_lshr_b32 s48, s2, 3
    s_add_u32 s47, s47, s48
    s_cmp_lt_u32 s2, 144
    s_cselect_b32 s47, s47, s2
    s_lshl_b32 s47, s47, 7
    s_and_b32 s49, s98, 7
    s_mul_i32 s49, s49, 18
    s_lshr_b32 s48, s98, 3
    s_add_u32 s49, s49, s48
    s_cmp_lt_u32 s98, 144
    s_cselect_b32 s49, s49, s98
    s_lshl_b32 s49, s49, 7
    v_mov_b32 v255, s49
    v_writelane_b32 v255, s47, 1
    s_mov_b32 s2, s98
    s_cmp_lg_u32 s32, 0
    s_cbranch_scc1 M_nz
    v_lshlrev_b32 v2, 2, v1
    buffer_load_dword v254, v2, s[8:11], 0 offen sc0 sc1
M_nz:
    s_waitcnt vmcnt(0)
    s_barrier
    s_cmp_ge_u32 s32, 4
    s_cbranch_scc1 K2_gemm
    s_and_b32 s37, s2, 7
    s_lshr_b32 s38, s2, 3
    s_lshl_b32 s33, s37, 1
    s_lshr_b32 s39, s38, 4
    s_add_u32 s33, s33, s39
    s_and_b32 s34, s38, 15
    s_lshr_b32 s35, s32, 1
    s_and_b32 s36, s32, 1
    v_lshlrev_b32 v10, 4, v1
    s_lshl_b32 s40, s33, 6
    s_lshl_b32 s41, s34, 2
    s_add_u32 s41, s41, s40
    s_lshl_b32 s41, s41, 11
    s_add_u32 s41, s41, 0
    s_add_u32 s45, s41, 4096
    s_lshl_b32 s50, s32, 4
    s_add_u32 s50, s50, s40
    s_lshl_b32 s50, s50, 11
    s_add_u32 s51, s50, 4194304
    s_add_u32 s50, s50, 2097152
    v_cmp_le_u32 s[62:63], 32, v1
    s_mov_b32 s52, 0
    s_mov_b32 s53, 1266679808
    s_cmp_lg_u32 s32, 0
    s_cbranch_scc1 M_go
M_zchk:
    v_cmp_ne_u32 vcc, 3, v254
    s_mov_b32 s47, 32505856
    s_cmp_eq_u64 vcc, 0
    s_cbranch_scc1 M_pub
    v_cmp_eq_u32 vcc, 0, v254
    s_add_u32 s99, s99, 1
    s_cmp_lt_u32 s99, 400
    s_cbranch_scc1 M_zagain
    s_cmp_eq_u64 vcc, 0
    s_cbranch_scc1 M_zagain
    s_ff1_i32_b64 s48, vcc
    s_add_u32 s48, s48, 193
    s_branch M_ask
M_zagain:
    s_sleep 2
    v_lshlrev_b32 v2, 2, v1
    buffer_load_dword v254, v2, s[8:11], 0 offen sc0 sc1
    s_waitcnt vmcnt(0)
    s_branch M_zchk
M_pub:
    v_mov_b32 v3, 1
    s_mov_b64 exec, 3
    buffer_store_dword v3, v255, s[28:31], s47 offen sc0 sc1
    s_mov_b64 exec, -1
    s_and_b32 s47, s2, 7
    s_lshl_b32 s47, s47, 1
    s_lshr_b32 s48, s2, 7
    s_add_u32 s47, s47, s48
    s_cmp_ge_u32 s47, 5
    s_cselect_b32 s48, 1, 0
    s_cmp_ge_u32 s47, 11
    s_addc_u32 s48, s48, 0
    v_add_u32 v4, 16, v1
    v_mul_u32_u24 v4, 3, v4
    v_add_u32 v4, s48, v4
    s_bfe_u32 s49, s2, 0x40003
    s_mul_i32 s49, s49, 3
    s_add_u32 s49, s49, s48
    v_mov_b32 v6, s49
    s_andn2_b32 s47, s47, 3
    v_bfe_u32 v5, v1, 2, 2
    v_add_u32 v5, s47, v5
    v_min_u32 v5, 13, v5
    v_lshlrev_b32 v5, 2, v5
    v_and_b32 v7, 3, v1
    v_add_u32 v7, v7, v5
    v_add_u32 v7, 0x90, v7
    s_bfe_u32 s47, s2, 0x10001
    s_mul_i32 s47, s47, 448
    s_bfe_u32 s48, s2, 0x20003
    s_mul_i32 s48, s48, 112
    s_add_u32 s47, s47, s48
    s_add_u32 s48, s47, 111
    s_lshr_b32 s47, s47, 7
    s_lshr_b32 s48, s48, 7
    v_mov_b32 v8, s47
    v_mov_b32 v5, s48
    v_cmp_le_u32 vcc, 40, v1
    v_cndmask_b32 v8, v8, v5, vcc
    v_lshlrev_b32 v8, 4, v8
    v_and_b32 v5, 1, v1
    v_lshlrev_b32 v5, 3, v5
    v_bfe_u32 v9, v1, 1, 2
    s_and_b32 s47, s2, 1
    s_lshl_b32 s47, s47, 2
    s_add_u32 s47, s47, 144
    v_add3_u32 v8, v8, v5, v9
    v_add_u32 v8, s47, v8
    v_cmp_le_u32 vcc, 32, v1
    v_cndmask_b32 v4, v4, v8, vcc
    v_cmp_le_u32 vcc, 48, v1
    v_cndmask_b32 v4, v4, v7, vcc
    v_lshlrev_b32 v7, 7, v4
    v_lshlrev_b32 v8, 7, v6
    s_mov_b32 s47, 32505856
    s_mov_b64 s[100:101], -1
M_poll:
    s_mov_b64 exec, s[100:101]
    buffer_load_dword v3, v7, s[28:31], s47 offen sc0 sc1
    s_mov_b64 exec, 1
    buffer_load_dword v5, v8, s[28:31], s47 offen sc0 sc1
    s_mov_b64 exec, -1
    s_add_u32 s99, s99, 1
    s_waitcnt vmcnt(0)
    v_readfirstlane_b32 s48, v5
    v_cmp_ne_u32 vcc, 1, v3
    s_or_b64 s[100:101], vcc, 1
    s_xor_b32 s48, s48, 1
    s_or_b32 s49, s48, vcc_lo
    s_or_b32 s49, s49, vcc_hi
    s_cbranch_scc0 M_go
    s_cmp_ge_u32 s99, 400
    s_cbranch_scc1 M_miss
    s_sleep 2
    s_branch M_poll
M_miss:
    v_readfirstlane_b32 s49, v6
    s_cmp_lg_u32 s48, 0
    s_cbranch_scc1 M_inv
    s_ff1_i32_b64 s48, vcc
    s_nop 3
    v_readlane_b32 s49, v4, s48
M_inv:
    s_mul_i32 s48, s49, 57
    s_lshr_b32 s48, s48, 10
    s_mul_i32 s47, s48, 18
    s_sub_u32 s47, s49, s47
    s_lshl_b32 s47, s47, 3
    s_add_u32 s48, s48, s47
    s_cmp_lt_u32 s49, 144
    s_cselect_b32 s48, s48, s49
    s_add_u32 s48, s48, 1
M_ask:
    v_mov_b32 v2, 155768
    v_mov_b32 v3, s48
    ds_write_b32 v2, v3
    s_waitcnt lgkmcnt(0)
M_go:
    s_barrier
    v_mov_b32 v2, 155768
    ds_read_b32 v9, v2
    s_waitcnt lgkmcnt(0)
    v_readfirstlane_b32 s48, v9
    s_cmp_lg_u32 s48, 0
    s_cbranch_scc1 M_help
    s_branch M_cont
M_help:
    s_sub_u32 s2, s48, 1
    s_setprio 0
    s_waitcnt vmcnt(0)
    s_barrier
    s_branch K1_item
M_cont:
    buffer_load_dwordx4 v[16:19], v10, s[28:31], s41 offen offset:0
    buffer_load_dwordx4 v[20:23], v10, s[28:31], s41 offen offset:1024
    buffer_load_dwordx4 v[24:27], v10, s[28:31], s41 offen offset:2048
    buffer_load_dwordx4 v[28:31], v10, s[28:31], s41 offen offset:3072
    buffer_load_dwordx4 v[32:35], v10, s[28:31], s45 offen offset:0
    buffer_load_dwordx4 v[36:39], v10, s[28:31], s45 offen offset:1024
    buffer_load_dwordx4 v[40:43], v10, s[28:31], s45 offen offset:2048
    buffer_load_dwordx4 v[44:47], v10, s[28:31], s45 offen offset:3072
K2A_restart:
    s_mov_b32 s42, s50
    s_mov_b32 s43, s51
    buffer_load_dwordx4 v[48:51], v10, s[28:31], s42 offen
    buffer_load_dwordx4 v[52:55], v10, s[28:31], s42 offen offset:1024
    s_add_u32 s42, s42, 2048
    buffer_load_dwordx4 v[56:59], v10, s[28:31], s42 offen
    buffer_load_dwordx4 v[60:63], v10, s[28:31], s42 offen offset:1024
    s_add_u32 s42, s42, 2048
    buffer_load_dwordx4 v[64:67], v10, s[28:31], s43 offen
    buffer_load_dwordx4 v[68:71], v10, s[28:31], s43 offen offset:1024
    s_add_u32 s43, s43, 2048
    v_mov_b32 v176, 0
    v_mov_b32 v177, 0
    v_mov_b32 v178, 0
    v_mov_b32 v179, 0
    v_mov_b32 v180, 0
    v_mov_b32 v181, 0
    v_mov_b32 v182, 0
    v_mov_b32 v183, 0
    v_mov_b32 v184, 0
    v_mov_b32 v185, 0
    v_mov_b32 v186, 0
    v_mov_b32 v187, 0
    v_mov_b32 v188, 0
    v_mov_b32 v189, 0
    v_mov_b32 v190, 0
    v_mov_b32 v191, 0
    v_mov_b32 v192, 0
    v_mov_b32 v193, 0
    v_mov_b32 v194, 0
    v_mov_b32 v195, 0
    v_mov_b32 v196, 0
    v_mov_b32 v197, 0
    v_mov_b32 v198, 0
    v_mov_b32 v199, 0
    v_mov_b32 v200, 0
    v_mov_b32 v201, 0
    v_mov_b32 v202, 0
    v_mov_b32 v203, 0
    v_mov_b32 v204, 0
    v_mov_b32 v205, 0
    v_mov_b32 v206, 0
    v_mov_b32 v207, 0
    v_mov_b32 v208, 0
    v_mov_b32 v209, 0
    v_mov_b32 v210, 0
    v_mov_b32 v211, 0
    v_mov_b32 v212, 0
    v_mov_b32 v213, 0
    v_mov_b32 v214, 0
    v_mov_b32 v215, 0
    v_mov_b32 v216, 0
    v_mov_b32 v217, 0
    v_mov_b32 v218, 0
    v_mov_b32 v219, 0
    v_mov_b32 v220, 0
    v_mov_b32 v221, 0
    v_mov_b32 v222, 0
    v_mov_b32 v223, 0
    v_mov_b32 v224, 0
    v_mov_b32 v225, 0
    v_mov_b32 v226, 0
    v_mov_b32 v227, 0
    v_mov_b32 v228, 0
    v_mov_b32 v229, 0
    v_mov_b32 v230, 0
    v_mov_b32 v231, 0
    v_mov_b32 v232, 0
    v_mov_b32 v233, 0
    v_mov_b32 v234, 0
    v_mov_b32 v235, 0
    v_mov_b32 v236, 0
    v_mov_b32 v237, 0
    v_mov_b32 v238, 0
    v_mov_b32 v239, 0
    v_mov_b32 v160, 0
    v_mov_b32 v161, 0
    v_mov_b32 v162, 0
    v_mov_b32 v163, 0
    v_mov_b32 v164, 0
    v_mov_b32 v165, 0
    v_mov_b32 v166, 0
    v_mov_b32 v167, 0
    v_mov_b32 v168, 0
    v_mov_b32 v169, 0
    v_mov_b32 v170, 0
    v_mov_b32 v171, 0
    v_mov_b32 v172, 0
    v_mov_b32 v173, 0
    v_mov_b32 v174, 0
    v_mov_b32 v175, 0
    v_mov_b32 v72, 0
    v_mov_b32 v73, 0
    v_mov_b32 v74, 0
    v_mov_b32 v75, 0
    v_mov_b32 v76, 0
    v_mov_b32 v77, 0
    v_mov_b32 v78, 0
    v_mov_b32 v79, 0
    v_mov_b32 v244, 0
    v_mov_b32 v245, 0
    v_mov_b32 v246, 0
    v_mov_b32 v247, 0
    s_waitcnt vmcnt(4)
    v_mfma_f32_32x32x16_bf16 v[80:95], v[48:51], v[16:19], 0
    v_mfma_f32_32x32x16_bf16 v[80:95], v[52:55], v[20:23], v[80:95]
    v_mfma_f32_32x32x16_bf16 v[96:111], v[48:51], v[24:27], 0
    v_mfma_f32_32x32x16_bf16 v[96:111], v[52:55], v[28:31], v[96:111]
    s_cmp_lg_u32 s52, 0
    s_cbranch_scc1 K2A_havemax
    v_mfma_f32_32x32x16_bf16 v[112:127], v[48:51], v[32:35], 0
    v_mfma_f32_32x32x16_bf16 v[112:127], v[52:55], v[36:39], v[112:127]
    v_mfma_f32_32x32x16_bf16 v[128:143], v[48:51], v[40:43], 0
    v_mfma_f32_32x32x16_bf16 v[128:143], v[52:55], v[44:47], v[128:143]
    s_nop 3
    v_max3_f32 v11, v80, v81, v82
    v_max3_f32 v11, v11, v83, v84
    v_max3_f32 v11, v11, v85, v86
    v_max3_f32 v11, v11, v87, v88
    v_max3_f32 v11, v11, v89, v90
    v_max3_f32 v11, v11, v91, v92
    v_max3_f32 v11, v11, v93, v94
    v_max_f32 v11, v11, v95
    v_mov_b32 v2, v11
    s_nop 1
    v_permlane32_swap_b32 v11, v2
    s_nop 1
    v_max_f32 v11, v11, v2
    v_add_f32 v11, 64.0, v11
    v_sub_f32 v80, v80, v11
    v_sub_f32 v81, v81, v11
    v_sub_f32 v82, v82, v11
    v_sub_f32 v83, v83, v11
    v_sub_f32 v84, v84, v11
    v_sub_f32 v85, v85, v11
    v_sub_f32 v86, v86, v11
    v_sub_f32 v87, v87, v11
    v_sub_f32 v88, v88, v11
    v_sub_f32 v89, v89, v11
    v_sub_f32 v90, v90, v11
    v_sub_f32 v91, v91, v11
    v_sub_f32 v92, v92, v11
    v_sub_f32 v93, v93, v11
    v_sub_f32 v94, v94, v11
    v_sub_f32 v95, v95, v11
    v_sub_f32 v2, 0, v11
    v_cvt_pk_bf16_f32 v3, 0, v2
    v_sub_f32 v2, v2, v3
    v_cvt_pk_bf16_f32 v4, 0, v2
    v_sub_f32 v2, v2, v4
    v_cvt_pk_bf16_f32 v5, v2, 0
    v_lshrrev_b32 v3, 16, v3
    v_or_b32 v3, v3, v4
    v_cndmask_b32 v22, v22, v3, s[62:63]
    v_cndmask_b32 v23, v23, v5, s[62:63]
    v_max3_f32 v12, v96, v97, v98
    v_max3_f32 v12, v12, v99, v100
    v_max3_f32 v12, v12, v101, v102
    v_max3_f32 v12, v12, v103, v104
    v_max3_f32 v12, v12, v105, v106
    v_max3_f32 v12, v12, v107, v108
    v_max3_f32 v12, v12, v109, v110
    v_max_f32 v12, v12, v111
    v_mov_b32 v2, v12
    s_nop 1
    v_permlane32_swap_b32 v12, v2
    s_nop 1
    v_max_f32 v12, v12, v2
    v_add_f32 v12, 64.0, v12
    v_sub_f32 v96, v96, v12
    v_sub_f32 v97, v97, v12
    v_sub_f32 v98, v98, v12
    v_sub_f32 v99, v99, v12
    v_sub_f32 v100, v100, v12
    v_sub_f32 v101, v101, v12
    v_sub_f32 v102, v102, v12
    v_sub_f32 v103, v103, v12
    v_sub_f32 v104, v104, v12
    v_sub_f32 v105, v105, v12
    v_sub_f32 v106, v106, v12
    v_sub_f32 v107, v107, v12
    v_sub_f32 v108, v108, v12
    v_sub_f32 v109, v109, v12
    v_sub_f32 v110, v110, v12
    v_sub_f32 v111, v111, v12
    v_sub_f32 v2, 0, v12
    v_cvt_pk_bf16_f32 v3, 0, v2
    v_sub_f32 v2, v2, v3
    v_cvt_pk_bf16_f32 v4, 0, v2
    v_sub_f32 v2, v2, v4
    v_cvt_pk_bf16_f32 v5, v2, 0
    v_lshrrev_b32 v3, 16, v3
    v_or_b32 v3, v3, v4
    v_cndmask_b32 v30, v30, v3, s[62:63]
    v_cndmask_b32 v31, v31, v5, s[62:63]
    v_max3_f32 v13, v112, v113, v114
    v_max3_f32 v13, v13, v115, v116
    v_max3_f32 v13, v13, v117, v118
    v_max3_f32 v13, v13, v119, v120
    v_max3_f32 v13, v13, v121, v122
    v_max3_f32 v13, v13, v123, v124
    v_max3_f32 v13, v13, v125, v126
    v_max_f32 v13, v13, v127
    v_mov_b32 v2, v13
    s_nop 1
    v_permlane32_swap_b32 v13, v2
    s_nop 1
    v_max_f32 v13, v13, v2
    v_add_f32 v13, 64.0, v13
    v_sub_f32 v2, 0, v13
    v_cvt_pk_bf16_f32 v3, 0, v2
    v_sub_f32 v2, v2, v3
    v_cvt_pk_bf16_f32 v4, 0, v2
    v_sub_f32 v2, v2, v4
    v_cvt_pk_bf16_f32 v5, v2, 0
    v_lshrrev_b32 v3, 16, v3
    v_or_b32 v3, v3, v4
    v_cndmask_b32 v38, v38, v3, s[62:63]
    v_cndmask_b32 v39, v39, v5, s[62:63]
    v_max3_f32 v14, v128, v129, v130
    v_max3_f32 v14, v14, v131, v132
    v_max3_f32 v14, v14, v133, v134
    v_max3_f32 v14, v14, v135, v136
    v_max3_f32 v14, v14, v137, v138
    v_max3_f32 v14, v14, v139, v140
    v_max3_f32 v14, v14, v141, v142
    v_max_f32 v14, v14, v143
    v_mov_b32 v2, v14
    s_nop 1
    v_permlane32_swap_b32 v14, v2
    s_nop 1
    v_max_f32 v14, v14, v2
    v_add_f32 v14, 64.0, v14
    v_sub_f32 v2, 0, v14
    v_cvt_pk_bf16_f32 v3, 0, v2
    v_sub_f32 v2, v2, v3
    v_cvt_pk_bf16_f32 v4, 0, v2
    v_sub_f32 v2, v2, v4
    v_cvt_pk_bf16_f32 v5, v2, 0
    v_lshrrev_b32 v3, 16, v3
    v_or_b32 v3, v3, v4
    v_cndmask_b32 v46, v46, v3, s[62:63]
    v_cndmask_b32 v47, v47, v5, s[62:63]
K2A_havemax:
    s_nop 15
    s_mov_b32 s44, 8
    s_nop 1
K2A_loop:
    v_mfma_f32_32x32x16_bf16 v[112:127], v[48:51], v[32:35], 0
    v_exp_f32 v240, v80
    v_exp_f32 v241, v81
    v_exp_f32 v242, v82
    v_exp_f32 v243, v83
    v_cvt_pk_bf16_f32 v174, v244, v245
    v_cvt_pk_bf16_f32 v175, v246, v247
    v_mfma_f32_32x32x16_bf16 v[112:127], v[52:55], v[36:39], v[112:127]
    v_exp_f32 v244, v84
    v_exp_f32 v245, v85
    v_exp_f32 v246, v86
    v_exp_f32 v247, v87
    v_cvt_pk_bf16_f32 v144, v240, v241
    v_cvt_pk_bf16_f32 v145, v242, v243
    v_mfma_f32_32x32x16_bf16 v[128:143], v[48:51], v[40:43], 0
    v_exp_f32 v240, v88
    v_exp_f32 v241, v89
    v_exp_f32 v242, v90
    v_exp_f32 v243, v91
    v_cvt_pk_bf16_f32 v146, v244, v245
    v_cvt_pk_bf16_f32 v147, v246, v247
    v_mfma_f32_32x32x16_bf16 v[128:143], v[52:55], v[44:47], v[128:143]
    buffer_load_dwordx4 v[48:51], v10, s[28:31], s42 offen
    buffer_load_dwordx4 v[52:55], v10, s[28:31], s42 offen offset:1024
    s_add_u32 s42, s42, 2048
    v_exp_f32 v244, v92
    v_exp_f32 v245, v93
    v_exp_f32 v246, v94
    v_exp_f32 v247, v95
    v_cvt_pk_bf16_f32 v148, v240, v241
    v_cvt_pk_bf16_f32 v149, v242, v243
    v_mfma_f32_32x32x16_bf16 v[208:223], v[72:75], v[160:163], v[208:223]
    v_exp_f32 v240, v96
    v_exp_f32 v241, v97
    v_exp_f32 v242, v98
    v_exp_f32 v243, v99
    v_cvt_pk_bf16_f32 v150, v244, v245
    v_cvt_pk_bf16_f32 v151, v246, v247
    v_mfma_f32_32x32x16_bf16 v[208:223], v[76:79], v[164:167], v[208:223]
    v_exp_f32 v244, v100
    v_exp_f32 v245, v101
    v_exp_f32 v246, v102
    v_exp_f32 v247, v103
    v_cvt_pk_bf16_f32 v152, v240, v241
    v_cvt_pk_bf16_f32 v153, v242, v243
    v_mfma_f32_32x32x16_bf16 v[224:239], v[72:75], v[168:171], v[224:239]
    v_exp_f32 v240, v104
    v_exp_f32 v241, v105
    v_exp_f32 v242, v106
    v_exp_f32 v243, v107
    v_cvt_pk_bf16_f32 v154, v244, v245
    v_cvt_pk_bf16_f32 v155, v246, v247
    v_mfma_f32_32x32x16_bf16 v[224:239], v[76:79], v[172:175], v[224:239]
    buffer_load_dwordx4 v[72:75], v10, s[28:31], s43 offen
    buffer_load_dwordx4 v[76:79], v10, s[28:31], s43 offen offset:1024
    s_add_u32 s43, s43, 2048
    v_exp_f32 v244, v108
    v_exp_f32 v245, v109
    v_exp_f32 v246, v110
    v_exp_f32 v247, v111
    v_cvt_pk_bf16_f32 v156, v240, v241
    v_cvt_pk_bf16_f32 v157, v242, v243
    s_waitcnt vmcnt(6)
    v_mfma_f32_32x32x16_bf16 v[80:95], v[56:59], v[16:19], 0
    v_exp_f32 v240, v112
    v_exp_f32 v241, v113
    v_exp_f32 v242, v114
    v_exp_f32 v243, v115
    v_cvt_pk_bf16_f32 v158, v244, v245
    v_cvt_pk_bf16_f32 v159, v246, v247
    v_mfma_f32_32x32x16_bf16 v[80:95], v[60:63], v[20:23], v[80:95]
    v_exp_f32 v244, v116
    v_exp_f32 v245, v117
    v_exp_f32 v246, v118
    v_exp_f32 v247, v119
    v_cvt_pk_bf16_f32 v160, v240, v241
    v_cvt_pk_bf16_f32 v161, v242, v243
    v_mfma_f32_32x32x16_bf16 v[96:111], v[56:59], v[24:27], 0
    v_exp_f32 v240, v120
    v_exp_f32 v241, v121
    v_exp_f32 v242, v122
    v_exp_f32 v243, v123
    v_cvt_pk_bf16_f32 v162, v244, v245
    v_cvt_pk_bf16_f32 v163, v246, v247
    v_mfma_f32_32x32x16_bf16 v[96:111], v[60:63], v[28:31], v[96:111]
    v_exp_f32 v244, v124
    v_exp_f32 v245, v125
    v_exp_f32 v246, v126
    v_exp_f32 v247, v127
    v_cvt_pk_bf16_f32 v164, v240, v241
    v_cvt_pk_bf16_f32 v165, v242, v243
    s_waitcnt vmcnt(4)
    v_mfma_f32_32x32x16_bf16 v[176:191], v[64:67], v[144:147], v[176:191]
    v_exp_f32 v240, v128
    v_exp_f32 v241, v129
    v_exp_f32 v242, v130
    v_exp_f32 v243, v131
    v_cvt_pk_bf16_f32 v166, v244, v245
    v_cvt_pk_bf16_f32 v167, v246, v247
    v_mfma_f32_32x32x16_bf16 v[176:191], v[68:71], v[148:151], v[176:191]
    v_exp_f32 v244, v132
    v_exp_f32 v245, v133
    v_exp_f32 v246, v134
    v_exp_f32 v247, v135
    v_cvt_pk_bf16_f32 v168, v240, v241
    v_cvt_pk_bf16_f32 v169, v242, v243
    v_mfma_f32_32x32x16_bf16 v[192:207], v[64:67], v[152:155], v[192:207]
    v_exp_f32 v240, v136
    v_exp_f32 v241, v137
    v_exp_f32 v242, v138
    v_exp_f32 v243, v139
    v_cvt_pk_bf16_f32 v170, v244, v245
    v_cvt_pk_bf16_f32 v171, v246, v247
    v_mfma_f32_32x32x16_bf16 v[192:207], v[68:71], v[156:159], v[192:207]
    v_exp_f32 v244, v140
    v_exp_f32 v245, v141
    v_exp_f32 v246, v142
    v_exp_f32 v247, v143
    v_cvt_pk_bf16_f32 v172, v240, v241
    v_cvt_pk_bf16_f32 v173, v242, v243
    v_mfma_f32_32x32x16_bf16 v[112:127], v[56:59], v[32:35], 0
    v_exp_f32 v240, v80
    v_exp_f32 v241, v81
    v_exp_f32 v242, v82
    v_exp_f32 v243, v83
    v_cvt_pk_bf16_f32 v174, v244, v245
    v_cvt_pk_bf16_f32 v175, v246, v247
    v_mfma_f32_32x32x16_bf16 v[112:127], v[60:63], v[36:39], v[112:127]
    v_exp_f32 v244, v84
    v_exp_f32 v245, v85
    v_exp_f32 v246, v86
    v_exp_f32 v247, v87
    v_cvt_pk_bf16_f32 v144, v240, v241
    v_cvt_pk_bf16_f32 v145, v242, v243
    v_mfma_f32_32x32x16_bf16 v[128:143], v[56:59], v[40:43], 0
    v_exp_f32 v240, v88
    v_exp_f32 v241, v89
    v_exp_f32 v242, v90
    v_exp_f32 v243, v91
    v_cvt_pk_bf16_f32 v146, v244, v245
    v_cvt_pk_bf16_f32 v147, v246, v247
    v_mfma_f32_32x32x16_bf16 v[128:143], v[60:63], v[44:47], v[128:143]
    buffer_load_dwordx4 v[56:59], v10, s[28:31], s42 offen
    buffer_load_dwordx4 v[60:63], v10, s[28:31], s42 offen offset:1024
    s_add_u32 s42, s42, 2048
    v_exp_f32 v244, v92
    v_exp_f32 v245, v93
    v_exp_f32 v246, v94
    v_exp_f32 v247, v95
    v_cvt_pk_bf16_f32 v148, v240, v241
    v_cvt_pk_bf16_f32 v149, v242, v243
    v_mfma_f32_32x32x16_bf16 v[208:223], v[64:67], v[160:163], v[208:223]
    v_exp_f32 v240, v96
    v_exp_f32 v241, v97
    v_exp_f32 v242, v98
    v_exp_f32 v243, v99
    v_cvt_pk_bf16_f32 v150, v244, v245
    v_cvt_pk_bf16_f32 v151, v246, v247
    v_mfma_f32_32x32x16_bf16 v[208:223], v[68:71], v[164:167], v[208:223]
    v_exp_f32 v244, v100
    v_exp_f32 v245, v101
    v_exp_f32 v246, v102
    v_exp_f32 v247, v103
    v_cvt_pk_bf16_f32 v152, v240, v241
    v_cvt_pk_bf16_f32 v153, v242, v243
    v_mfma_f32_32x32x16_bf16 v[224:239], v[64:67], v[168:171], v[224:239]
    v_exp_f32 v240, v104
    v_exp_f32 v241, v105
    v_exp_f32 v242, v106
    v_exp_f32 v243, v107
    v_cvt_pk_bf16_f32 v154, v244, v245
    v_cvt_pk_bf16_f32 v155, v246, v247
    v_mfma_f32_32x32x16_bf16 v[224:239], v[68:71], v[172:175], v[224:239]
    buffer_load_dwordx4 v[64:67], v10, s[28:31], s43 offen
    buffer_load_dwordx4 v[68:71], v10, s[28:31], s43 offen offset:1024
    s_add_u32 s43, s43, 2048
    v_exp_f32 v244, v108
    v_exp_f32 v245, v109
    v_exp_f32 v246, v110
    v_exp_f32 v247, v111
    v_cvt_pk_bf16_f32 v156, v240, v241
    v_cvt_pk_bf16_f32 v157, v242, v243
    s_waitcnt vmcnt(6)
    v_mfma_f32_32x32x16_bf16 v[80:95], v[48:51], v[16:19], 0
    v_exp_f32 v240, v112
    v_exp_f32 v241, v113
    v_exp_f32 v242, v114
    v_exp_f32 v243, v115
    v_cvt_pk_bf16_f32 v158, v244, v245
    v_cvt_pk_bf16_f32 v159, v246, v247
    v_mfma_f32_32x32x16_bf16 v[80:95], v[52:55], v[20:23], v[80:95]
    v_exp_f32 v244, v116
    v_exp_f32 v245, v117
    v_exp_f32 v246, v118
    v_exp_f32 v247, v119
    v_cvt_pk_bf16_f32 v160, v240, v241
    v_cvt_pk_bf16_f32 v161, v242, v243
    v_mfma_f32_32x32x16_bf16 v[96:111], v[48:51], v[24:27], 0
    v_exp_f32 v240, v120
    v_exp_f32 v241, v121
    v_exp_f32 v242, v122
    v_exp_f32 v243, v123
    v_cvt_pk_bf16_f32 v162, v244, v245
    v_cvt_pk_bf16_f32 v163, v246, v247
    v_mfma_f32_32x32x16_bf16 v[96:111], v[52:55], v[28:31], v[96:111]
    v_exp_f32 v244, v124
    v_exp_f32 v245, v125
    v_exp_f32 v246, v126
    v_exp_f32 v247, v127
    v_cvt_pk_bf16_f32 v164, v240, v241
    v_cvt_pk_bf16_f32 v165, v242, v243
    s_waitcnt vmcnt(4)
    v_cmp_lt_f32 s[64:65], s53, v188
    v_cmp_lt_f32 s[66:67], s53, v204
    v_cmp_lt_f32 s[68:69], s53, v220
    v_cmp_lt_f32 s[70:71], s53, v236
    v_mfma_f32_32x32x16_bf16 v[176:191], v[72:75], v[144:147], v[176:191]
    v_exp_f32 v240, v128
    v_exp_f32 v241, v129
    v_exp_f32 v242, v130
    v_exp_f32 v243, v131
    v_cvt_pk_bf16_f32 v166, v244, v245
    v_cvt_pk_bf16_f32 v167, v246, v247
    v_mfma_f32_32x32x16_bf16 v[176:191], v[76:79], v[148:151], v[176:191]
    v_exp_f32 v244, v132
    v_exp_f32 v245, v133
    v_exp_f32 v246, v134
    v_exp_f32 v247, v135
    v_cvt_pk_bf16_f32 v168, v240, v241
    v_cvt_pk_bf16_f32 v169, v242, v243
    v_mfma_f32_32x32x16_bf16 v[192:207], v[72:75], v[152:155], v[192:207]
    v_exp_f32 v240, v136
    v_exp_f32 v241, v137
    v_exp_f32 v242, v138
    v_exp_f32 v243, v139
    v_cvt_pk_bf16_f32 v170, v244, v245
    v_cvt_pk_bf16_f32 v171, v246, v247
    v_mfma_f32_32x32x16_bf16 v[192:207], v[76:79], v[156:159], v[192:207]
    v_exp_f32 v244, v140
    v_exp_f32 v245, v141
    v_exp_f32 v246, v142
    v_exp_f32 v247, v143
    v_cvt_pk_bf16_f32 v172, v240, v241
    v_cvt_pk_bf16_f32 v173, v242, v243
    s_or_b64 s[64:65], s[64:65], s[66:67]
    s_or_b64 s[68:69], s[68:69], s[70:71]
    s_or_b64 s[64:65], s[64:65], s[68:69]
    s_and_b64 s[64:65], s[64:65], s[62:63]
    s_cbranch_scc1 K2A_recentre
K2A_back:
    s_sub_u32 s44, s44, 1
    s_cmp_lg_u32 s44, 0
    s_cbranch_scc1 K2A_loop
    v_cvt_pk_bf16_f32 v174, v244, v245
    v_cvt_pk_bf16_f32 v175, v246, v247
    s_setprio 2
    v_mov_b32 v2, 155680
CE_g:
    ds_read_b32 v3, v2
    s_waitcnt lgkmcnt(0)
    v_readfirstlane_b32 s47, v3
    s_cmp_ge_u32 s47, 8
    s_cbranch_scc1 CE_ok
    s_sleep 1
    s_branch CE_g
CE_ok:
    s_nop 1
    v_mfma_f32_32x32x16_bf16 v[208:223], v[72:75], v[160:163], v[208:223]
    v_mfma_f32_32x32x16_bf16 v[208:223], v[76:79], v[164:167], v[208:223]
    v_mfma_f32_32x32x16_bf16 v[224:239], v[72:75], v[168:171], v[224:239]
    v_mfma_f32_32x32x16_bf16 v[224:239], v[76:79], v[172:175], v[224:239]
    s_lshl_b32 s45, s32, 13
    s_add_u32 s45, s45, 122880
    s_xor_b32 s46, s32, 2
    s_lshl_b32 s47, s46, 13
    s_add_u32 s47, s47, 122880
    v_add_u32 v144, s45, v10
    v_add_u32 v145, s47, v10
    v_lshlrev_b32 v4, 2, v1
    s_mul_i32 s45, s32, 768
    s_add_u32 s45, s45, 155776
    s_mul_i32 s47, s46, 768
    s_add_u32 s47, s47, 155776
    v_add_u32 v146, s45, v4
    v_add_u32 v147, s47, v4
    s_lshl_b32 s47, s46, 2
    s_add_u32 s47, s47, 155652
    v_mov_b32 v149, s47
    s_lshl_b32 s47, s32, 2
    s_add_u32 s47, s47, 155652
    v_mov_b32 v148, s47
    s_xor_b32 s46, s32, 1
    s_lshl_b32 s47, s46, 2
    s_add_u32 s47, s47, 155652
    v_mov_b32 v150, s47
    s_xor_b32 s47, s32, 3
    s_lshl_b32 s47, s47, 13
    s_add_u32 s47, s47, 122880
    v_add_u32 v5, s47, v10
    s_mul_i32 s47, s46, 768
    s_add_u32 s47, s47, 155776
    v_add_u32 v15, s47, v4
    v_mov_b32 v151, 1
    v_mov_b32 v8, 0
    v_mov_b32 v9, 0
    v_mov_b32 v2, 0
    v_mov_b32 v3, 0
    s_cmp_lg_u32 s52, 0
    s_cbranch_scc1 K2A_ok
    v_pk_fma_f32 v[2:3], v[176:177], v[8:9], v[2:3]
    v_pk_fma_f32 v[2:3], v[178:179], v[8:9], v[2:3]
    v_pk_fma_f32 v[2:3], v[180:181], v[8:9], v[2:3]
    v_pk_fma_f32 v[2:3], v[182:183], v[8:9], v[2:3]
    v_pk_fma_f32 v[2:3], v[184:185], v[8:9], v[2:3]
    v_pk_fma_f32 v[2:3], v[186:187], v[8:9], v[2:3]
    v_pk_fma_f32 v[2:3], v[188:189], v[8:9], v[2:3]
    v_pk_fma_f32 v[2:3], v[190:191], v[8:9], v[2:3]
    v_pk_fma_f32 v[2:3], v[192:193], v[8:9], v[2:3]
    v_pk_fma_f32 v[2:3], v[194:195], v[8:9], v[2:3]
    v_pk_fma_f32 v[2:3], v[196:197], v[8:9], v[2:3]
    v_pk_fma_f32 v[2:3], v[198:199], v[8:9], v[2:3]
    v_pk_fma_f32 v[2:3], v[200:201], v[8:9], v[2:3]
    v_pk_fma_f32 v[2:3], v[202:203], v[8:9], v[2:3]
    v_pk_fma_f32 v[2:3], v[204:205], v[8:9], v[2:3]
    v_pk_fma_f32 v[2:3], v[206:207], v[8:9], v[2:3]
    s_nop 3
    v_pk_fma_f32 v[2:3], v[208:209], v[8:9], v[2:3]
    v_pk_fma_f32 v[2:3], v[210:211], v[8:9], v[2:3]
    v_pk_fma_f32 v[2:3], v[212:213], v[8:9], v[2:3]
    v_pk_fma_f32 v[2:3], v[214:215], v[8:9], v[2:3]
    v_pk_fma_f32 v[2:3], v[216:217], v[8:9], v[2:3]
    v_pk_fma_f32 v[2:3], v[218:219], v[8:9], v[2:3]
    v_pk_fma_f32 v[2:3], v[220:221], v[8:9], v[2:3]
    v_pk_fma_f32 v[2:3], v[222:223], v[8:9], v[2:3]
    v_pk_fma_f32 v[2:3], v[224:225], v[8:9], v[2:3]
    v_pk_fma_f32 v[2:3], v[226:227], v[8:9], v[2:3]
    v_pk_fma_f32 v[2:3], v[228:229], v[8:9], v[2:3]
    v_pk_fma_f32 v[2:3], v[230:231], v[8:9], v[2:3]
    v_pk_fma_f32 v[2:3], v[232:233], v[8:9], v[2:3]
    v_pk_fma_f32 v[2:3], v[234:235], v[8:9], v[2:3]
    v_pk_fma_f32 v[2:3], v[236:237], v[8:9], v[2:3]
    v_pk_fma_f32 v[2:3], v[238:239], v[8:9], v[2:3]
    v_cmp_u_f32 vcc, v2, v3
    s_cbranch_vccnz K2A_fallback
K2A_ok:
    s_nop 7
    s_cmp_eq_u32 s35, 0
    s_cbranch_scc0 K2A_ep1
    ds_write_b128 v144, v[208:211] offset:0
    ds_write_b128 v144, v[212:215] offset:1024
    ds_write_b128 v144, v[216:219] offset:2048
    ds_write_b128 v144, v[220:223] offset:3072
    ds_write_b32 v146, v13 offset:0
    ds_write_b128 v144, v[224:227] offset:4096
    ds_write_b128 v144, v[228:231] offset:5120
    ds_write_b128 v144, v[232:235] offset:6144
    ds_write_b128 v144, v[236:239] offset:7168
    ds_write_b32 v146, v14 offset:256
    s_waitcnt lgkmcnt(0)
    ds_write_b32 v148, v151
K2A_spina0:
    ds_read_b32 v6, v149
    s_add_u32 s55, s55, 1
    s_waitcnt lgkmcnt(0)
    v_readfirstlane_b32 s47, v6
    s_bitcmp1_b32 s55, 22
    s_cbranch_scc1 K2A_spuna0
    s_cmp_ge_u32 s47, 1
    s_cbranch_scc1 K2A_spuna0
    s_sleep 1
    s_branch K2A_spina0
K2A_spuna0:
    s_cmp_eq_u32 s36, 0
    s_cbranch_scc0 K2A_ep0b
    ds_read_b128 v[96:99], v145 offset:4096
    ds_read_b128 v[100:103], v145 offset:5120
    ds_read_b128 v[104:107], v145 offset:6144
    ds_read_b128 v[108:111], v145 offset:7168
    ds_read_b32 v3, v147 offset:256
    ds_read_b128 v[80:83], v145 offset:0
    ds_read_b128 v[84:87], v145 offset:1024
    ds_read_b128 v[88:91], v145 offset:2048
    ds_read_b128 v[92:95], v145 offset:3072
    ds_read_b32 v2, v147 offset:0
    s_waitcnt lgkmcnt(5)
    v_max_f32 v7, v12, v3
    v_sub_f32 v8, v12, v7
    v_sub_f32 v9, v3, v7
    v_exp_f32 v8, v8
    v_exp_f32 v9, v9
    v_mov_b32 v12, v7
    v_mul_f32 v192, v192, v8
    v_fma_f32 v192, v96, v9, v192
    v_mul_f32 v193, v193, v8
    v_fma_f32 v193, v97, v9, v193
    v_mul_f32 v194, v194, v8
    v_fma_f32 v194, v98, v9, v194
    v_mul_f32 v195, v195, v8
    v_fma_f32 v195, v99, v9, v195
    v_mul_f32 v196, v196, v8
    v_fma_f32 v196, v100, v9, v196
    v_mul_f32 v197, v197, v8
    v_fma_f32 v197, v101, v9, v197
    v_mul_f32 v198, v198, v8
    v_fma_f32 v198, v102, v9, v198
    v_mul_f32 v199, v199, v8
    v_fma_f32 v199, v103, v9, v199
    v_mul_f32 v200, v200, v8
    v_fma_f32 v200, v104, v9, v200
    v_mul_f32 v201, v201, v8
    v_fma_f32 v201, v105, v9, v201
    v_mul_f32 v202, v202, v8
    v_fma_f32 v202, v106, v9, v202
    v_mul_f32 v203, v203, v8
    v_fma_f32 v203, v107, v9, v203
    v_mul_f32 v204, v204, v8
    v_fma_f32 v204, v108, v9, v204
    v_mul_f32 v205, v205, v8
    v_fma_f32 v205, v109, v9, v205
    v_mul_f32 v206, v206, v8
    v_fma_f32 v206, v110, v9, v206
    v_mul_f32 v207, v207, v8
    v_fma_f32 v207, v111, v9, v207
    s_waitcnt lgkmcnt(0)
    ds_write_b128 v145, v[192:195] offset:0
    ds_write_b128 v145, v[196:199] offset:1024
    ds_write_b128 v145, v[200:203] offset:2048
    ds_write_b128 v145, v[204:207] offset:3072
    ds_write_b32 v146, v12 offset:512
    v_mov_b32 v151, 2
    s_waitcnt lgkmcnt(0)
    ds_write_b32 v148, v151
    v_max_f32 v7, v11, v2
    v_sub_f32 v8, v11, v7
    v_sub_f32 v9, v2, v7
    v_exp_f32 v8, v8
    v_exp_f32 v9, v9
    v_mov_b32 v11, v7
    v_mul_f32 v176, v176, v8
    v_fma_f32 v176, v80, v9, v176
    v_mul_f32 v177, v177, v8
    v_fma_f32 v177, v81, v9, v177
    v_mul_f32 v178, v178, v8
    v_fma_f32 v178, v82, v9, v178
    v_mul_f32 v179, v179, v8
    v_fma_f32 v179, v83, v9, v179
    v_mul_f32 v180, v180, v8
    v_fma_f32 v180, v84, v9, v180
    v_mul_f32 v181, v181, v8
    v_fma_f32 v181, v85, v9, v181
    v_mul_f32 v182, v182, v8
    v_fma_f32 v182, v86, v9, v182
    v_mul_f32 v183, v183, v8
    v_fma_f32 v183, v87, v9, v183
    v_mul_f32 v184, v184, v8
    v_fma_f32 v184, v88, v9, v184
    v_mul_f32 v185, v185, v8
    v_fma_f32 v185, v89, v9, v185
    v_mul_f32 v186, v186, v8
    v_fma_f32 v186, v90, v9, v186
    v_mul_f32 v187, v187, v8
    v_fma_f32 v187, v91, v9, v187
    v_mul_f32 v188, v188, v8
    v_fma_f32 v188, v92, v9, v188
    v_mul_f32 v189, v189, v8
    v_fma_f32 v189, v93, v9, v189
    v_mul_f32 v190, v190, v8
    v_fma_f32 v190, v94, v9, v190
    v_mul_f32 v191, v191, v8
    v_fma_f32 v191, v95, v9, v191
K2A_spinb00:
    ds_read_b32 v6, v150
    s_add_u32 s55, s55, 1
    s_waitcnt lgkmcnt(0)
    v_readfirstlane_b32 s47, v6
    s_bitcmp1_b32 s55, 22
    s_cbranch_scc1 K2A_spunb00
    s_cmp_ge_u32 s47, 2
    s_cbranch_scc1 K2A_spunb00
    s_sleep 1
    s_branch K2A_spinb00
K2A_spunb00:
    ds_read_b128 v[80:83], v5 offset:0
    ds_read_b128 v[84:87], v5 offset:1024
    ds_read_b128 v[88:91], v5 offset:2048
    ds_read_b128 v[92:95], v5 offset:3072
    ds_read_b32 v2, v15 offset:512
    s_waitcnt lgkmcnt(0)
    v_max_f32 v7, v11, v2
    v_sub_f32 v8, v11, v7
    v_sub_f32 v9, v2, v7
    v_exp_f32 v8, v8
    v_exp_f32 v9, v9
    v_mov_b32 v11, v7
    v_mul_f32 v176, v176, v8
    v_fma_f32 v176, v80, v9, v176
    v_mul_f32 v177, v177, v8
    v_fma_f32 v177, v81, v9, v177
    v_mul_f32 v178, v178, v8
    v_fma_f32 v178, v82, v9, v178
    v_mul_f32 v179, v179, v8
    v_fma_f32 v179, v83, v9, v179
    v_mul_f32 v180, v180, v8
    v_fma_f32 v180, v84, v9, v180
    v_mul_f32 v181, v181, v8
    v_fma_f32 v181, v85, v9, v181
    v_mul_f32 v182, v182, v8
    v_fma_f32 v182, v86, v9, v182
    v_mul_f32 v183, v183, v8
    v_fma_f32 v183, v87, v9, v183
    v_mul_f32 v184, v184, v8
    v_fma_f32 v184, v88, v9, v184
    v_mul_f32 v185, v185, v8
    v_fma_f32 v185, v89, v9, v185
    v_mul_f32 v186, v186, v8
    v_fma_f32 v186, v90, v9, v186
    v_mul_f32 v187, v187, v8
    v_fma_f32 v187, v91, v9, v187
    v_mul_f32 v188, v188, v8
    v_fma_f32 v188, v92, v9, v188
    v_mul_f32 v189, v189, v8
    v_fma_f32 v189, v93, v9, v189
    v_mul_f32 v190, v190, v8
    v_fma_f32 v190, v94, v9, v190
    v_mul_f32 v191, v191, v8
    v_fma_f32 v191, v95, v9, v191
    v_mov_b32 v7, v188
    v_mov_b32 v8, v188
    s_nop 1
    v_permlane32_swap_b32 v7, v8
    s_nop 1
    v_rcp_f32 v8, v8
    s_nop 0
    v_mul_f32 v176, v176, v8
    v_mul_f32 v177, v177, v8
    v_mul_f32 v178, v178, v8
    v_mul_f32 v179, v179, v8
    v_mul_f32 v180, v180, v8
    v_mul_f32 v181, v181, v8
    v_mul_f32 v182, v182, v8
    v_mul_f32 v183, v183, v8
    v_mul_f32 v184, v184, v8
    v_mul_f32 v185, v185, v8
    v_mul_f32 v186, v186, v8
    v_mul_f32 v187, v187, v8
    v_mul_f32 v188, v188, v8
    v_mul_f32 v189, v189, v8
    v_mul_f32 v190, v190, v8
    v_mul_f32 v191, v191, v8
    v_cvt_pk_bf16_f32 v80, v176, v177
    v_cvt_pk_bf16_f32 v81, v178, v179
    v_cvt_pk_bf16_f32 v82, v180, v181
    v_cvt_pk_bf16_f32 v83, v182, v183
    v_cvt_pk_bf16_f32 v84, v184, v185
    v_cvt_pk_bf16_f32 v85, v186, v187
    v_cvt_pk_bf16_f32 v86, v188, v189
    v_cvt_pk_bf16_f32 v87, v190, v191
    s_branch K2A_ost
K2A_ep0b:
    ds_read_b128 v[80:83], v145 offset:0
    ds_read_b128 v[84:87], v145 offset:1024
    ds_read_b128 v[88:91], v145 offset:2048
    ds_read_b128 v[92:95], v145 offset:3072
    ds_read_b32 v2, v147 offset:0
    ds_read_b128 v[96:99], v145 offset:4096
    ds_read_b128 v[100:103], v145 offset:5120
    ds_read_b128 v[104:107], v145 offset:6144
    ds_read_b128 v[108:111], v145 offset:7168
    ds_read_b32 v3, v147 offset:256
    s_waitcnt lgkmcnt(5)
    v_max_f32 v7, v11, v2
    v_sub_f32 v8, v11, v7
    v_sub_f32 v9, v2, v7
    v_exp_f32 v8, v8
    v_exp_f32 v9, v9
    v_mov_b32 v11, v7
    v_mul_f32 v176, v176, v8
    v_fma_f32 v176, v80, v9, v176
    v_mul_f32 v177, v177, v8
    v_fma_f32 v177, v81, v9, v177
    v_mul_f32 v178, v178, v8
    v_fma_f32 v178, v82, v9, v178
    v_mul_f32 v179, v179, v8
    v_fma_f32 v179, v83, v9, v179
    v_mul_f32 v180, v180, v8
    v_fma_f32 v180, v84, v9, v180
    v_mul_f32 v181, v181, v8
    v_fma_f32 v181, v85, v9, v181
    v_mul_f32 v182, v182, v8
    v_fma_f32 v182, v86, v9, v182
    v_mul_f32 v183, v183, v8
    v_fma_f32 v183, v87, v9, v183
    v_mul_f32 v184, v184, v8
    v_fma_f32 v184, v88, v9, v184
    v_mul_f32 v185, v185, v8
    v_fma_f32 v185, v89, v9, v185
    v_mul_f32 v186, v186, v8
    v_fma_f32 v186, v90, v9, v186
    v_mul_f32 v187, v187, v8
    v_fma_f32 v187, v91, v9, v187
    v_mul_f32 v188, v188, v8
    v_fma_f32 v188, v92, v9, v188
    v_mul_f32 v189, v189, v8
    v_fma_f32 v189, v93, v9, v189
    v_mul_f32 v190, v190, v8
    v_fma_f32 v190, v94, v9, v190
    v_mul_f32 v191, v191, v8
    v_fma_f32 v191, v95, v9, v191
    s_waitcnt lgkmcnt(0)
    ds_write_b128 v145, v[176:179] offset:0
    ds_write_b128 v145, v[180:183] offset:1024
    ds_write_b128 v145, v[184:187] offset:2048
    ds_write_b128 v145, v[188:191] offset:3072
    ds_write_b32 v146, v11 offset:512
    v_mov_b32 v151, 2
    s_waitcnt lgkmcnt(0)
    ds_write_b32 v148, v151
    v_max_f32 v7, v12, v3
    v_sub_f32 v8, v12, v7
    v_sub_f32 v9, v3, v7
    v_exp_f32 v8, v8
    v_exp_f32 v9, v9
    v_mov_b32 v12, v7
    v_mul_f32 v192, v192, v8
    v_fma_f32 v192, v96, v9, v192
    v_mul_f32 v193, v193, v8
    v_fma_f32 v193, v97, v9, v193
    v_mul_f32 v194, v194, v8
    v_fma_f32 v194, v98, v9, v194
    v_mul_f32 v195, v195, v8
    v_fma_f32 v195, v99, v9, v195
    v_mul_f32 v196, v196, v8
    v_fma_f32 v196, v100, v9, v196
    v_mul_f32 v197, v197, v8
    v_fma_f32 v197, v101, v9, v197
    v_mul_f32 v198, v198, v8
    v_fma_f32 v198, v102, v9, v198
    v_mul_f32 v199, v199, v8
    v_fma_f32 v199, v103, v9, v199
    v_mul_f32 v200, v200, v8
    v_fma_f32 v200, v104, v9, v200
    v_mul_f32 v201, v201, v8
    v_fma_f32 v201, v105, v9, v201
    v_mul_f32 v202, v202, v8
    v_fma_f32 v202, v106, v9, v202
    v_mul_f32 v203, v203, v8
    v_fma_f32 v203, v107, v9, v203
    v_mul_f32 v204, v204, v8
    v_fma_f32 v204, v108, v9, v204
    v_mul_f32 v205, v205, v8
    v_fma_f32 v205, v109, v9, v205
    v_mul_f32 v206, v206, v8
    v_fma_f32 v206, v110, v9, v206
    v_mul_f32 v207, v207, v8
    v_fma_f32 v207, v111, v9, v207
K2A_spinb01:
    ds_read_b32 v6, v150
    s_add_u32 s55, s55, 1
    s_waitcnt lgkmcnt(0)
    v_readfirstlane_b32 s47, v6
    s_bitcmp1_b32 s55, 22
    s_cbranch_scc1 K2A_spunb01
    s_cmp_ge_u32 s47, 2
    s_cbranch_scc1 K2A_spunb01
    s_sleep 1
    s_branch K2A_spinb01
K2A_spunb01:
    ds_read_b128 v[80:83], v5 offset:0
    ds_read_b128 v[84:87], v5 offset:1024
    ds_read_b128 v[88:91], v5 offset:2048
    ds_read_b128 v[92:95], v5 offset:3072
    ds_read_b32 v2, v15 offset:512
    s_waitcnt lgkmcnt(0)
    v_max_f32 v7, v12, v2
    v_sub_f32 v8, v12, v7
    v_sub_f32 v9, v2, v7
    v_exp_f32 v8, v8
    v_exp_f32 v9, v9
    v_mov_b32 v12, v7
    v_mul_f32 v192, v192, v8
    v_fma_f32 v192, v80, v9, v192
    v_mul_f32 v193, v193, v8
    v_fma_f32 v193, v81, v9, v193
    v_mul_f32 v194, v194, v8
    v_fma_f32 v194, v82, v9, v194
    v_mul_f32 v195, v195, v8
    v_fma_f32 v195, v83, v9, v195
    v_mul_f32 v196, v196, v8
    v_fma_f32 v196, v84, v9, v196
    v_mul_f32 v197, v197, v8
    v_fma_f32 v197, v85, v9, v197
    v_mul_f32 v198, v198, v8
    v_fma_f32 v198, v86, v9, v198
    v_mul_f32 v199, v199, v8
    v_fma_f32 v199, v87, v9, v199
    v_mul_f32 v200, v200, v8
    v_fma_f32 v200, v88, v9, v200
    v_mul_f32 v201, v201, v8
    v_fma_f32 v201, v89, v9, v201
    v_mul_f32 v202, v202, v8
    v_fma_f32 v202, v90, v9, v202
    v_mul_f32 v203, v203, v8
    v_fma_f32 v203, v91, v9, v203
    v_mul_f32 v204, v204, v8
    v_fma_f32 v204, v92, v9, v204
    v_mul_f32 v205, v205, v8
    v_fma_f32 v205, v93, v9, v205
    v_mul_f32 v206, v206, v8
    v_fma_f32 v206, v94, v9, v206
    v_mul_f32 v207, v207, v8
    v_fma_f32 v207, v95, v9, v207
    v_mov_b32 v7, v204
    v_mov_b32 v8, v204
    s_nop 1
    v_permlane32_swap_b32 v7, v8
    s_nop 1
    v_rcp_f32 v8, v8
    s_nop 0
    v_mul_f32 v192, v192, v8
    v_mul_f32 v193, v193, v8
    v_mul_f32 v194, v194, v8
    v_mul_f32 v195, v195, v8
    v_mul_f32 v196, v196, v8
    v_mul_f32 v197, v197, v8
    v_mul_f32 v198, v198, v8
    v_mul_f32 v199, v199, v8
    v_mul_f32 v200, v200, v8
    v_mul_f32 v201, v201, v8
    v_mul_f32 v202, v202, v8
    v_mul_f32 v203, v203, v8
    v_mul_f32 v204, v204, v8
    v_mul_f32 v205, v205, v8
    v_mul_f32 v206, v206, v8
    v_mul_f32 v207, v207, v8
    v_cvt_pk_bf16_f32 v80, v192, v193
    v_cvt_pk_bf16_f32 v81, v194, v195
    v_cvt_pk_bf16_f32 v82, v196, v197
    v_cvt_pk_bf16_f32 v83, v198, v199
    v_cvt_pk_bf16_f32 v84, v200, v201
    v_cvt_pk_bf16_f32 v85, v202, v203
    v_cvt_pk_bf16_f32 v86, v204, v205
    v_cvt_pk_bf16_f32 v87, v206, v207
    s_branch K2A_ost
K2A_ep1:
    ds_write_b128 v144, v[176:179] offset:0
    ds_write_b128 v144, v[180:183] offset:1024
    ds_write_b128 v144, v[184:187] offset:2048
    ds_write_b128 v144, v[188:191] offset:3072
    ds_write_b32 v146, v11 offset:0
    ds_write_b128 v144, v[192:195] offset:4096
    ds_write_b128 v144, v[196:199] offset:5120
    ds_write_b128 v144, v[200:203] offset:6144
    ds_write_b128 v144, v[204:207] offset:7168
    ds_write_b32 v146, v12 offset:256
    s_waitcnt lgkmcnt(0)
    ds_write_b32 v148, v151
K2A_spina1:
    ds_read_b32 v6, v149
    s_add_u32 s55, s55, 1
    s_waitcnt lgkmcnt(0)
    v_readfirstlane_b32 s47, v6
    s_bitcmp1_b32 s55, 22
    s_cbranch_scc1 K2A_spuna1
    s_cmp_ge_u32 s47, 1
    s_cbranch_scc1 K2A_spuna1
    s_sleep 1
    s_branch K2A_spina1
K2A_spuna1:
    s_cmp_eq_u32 s36, 0
    s_cbranch_scc0 K2A_ep1b
    ds_read_b128 v[96:99], v145 offset:4096
    ds_read_b128 v[100:103], v145 offset:5120
    ds_read_b128 v[104:107], v145 offset:6144
    ds_read_b128 v[108:111], v145 offset:7168
    ds_read_b32 v3, v147 offset:256
    ds_read_b128 v[80:83], v145 offset:0
    ds_read_b128 v[84:87], v145 offset:1024
    ds_read_b128 v[88:91], v145 offset:2048
    ds_read_b128 v[92:95], v145 offset:3072
    ds_read_b32 v2, v147 offset:0
    s_waitcnt lgkmcnt(5)
    v_max_f32 v7, v14, v3
    v_sub_f32 v8, v14, v7
    v_sub_f32 v9, v3, v7
    v_exp_f32 v8, v8
    v_exp_f32 v9, v9
    v_mov_b32 v14, v7
    v_mul_f32 v224, v224, v8
    v_fma_f32 v224, v96, v9, v224
    v_mul_f32 v225, v225, v8
    v_fma_f32 v225, v97, v9, v225
    v_mul_f32 v226, v226, v8
    v_fma_f32 v226, v98, v9, v226
    v_mul_f32 v227, v227, v8
    v_fma_f32 v227, v99, v9, v227
    v_mul_f32 v228, v228, v8
    v_fma_f32 v228, v100, v9, v228
    v_mul_f32 v229, v229, v8
    v_fma_f32 v229, v101, v9, v229
    v_mul_f32 v230, v230, v8
    v_fma_f32 v230, v102, v9, v230
    v_mul_f32 v231, v231, v8
    v_fma_f32 v231, v103, v9, v231
    v_mul_f32 v232, v232, v8
    v_fma_f32 v232, v104, v9, v232
    v_mul_f32 v233, v233, v8
    v_fma_f32 v233, v105, v9, v233
    v_mul_f32 v234, v234, v8
    v_fma_f32 v234, v106, v9, v234
    v_mul_f32 v235, v235, v8
    v_fma_f32 v235, v107, v9, v235
    v_mul_f32 v236, v236, v8
    v_fma_f32 v236, v108, v9, v236
    v_mul_f32 v237, v237, v8
    v_fma_f32 v237, v109, v9, v237
    v_mul_f32 v238, v238, v8
    v_fma_f32 v238, v110, v9, v238
    v_mul_f32 v239, v239, v8
    v_fma_f32 v239, v111, v9, v239
    s_waitcnt lgkmcnt(0)
    ds_write_b128 v145, v[224:227] offset:0
    ds_write_b128 v145, v[228:231] offset:1024
    ds_write_b128 v145, v[232:235] offset:2048
    ds_write_b128 v145, v[236:239] offset:3072
    ds_write_b32 v146, v14 offset:512
    v_mov_b32 v151, 2
    s_waitcnt lgkmcnt(0)
    ds_write_b32 v148, v151
    v_max_f32 v7, v13, v2
    v_sub_f32 v8, v13, v7
    v_sub_f32 v9, v2, v7
    v_exp_f32 v8, v8
    v_exp_f32 v9, v9
    v_mov_b32 v13, v7
    v_mul_f32 v208, v208, v8
    v_fma_f32 v208, v80, v9, v208
    v_mul_f32 v209, v209, v8
    v_fma_f32 v209, v81, v9, v209
    v_mul_f32 v210, v210, v8
    v_fma_f32 v210, v82, v9, v210
    v_mul_f32 v211, v211, v8
    v_fma_f32 v211, v83, v9, v211
    v_mul_f32 v212, v212, v8
    v_fma_f32 v212, v84, v9, v212
    v_mul_f32 v213, v213, v8
    v_fma_f32 v213, v85, v9, v213
    v_mul_f32 v214, v214, v8
    v_fma_f32 v214, v86, v9, v214
    v_mul_f32 v215, v215, v8
    v_fma_f32 v215, v87, v9, v215
    v_mul_f32 v216, v216, v8
    v_fma_f32 v216, v88, v9, v216
    v_mul_f32 v217, v217, v8
    v_fma_f32 v217, v89, v9, v217
    v_mul_f32 v218, v218, v8
    v_fma_f32 v218, v90, v9, v218
    v_mul_f32 v219, v219, v8
    v_fma_f32 v219, v91, v9, v219
    v_mul_f32 v220, v220, v8
    v_fma_f32 v220, v92, v9, v220
    v_mul_f32 v221, v221, v8
    v_fma_f32 v221, v93, v9, v221
    v_mul_f32 v222, v222, v8
    v_fma_f32 v222, v94, v9, v222
    v_mul_f32 v223, v223, v8
    v_fma_f32 v223, v95, v9, v223
K2A_spinb10:
    ds_read_b32 v6, v150
    s_add_u32 s55, s55, 1
    s_waitcnt lgkmcnt(0)
    v_readfirstlane_b32 s47, v6
    s_bitcmp1_b32 s55, 22
    s_cbranch_scc1 K2A_spunb10
    s_cmp_ge_u32 s47, 2
    s_cbranch_scc1 K2A_spunb10
    s_sleep 1
    s_branch K2A_spinb10
K2A_spunb10:
    ds_read_b128 v[80:83], v5 offset:0
    ds_read_b128 v[84:87], v5 offset:1024
    ds_read_b128 v[88:91], v5 offset:2048
    ds_read_b128 v[92:95], v5 offset:3072
    ds_read_b32 v2, v15 offset:512
    s_waitcnt lgkmcnt(0)
    v_max_f32 v7, v13, v2
    v_sub_f32 v8, v13, v7
    v_sub_f32 v9, v2, v7
    v_exp_f32 v8, v8
    v_exp_f32 v9, v9
    v_mov_b32 v13, v7
    v_mul_f32 v208, v208, v8
    v_fma_f32 v208, v80, v9, v208
    v_mul_f32 v209, v209, v8
    v_fma_f32 v209, v81, v9, v209
    v_mul_f32 v210, v210, v8
    v_fma_f32 v210, v82, v9, v210
    v_mul_f32 v211, v211, v8
    v_fma_f32 v211, v83, v9, v211
    v_mul_f32 v212, v212, v8
    v_fma_f32 v212, v84, v9, v212
    v_mul_f32 v213, v213, v8
    v_fma_f32 v213, v85, v9, v213
    v_mul_f32 v214, v214, v8
    v_fma_f32 v214, v86, v9, v214
    v_mul_f32 v215, v215, v8
    v_fma_f32 v215, v87, v9, v215
    v_mul_f32 v216, v216, v8
    v_fma_f32 v216, v88, v9, v216
    v_mul_f32 v217, v217, v8
    v_fma_f32 v217, v89, v9, v217
    v_mul_f32 v218, v218, v8
    v_fma_f32 v218, v90, v9, v218
    v_mul_f32 v219, v219, v8
    v_fma_f32 v219, v91, v9, v219
    v_mul_f32 v220, v220, v8
    v_fma_f32 v220, v92, v9, v220
    v_mul_f32 v221, v221, v8
    v_fma_f32 v221, v93, v9, v221
    v_mul_f32 v222, v222, v8
    v_fma_f32 v222, v94, v9, v222
    v_mul_f32 v223, v223, v8
    v_fma_f32 v223, v95, v9, v223
    v_mov_b32 v7, v220
    v_mov_b32 v8, v220
    s_nop 1
    v_permlane32_swap_b32 v7, v8
    s_nop 1
    v_rcp_f32 v8, v8
    s_nop 0
    v_mul_f32 v208, v208, v8
    v_mul_f32 v209, v209, v8
    v_mul_f32 v210, v210, v8
    v_mul_f32 v211, v211, v8
    v_mul_f32 v212, v212, v8
    v_mul_f32 v213, v213, v8
    v_mul_f32 v214, v214, v8
    v_mul_f32 v215, v215, v8
    v_mul_f32 v216, v216, v8
    v_mul_f32 v217, v217, v8
    v_mul_f32 v218, v218, v8
    v_mul_f32 v219, v219, v8
    v_mul_f32 v220, v220, v8
    v_mul_f32 v221, v221, v8
    v_mul_f32 v222, v222, v8
    v_mul_f32 v223, v223, v8
    v_cvt_pk_bf16_f32 v80, v208, v209
    v_cvt_pk_bf16_f32 v81, v210, v211
    v_cvt_pk_bf16_f32 v82, v212, v213
    v_cvt_pk_bf16_f32 v83, v214, v215
    v_cvt_pk_bf16_f32 v84, v216, v217
    v_cvt_pk_bf16_f32 v85, v218, v219
    v_cvt_pk_bf16_f32 v86, v220, v221
    v_cvt_pk_bf16_f32 v87, v222, v223
    s_branch K2A_ost
K2A_ep1b:
    ds_read_b128 v[80:83], v145 offset:0
    ds_read_b128 v[84:87], v145 offset:1024
    ds_read_b128 v[88:91], v145 offset:2048
    ds_read_b128 v[92:95], v145 offset:3072
    ds_read_b32 v2, v147 offset:0
    ds_read_b128 v[96:99], v145 offset:4096
    ds_read_b128 v[100:103], v145 offset:5120
    ds_read_b128 v[104:107], v145 offset:6144
    ds_read_b128 v[108:111], v145 offset:7168
    ds_read_b32 v3, v147 offset:256
    s_waitcnt lgkmcnt(5)
    v_max_f32 v7, v13, v2
    v_sub_f32 v8, v13, v7
    v_sub_f32 v9, v2, v7
    v_exp_f32 v8, v8
    v_exp_f32 v9, v9
    v_mov_b32 v13, v7
    v_mul_f32 v208, v208, v8
    v_fma_f32 v208, v80, v9, v208
    v_mul_f32 v209, v209, v8
    v_fma_f32 v209, v81, v9, v209
    v_mul_f32 v210, v210, v8
    v_fma_f32 v210, v82, v9, v210
    v_mul_f32 v211, v211, v8
    v_fma_f32 v211, v83, v9, v211
    v_mul_f32 v212, v212, v8
    v_fma_f32 v212, v84, v9, v212
    v_mul_f32 v213, v213, v8
    v_fma_f32 v213, v85, v9, v213
    v_mul_f32 v214, v214, v8
    v_fma_f32 v214, v86, v9, v214
    v_mul_f32 v215, v215, v8
    v_fma_f32 v215, v87, v9, v215
    v_mul_f32 v216, v216, v8
    v_fma_f32 v216, v88, v9, v216
    v_mul_f32 v217, v217, v8
    v_fma_f32 v217, v89, v9, v217
    v_mul_f32 v218, v218, v8
    v_fma_f32 v218, v90, v9, v218
    v_mul_f32 v219, v219, v8
    v_fma_f32 v219, v91, v9, v219
    v_mul_f32 v220, v220, v8
    v_fma_f32 v220, v92, v9, v220
    v_mul_f32 v221, v221, v8
    v_fma_f32 v221, v93, v9, v221
    v_mul_f32 v222, v222, v8
    v_fma_f32 v222, v94, v9, v222
    v_mul_f32 v223, v223, v8
    v_fma_f32 v223, v95, v9, v223
    s_waitcnt lgkmcnt(0)
    ds_write_b128 v145, v[208:211] offset:0
    ds_write_b128 v145, v[212:215] offset:1024
    ds_write_b128 v145, v[216:219] offset:2048
    ds_write_b128 v145, v[220:223] offset:3072
    ds_write_b32 v146, v13 offset:512
    v_mov_b32 v151, 2
    s_waitcnt lgkmcnt(0)
    ds_write_b32 v148, v151
    v_max_f32 v7, v14, v3
    v_sub_f32 v8, v14, v7
    v_sub_f32 v9, v3, v7
    v_exp_f32 v8, v8
    v_exp_f32 v9, v9
    v_mov_b32 v14, v7
    v_mul_f32 v224, v224, v8
    v_fma_f32 v224, v96, v9, v224
    v_mul_f32 v225, v225, v8
    v_fma_f32 v225, v97, v9, v225
    v_mul_f32 v226, v226, v8
    v_fma_f32 v226, v98, v9, v226
    v_mul_f32 v227, v227, v8
    v_fma_f32 v227, v99, v9, v227
    v_mul_f32 v228, v228, v8
    v_fma_f32 v228, v100, v9, v228
    v_mul_f32 v229, v229, v8
    v_fma_f32 v229, v101, v9, v229
    v_mul_f32 v230, v230, v8
    v_fma_f32 v230, v102, v9, v230
    v_mul_f32 v231, v231, v8
    v_fma_f32 v231, v103, v9, v231
    v_mul_f32 v232, v232, v8
    v_fma_f32 v232, v104, v9, v232
    v_mul_f32 v233, v233, v8
    v_fma_f32 v233, v105, v9, v233
    v_mul_f32 v234, v234, v8
    v_fma_f32 v234, v106, v9, v234
    v_mul_f32 v235, v235, v8
    v_fma_f32 v235, v107, v9, v235
    v_mul_f32 v236, v236, v8
    v_fma_f32 v236, v108, v9, v236
    v_mul_f32 v237, v237, v8
    v_fma_f32 v237, v109, v9, v237
    v_mul_f32 v238, v238, v8
    v_fma_f32 v238, v110, v9, v238
    v_mul_f32 v239, v239, v8
    v_fma_f32 v239, v111, v9, v239
K2A_spinb11:
    ds_read_b32 v6, v150
    s_add_u32 s55, s55, 1
    s_waitcnt lgkmcnt(0)
    v_readfirstlane_b32 s47, v6
    s_bitcmp1_b32 s55, 22
    s_cbranch_scc1 K2A_spunb11
    s_cmp_ge_u32 s47, 2
    s_cbranch_scc1 K2A_spunb11
    s_sleep 1
    s_branch K2A_spinb11
K2A_spunb11:
    ds_read_b128 v[80:83], v5 offset:0
    ds_read_b128 v[84:87], v5 offset:1024
    ds_read_b128 v[88:91], v5 offset:2048
    ds_read_b128 v[92:95], v5 offset:3072
    ds_read_b32 v2, v15 offset:512
    s_waitcnt lgkmcnt(0)
    v_max_f32 v7, v14, v2
    v_sub_f32 v8, v14, v7
    v_sub_f32 v9, v2, v7
    v_exp_f32 v8, v8
    v_exp_f32 v9, v9
    v_mov_b32 v14, v7
    v_mul_f32 v224, v224, v8
    v_fma_f32 v224, v80, v9, v224
    v_mul_f32 v225, v225, v8
    v_fma_f32 v225, v81, v9, v225
    v_mul_f32 v226, v226, v8
    v_fma_f32 v226, v82, v9, v226
    v_mul_f32 v227, v227, v8
    v_fma_f32 v227, v83, v9, v227
    v_mul_f32 v228, v228, v8
    v_fma_f32 v228, v84, v9, v228
    v_mul_f32 v229, v229, v8
    v_fma_f32 v229, v85, v9, v229
    v_mul_f32 v230, v230, v8
    v_fma_f32 v230, v86, v9, v230
    v_mul_f32 v231, v231, v8
    v_fma_f32 v231, v87, v9, v231
    v_mul_f32 v232, v232, v8
    v_fma_f32 v232, v88, v9, v232
    v_mul_f32 v233, v233, v8
    v_fma_f32 v233, v89, v9, v233
    v_mul_f32 v234, v234, v8
    v_fma_f32 v234, v90, v9, v234
    v_mul_f32 v235, v235, v8
    v_fma_f32 v235, v91, v9, v235
    v_mul_f32 v236, v236, v8
    v_fma_f32 v236, v92, v9, v236
    v_mul_f32 v237, v237, v8
    v_fma_f32 v237, v93, v9, v237
    v_mul_f32 v238, v238, v8
    v_fma_f32 v238, v94, v9, v238
    v_mul_f32 v239, v239, v8
    v_fma_f32 v239, v95, v9, v239
    v_mov_b32 v7, v236
    v_mov_b32 v8, v236
    s_nop 1
    v_permlane32_swap_b32 v7, v8
    s_nop 1
    v_rcp_f32 v8, v8
    s_nop 0
    v_mul_f32 v224, v224, v8
    v_mul_f32 v225, v225, v8
    v_mul_f32 v226, v226, v8
    v_mul_f32 v227, v227, v8
    v_mul_f32 v228, v228, v8
    v_mul_f32 v229, v229, v8
    v_mul_f32 v230, v230, v8
    v_mul_f32 v231, v231, v8
    v_mul_f32 v232, v232, v8
    v_mul_f32 v233, v233, v8
    v_mul_f32 v234, v234, v8
    v_mul_f32 v235, v235, v8
    v_mul_f32 v236, v236, v8
    v_mul_f32 v237, v237, v8
    v_mul_f32 v238, v238, v8
    v_mul_f32 v239, v239, v8
    v_cvt_pk_bf16_f32 v80, v224, v225
    v_cvt_pk_bf16_f32 v81, v226, v227
    v_cvt_pk_bf16_f32 v82, v228, v229
    v_cvt_pk_bf16_f32 v83, v230, v231
    v_cvt_pk_bf16_f32 v84, v232, v233
    v_cvt_pk_bf16_f32 v85, v234, v235
    v_cvt_pk_bf16_f32 v86, v236, v237
    v_cvt_pk_bf16_f32 v87, v238, v239
K2A_ost:
    s_lshl_b32 s47, s34, 2
    s_add_u32 s47, s47, s32
    s_lshl_b32 s47, s47, 4
    s_add_u32 s47, s47, s33
    s_lshl_b32 s47, s47, 11
    s_add_u32 s47, s47, 10485760
    buffer_store_dwordx4 v[80:83], v10, s[28:31], s47 offen sc0 sc1
    buffer_store_dwordx4 v[84:87], v10, s[28:31], s47 offen offset:1024 sc0 sc1
K2A_tail:
    v_mov_b32 v13, 155688
    v_mov_b32 v3, 1
    s_mov_b64 exec, 1
    ds_add_u32 v13, v3 offset:12
    s_mov_b64 exec, -1
    s_lshl_b32 s89, s34, 12
    s_add_u32 s89, s89, 14680064
    s_lshl_b32 s70, s33, 8
    s_add_u32 s70, s70, s89
    s_lshl_b32 s47, s35, 1
    s_add_u32 s80, s47, s36
    s_lshl_b32 s47, s80, 8
    s_add_u32 s81, s47, s89
    s_lshl_b32 s48, s33, 2
    s_add_u32 s48, s48, s81
    s_lshl_b32 s47, s32, 2
    s_lshl_b32 s82, 15, s47
    s_and_b32 s75, s33, 3
    s_lshl_b32 s73, s34, 2
    s_add_u32 s75, s75, s73
    s_lshl_b32 s73, s75, 15
    s_lshl_b32 s79, s32, 13
    s_add_u32 s73, s73, s79
    s_add_u32 s73, s73, 10485760
    s_add_u32 s79, s79, 122880
    v_lshlrev_b32 v5, 2, v1
    v_lshlrev_b32 v6, 10, v1
    v_mov_b32 v2, 0
    v_add_u32 v14, 122880, v10
    s_mov_b32 s78, 0
    s_waitcnt vmcnt(0)
    s_mov_b64 exec, 15
    buffer_store_dword v3, v6, s[28:31], s48 offen sc0 sc1
    s_mov_b64 exec, 0xffff
    s_setprio 0
    v_mov_b32 v15, 155648
K2_spinw:
    ds_read_b32 v8, v15
    s_add_u32 s55, s55, 1
    s_waitcnt lgkmcnt(0)
    v_readfirstlane_b32 s47, v8
    s_bitcmp1_b32 s55, 23
    s_cbranch_scc1 K2_done
    s_and_b32 s47, s47, 0xff
    s_cmp_ge_u32 s47, 56
    s_cbranch_scc1 K2_spunw
    s_sleep 2
    s_branch K2_spinw
K2_spunw:
K2A_poll:
    buffer_load_dword v4, v5, s[28:31], s70 offen sc0 sc1
    ds_read_b32 v7, v13
    ds_read_b32 v8, v13 offset:12
    s_add_u32 s78, s78, 1
    s_waitcnt vmcnt(0) lgkmcnt(0)
    v_cmp_eq_u32 vcc, 0, v4
    v_readfirstlane_b32 s47, v7
    v_readfirstlane_b32 s83, v8
    s_cmp_ge_u32 s47, 0x10000
    s_cbranch_scc1 K2A_b
    s_and_b32 s47, vcc_lo, s82
    s_cbranch_scc1 K2A_notyet
    s_cmp_ge_u32 s83, 4
    s_cbranch_scc1 K2A_ready
    s_bitcmp1_b32 s78, 20
    s_cbranch_scc0 K2A_poll
K2A_notyet:
    s_cmp_lt_u32 s78, 2048
    s_cbranch_scc1 K2A_poll
    s_mov_b64 exec, 1
    buffer_store_dword v3, v2, s[28:31], s70 offen offset:64 sc0 sc1
    s_mov_b64 exec, 0xffff
    s_waitcnt vmcnt(0)
    buffer_load_dword v4, v5, s[28:31], s70 offen sc0 sc1
    s_mov_b32 s78, 0
    s_waitcnt vmcnt(0)
    v_cmp_eq_u32 vcc, 0, v4
    s_cbranch_vccz K2A_poll
    v_mov_b32 v8, 0x10000
    s_mov_b64 exec, 1
    ds_add_u32 v13, v8
    s_branch K2A_b
K2A_ready:
    s_mov_b64 exec, -1
    s_mov_b32 m0, s79
    s_add_u32 s72, s73, 4096
    buffer_load_dwordx4 v10, s[28:31], s73 offen offset:0 sc0 sc1 lds
    buffer_load_dwordx4 v10, s[28:31], s73 offen offset:1024 sc0 sc1 lds
    buffer_load_dwordx4 v10, s[28:31], s73 offen offset:2048 sc0 sc1 lds
    buffer_load_dwordx4 v10, s[28:31], s73 offen offset:3072 sc0 sc1 lds
    s_add_u32 m0, s79, 4096
    s_nop 0
    buffer_load_dwordx4 v10, s[28:31], s72 offen offset:0 sc0 sc1 lds
    buffer_load_dwordx4 v10, s[28:31], s72 offen offset:1024 sc0 sc1 lds
    buffer_load_dwordx4 v10, s[28:31], s72 offen offset:2048 sc0 sc1 lds
    buffer_load_dwordx4 v10, s[28:31], s72 offen offset:3072 sc0 sc1 lds
    s_bfe_u32 s84, s2, 0x10002
    s_lshl_b32 s84, s84, 3
    s_lshr_b32 s85, s2, 5
    s_add_u32 s84, s84, s85
    s_bfe_u32 s85, s2, 0x20003
    s_lshl_b32 s60, s84, 2
    s_add_u32 s60, s60, s85
    s_lshl_b32 s60, s60, 2
    s_add_u32 s60, s60, s32
    s_lshl_b32 s60, s60, 8
    s_add_u32 s60, s60, 14745600
    s_and_b32 s61, s2, 3
    s_lshl_b32 s64, 1, s61
    s_lshl_b32 s65, s84, 2
    s_add_u32 s65, s65, s32
    s_mul_i32 s62, s65, 28
    s_mul_i32 s63, s85, 7
    s_add_u32 s62, s62, s63
    s_lshl_b32 s62, s62, 12
    s_add_u32 s62, s62, 16777216
    s_lshl_b32 s63, s63, 5
    s_lshl_b32 s65, s65, 5
    v_and_b32 v16, 15, v1
    v_add_u32 v16, s65, v16
    s_mov_b32 s47, 1792
    v_mul_lo_u32 v16, v16, s47
    v_lshrrev_b32 v18, 5, v1
    v_lshlrev_b32 v18, 4, v18
    v_add_u32 v16, v16, v18
    v_add_u32 v16, s63, v16
    v_bfe_u32 v18, v1, 4, 1
    v_mul_u32_u24 v17, 28672, v18
    v_add_u32 v17, v17, v16
    v_lshlrev_b32 v18, 5, v18
    v_add_u32 v16, v16, v18
    s_mov_b32 s78, 0
    s_mov_b32 s66, 0
    s_waitcnt vmcnt(0)
    s_mov_b64 exec, 1
    ds_add_u32 v13, v3
    s_branch K2A_b2
K2A_b:
    s_mov_b64 exec, -1
    s_bfe_u32 s84, s2, 0x10002
    s_lshl_b32 s84, s84, 3
    s_lshr_b32 s85, s2, 5
    s_add_u32 s84, s84, s85
    s_bfe_u32 s85, s2, 0x20003
    s_lshl_b32 s60, s84, 2
    s_add_u32 s60, s60, s85
    s_lshl_b32 s60, s60, 2
    s_add_u32 s60, s60, s32
    s_lshl_b32 s60, s60, 8
    s_add_u32 s60, s60, 14745600
    s_and_b32 s61, s2, 3
    s_lshl_b32 s64, 1, s61
    s_lshl_b32 s65, s84, 2
    s_add_u32 s65, s65, s32
    s_mul_i32 s62, s65, 28
    s_mul_i32 s63, s85, 7
    s_add_u32 s62, s62, s63
    s_lshl_b32 s62, s62, 12
    s_add_u32 s62, s62, 16777216
    s_lshl_b32 s63, s63, 5
    s_lshl_b32 s65, s65, 5
    v_and_b32 v16, 15, v1
    v_add_u32 v16, s65, v16
    s_mov_b32 s47, 1792
    v_mul_lo_u32 v16, v16, s47
    v_lshrrev_b32 v18, 5, v1
    v_lshlrev_b32 v18, 4, v18
    v_add_u32 v16, v16, v18
    v_add_u32 v16, s63, v16
    v_bfe_u32 v18, v1, 4, 1
    v_mul_u32_u24 v17, 28672, v18
    v_add_u32 v17, v17, v16
    v_lshlrev_b32 v18, 5, v18
    v_add_u32 v16, v16, v18
    s_mov_b32 s78, 0
    s_mov_b32 s66, 0
K2A_b2:
    s_mov_b64 exec, 15
    buffer_load_dword v9, v6, s[28:31], s81 offen offset:64 sc0 sc1
    s_mov_b64 exec, -1
    s_lshl_b32 s47, s32, 2
    s_add_u32 s47, s47, 155712
    v_mov_b32 v15, s47
K2_spings:
    ds_read_b32 v8, v15
    s_add_u32 s55, s55, 1
    s_waitcnt lgkmcnt(0)
    v_readfirstlane_b32 s47, v8
    s_bitcmp1_b32 s55, 23
    s_cbranch_scc1 K2_done
    s_and_b32 s47, s47, 0xff
    s_cmp_ge_u32 s47, 1
    s_cbranch_scc1 K2_spungs
    s_sleep 1
    s_branch K2_spings
K2_spungs:
    v_add_u32 v11, 4096, v10
    s_lshl_b32 s47, s32, 11
    v_add_u32 v12, s47, v10
    s_mov_b64 exec, 0xff
K2B_poll:
    buffer_load_dword v4, v5, s[28:31], s60 offen sc0 sc1
    s_add_u32 s78, s78, 1
    s_waitcnt vmcnt(0)
    v_cmp_ne_u32 vcc, 0, v4
    s_and_b32 s47, vcc_lo, 15
    s_cmp_eq_u32 s47, 15
    s_cbranch_scc1 K2B_ready
    s_bitcmp1_b32 s78, 20
    s_cbranch_scc1 K2A_bdone
    s_cmp_lt_u32 s78, 2048
    s_cbranch_scc1 K2B_poll
    s_and_b32 s47, s47, s64
    s_cbranch_scc0 K2B_poll
    s_mov_b64 exec, -1
    ds_read_b128 v[32:35], v12
    ds_read_b128 v[36:39], v12 offset:1024
    s_mul_i32 s67, s61, 9216
    s_add_u32 s67, s67, s62
    s_waitcnt lgkmcnt(0)
    buffer_store_dwordx4 v[32:35], v10, s[28:31], s67 offen sc0 sc1
    s_cmp_eq_u32 s61, 3
    s_cbranch_scc1 K2B_pub1
    buffer_store_dwordx4 v[36:39], v11, s[28:31], s67 offen sc0 sc1
K2B_pub1:
    s_lshl_b32 s48, s61, 2
    s_add_u32 s48, s48, s60
    s_mov_b64 exec, 1
    s_waitcnt vmcnt(0)
    buffer_store_dword v3, v2, s[28:31], s48 offen offset:16 sc0 sc1
    s_mov_b64 exec, 0xff
    s_waitcnt vmcnt(0)
    buffer_load_dword v4, v5, s[28:31], s60 offen sc0 sc1
    s_waitcnt vmcnt(0)
    v_cmp_ne_u32 vcc, 0, v4
    s_and_b32 s47, vcc_lo, 15
    s_cmp_eq_u32 s47, 15
    s_cbranch_scc0 K2A_bdone
K2B_ready:
    buffer_load_dword v4, v5, s[28:31], s60 offen sc0 sc1
    s_mov_b64 exec, -1
K2B_piece:
    s_lshl_b32 s67, s61, 13
    s_add_u32 s67, s67, s62
    s_lshl_b32 s68, s61, 6
    s_add_u32 s69, s68, 28672
    s_add_u32 s47, s61, 0
    s_and_b32 s47, s47, 3
    s_lshl_b32 s56, s47, 10
    s_add_u32 s56, s56, s67
    s_bitcmp1_b32 s47, 1
    s_cselect_b32 s84, 0x80008000, 0
    s_add_u32 s47, s61, 1
    s_and_b32 s47, s47, 3
    s_lshl_b32 s57, s47, 10
    s_add_u32 s57, s57, s67
    s_bitcmp1_b32 s47, 1
    s_cselect_b32 s85, -1.0, 1.0
    s_add_u32 s47, s61, 2
    s_and_b32 s47, s47, 3
    s_lshl_b32 s58, s47, 10
    s_add_u32 s58, s58, s67
    s_bitcmp1_b32 s47, 1
    s_cselect_b32 s86, -1.0, 1.0
    s_add_u32 s47, s61, 3
    s_and_b32 s47, s47, 3
    s_lshl_b32 s59, s47, 10
    s_add_u32 s59, s59, s67
    s_bitcmp1_b32 s47, 1
    s_cselect_b32 s87, -1.0, 1.0
    s_bitcmp1_b32 s64, s61
    s_cbranch_scc1 K2B_own
    buffer_load_dwordx4 v[32:35], v10, s[28:31], s56 offen sc0 sc1
    s_cmp_eq_u32 s61, 3
    s_cbranch_scc1 K2B_rest
    buffer_load_dwordx4 v[48:51], v11, s[28:31], s56 offen sc0 sc1
    s_branch K2B_rest
K2B_own:
    ds_read_b128 v[32:35], v12
    ds_read_b128 v[48:51], v12 offset:1024
K2B_rest:
    buffer_load_dwordx4 v[36:39], v10, s[28:31], s57 offen sc0 sc1
    buffer_load_dwordx4 v[40:43], v10, s[28:31], s58 offen sc0 sc1
    buffer_load_dwordx4 v[44:47], v10, s[28:31], s59 offen sc0 sc1
    s_cmp_eq_u32 s61, 3
    s_cbranch_scc1 K2B_single
    buffer_load_dwordx4 v[52:55], v11, s[28:31], s57 offen sc0 sc1
    buffer_load_dwordx4 v[56:59], v11, s[28:31], s58 offen sc0 sc1
    buffer_load_dwordx4 v[60:63], v11, s[28:31], s59 offen sc0 sc1
    s_waitcnt vmcnt(6) lgkmcnt(0)
    v_xor_b32 v32, s84, v32
    v_lshlrev_b32 v100, 16, v32
    v_and_b32 v101, 0xffff0000, v32
    v_xor_b32 v33, s84, v33
    v_lshlrev_b32 v102, 16, v33
    v_and_b32 v103, 0xffff0000, v33
    v_xor_b32 v34, s84, v34
    v_lshlrev_b32 v104, 16, v34
    v_and_b32 v105, 0xffff0000, v34
    v_xor_b32 v35, s84, v35
    v_lshlrev_b32 v106, 16, v35
    v_and_b32 v107, 0xffff0000, v35
    v_xor_b32 v48, s84, v48
    v_lshlrev_b32 v108, 16, v48
    v_and_b32 v109, 0xffff0000, v48
    v_xor_b32 v49, s84, v49
    v_lshlrev_b32 v110, 16, v49
    v_and_b32 v111, 0xffff0000, v49
    v_xor_b32 v50, s84, v50
    v_lshlrev_b32 v112, 16, v50
    v_and_b32 v113, 0xffff0000, v50
    v_xor_b32 v51, s84, v51
    v_lshlrev_b32 v114, 16, v51
    v_and_b32 v115, 0xffff0000, v51
    s_waitcnt vmcnt(5)
    v_lshlrev_b32 v18, 16, v36
    v_and_b32 v19, 0xffff0000, v36
    v_fma_f32 v100, v18, s85, v100
    v_fma_f32 v101, v19, s85, v101
    v_lshlrev_b32 v18, 16, v37
    v_and_b32 v19, 0xffff0000, v37
    v_fma_f32 v102, v18, s85, v102
    v_fma_f32 v103, v19, s85, v103
    v_lshlrev_b32 v18, 16, v38
    v_and_b32 v19, 0xffff0000, v38
    v_fma_f32 v104, v18, s85, v104
    v_fma_f32 v105, v19, s85, v105
    v_lshlrev_b32 v18, 16, v39
    v_and_b32 v19, 0xffff0000, v39
    v_fma_f32 v106, v18, s85, v106
    v_fma_f32 v107, v19, s85, v107
    s_waitcnt vmcnt(4)
    v_lshlrev_b32 v18, 16, v40
    v_and_b32 v19, 0xffff0000, v40
    v_fma_f32 v100, v18, s86, v100
    v_fma_f32 v101, v19, s86, v101
    v_lshlrev_b32 v18, 16, v41
    v_and_b32 v19, 0xffff0000, v41
    v_fma_f32 v102, v18, s86, v102
    v_fma_f32 v103, v19, s86, v103
    v_lshlrev_b32 v18, 16, v42
    v_and_b32 v19, 0xffff0000, v42
    v_fma_f32 v104, v18, s86, v104
    v_fma_f32 v105, v19, s86, v105
    v_lshlrev_b32 v18, 16, v43
    v_and_b32 v19, 0xffff0000, v43
    v_fma_f32 v106, v18, s86, v106
    v_fma_f32 v107, v19, s86, v107
    s_waitcnt vmcnt(3)
    v_lshlrev_b32 v18, 16, v44
    v_and_b32 v19, 0xffff0000, v44
    v_fma_f32 v100, v18, s87, v100
    v_fma_f32 v101, v19, s87, v101
    v_lshlrev_b32 v18, 16, v45
    v_and_b32 v19, 0xffff0000, v45
    v_fma_f32 v102, v18, s87, v102
    v_fma_f32 v103, v19, s87, v103
    v_lshlrev_b32 v18, 16, v46
    v_and_b32 v19, 0xffff0000, v46
    v_fma_f32 v104, v18, s87, v104
    v_fma_f32 v105, v19, s87, v105
    v_lshlrev_b32 v18, 16, v47
    v_and_b32 v19, 0xffff0000, v47
    v_fma_f32 v106, v18, s87, v106
    v_fma_f32 v107, v19, s87, v107
    s_waitcnt vmcnt(2)
    v_lshlrev_b32 v18, 16, v52
    v_and_b32 v19, 0xffff0000, v52
    v_fma_f32 v108, v18, s85, v108
    v_fma_f32 v109, v19, s85, v109
    v_lshlrev_b32 v18, 16, v53
    v_and_b32 v19, 0xffff0000, v53
    v_fma_f32 v110, v18, s85, v110
    v_fma_f32 v111, v19, s85, v111
    v_lshlrev_b32 v18, 16, v54
    v_and_b32 v19, 0xffff0000, v54
    v_fma_f32 v112, v18, s85, v112
    v_fma_f32 v113, v19, s85, v113
    v_lshlrev_b32 v18, 16, v55
    v_and_b32 v19, 0xffff0000, v55
    v_fma_f32 v114, v18, s85, v114
    v_fma_f32 v115, v19, s85, v115
    s_waitcnt vmcnt(1)
    v_lshlrev_b32 v18, 16, v56
    v_and_b32 v19, 0xffff0000, v56
    v_fma_f32 v108, v18, s86, v108
    v_fma_f32 v109, v19, s86, v109
    v_lshlrev_b32 v18, 16, v57
    v_and_b32 v19, 0xffff0000, v57
    v_fma_f32 v110, v18, s86, v110
    v_fma_f32 v111, v19, s86, v111
    v_lshlrev_b32 v18, 16, v58
    v_and_b32 v19, 0xffff0000, v58
    v_fma_f32 v112, v18, s86, v112
    v_fma_f32 v113, v19, s86, v113
    v_lshlrev_b32 v18, 16, v59
    v_and_b32 v19, 0xffff0000, v59
    v_fma_f32 v114, v18, s86, v114
    v_fma_f32 v115, v19, s86, v115
    s_waitcnt vmcnt(0)
    v_lshlrev_b32 v18, 16, v60
    v_and_b32 v19, 0xffff0000, v60
    v_fma_f32 v108, v18, s87, v108
    v_fma_f32 v109, v19, s87, v109
    v_lshlrev_b32 v18, 16, v61
    v_and_b32 v19, 0xffff0000, v61
    v_fma_f32 v110, v18, s87, v110
    v_fma_f32 v111, v19, s87, v111
    v_lshlrev_b32 v18, 16, v62
    v_and_b32 v19, 0xffff0000, v62
    v_fma_f32 v112, v18, s87, v112
    v_fma_f32 v113, v19, s87, v113
    v_lshlrev_b32 v18, 16, v63
    v_and_b32 v19, 0xffff0000, v63
    v_fma_f32 v114, v18, s87, v114
    v_fma_f32 v115, v19, s87, v115
    v_cvt_pk_bf16_f32 v20, v100, v101
    v_cvt_pk_bf16_f32 v21, v102, v103
    v_cvt_pk_bf16_f32 v24, v104, v105
    v_cvt_pk_bf16_f32 v25, v106, v107
    v_cvt_pk_bf16_f32 v22, v108, v109
    v_cvt_pk_bf16_f32 v23, v110, v111
    v_cvt_pk_bf16_f32 v26, v112, v113
    v_cvt_pk_bf16_f32 v27, v114, v115
    s_nop 1
    v_permlane16_swap_b32 v20, v22
    v_permlane16_swap_b32 v21, v23
    v_permlane16_swap_b32 v24, v26
    v_permlane16_swap_b32 v25, v27
    s_nop 1
    buffer_store_dwordx4 v[20:23], v16, s[24:27], s68 offen offset:896 sc0 sc1
    buffer_store_dwordx4 v[24:27], v16, s[24:27], s69 offen offset:896 sc0 sc1
    s_branch K2B_next
K2B_single:
    s_waitcnt vmcnt(3) lgkmcnt(0)
    v_xor_b32 v32, s84, v32
    v_lshlrev_b32 v100, 16, v32
    v_and_b32 v101, 0xffff0000, v32
    v_xor_b32 v33, s84, v33
    v_lshlrev_b32 v102, 16, v33
    v_and_b32 v103, 0xffff0000, v33
    v_xor_b32 v34, s84, v34
    v_lshlrev_b32 v104, 16, v34
    v_and_b32 v105, 0xffff0000, v34
    v_xor_b32 v35, s84, v35
    v_lshlrev_b32 v106, 16, v35
    v_and_b32 v107, 0xffff0000, v35
    s_waitcnt vmcnt(2)
    v_lshlrev_b32 v18, 16, v36
    v_and_b32 v19, 0xffff0000, v36
    v_fma_f32 v100, v18, s85, v100
    v_fma_f32 v101, v19, s85, v101
    v_lshlrev_b32 v18, 16, v37
    v_and_b32 v19, 0xffff0000, v37
    v_fma_f32 v102, v18, s85, v102
    v_fma_f32 v103, v19, s85, v103
    v_lshlrev_b32 v18, 16, v38
    v_and_b32 v19, 0xffff0000, v38
    v_fma_f32 v104, v18, s85, v104
    v_fma_f32 v105, v19, s85, v105
    v_lshlrev_b32 v18, 16, v39
    v_and_b32 v19, 0xffff0000, v39
    v_fma_f32 v106, v18, s85, v106
    v_fma_f32 v107, v19, s85, v107
    s_waitcnt vmcnt(1)
    v_lshlrev_b32 v18, 16, v40
    v_and_b32 v19, 0xffff0000, v40
    v_fma_f32 v100, v18, s86, v100
    v_fma_f32 v101, v19, s86, v101
    v_lshlrev_b32 v18, 16, v41
    v_and_b32 v19, 0xffff0000, v41
    v_fma_f32 v102, v18, s86, v102
    v_fma_f32 v103, v19, s86, v103
    v_lshlrev_b32 v18, 16, v42
    v_and_b32 v19, 0xffff0000, v42
    v_fma_f32 v104, v18, s86, v104
    v_fma_f32 v105, v19, s86, v105
    v_lshlrev_b32 v18, 16, v43
    v_and_b32 v19, 0xffff0000, v43
    v_fma_f32 v106, v18, s86, v106
    v_fma_f32 v107, v19, s86, v107
    s_waitcnt vmcnt(0)
    v_lshlrev_b32 v18, 16, v44
    v_and_b32 v19, 0xffff0000, v44
    v_fma_f32 v100, v18, s87, v100
    v_fma_f32 v101, v19, s87, v101
    v_lshlrev_b32 v18, 16, v45
    v_and_b32 v19, 0xffff0000, v45
    v_fma_f32 v102, v18, s87, v102
    v_fma_f32 v103, v19, s87, v103
    v_lshlrev_b32 v18, 16, v46
    v_and_b32 v19, 0xffff0000, v46
    v_fma_f32 v104, v18, s87, v104
    v_fma_f32 v105, v19, s87, v105
    v_lshlrev_b32 v18, 16, v47
    v_and_b32 v19, 0xffff0000, v47
    v_fma_f32 v106, v18, s87, v106
    v_fma_f32 v107, v19, s87, v107
    v_cvt_pk_bf16_f32 v20, v100, v101
    v_cvt_pk_bf16_f32 v21, v102, v103
    v_cvt_pk_bf16_f32 v22, v104, v105
    v_cvt_pk_bf16_f32 v23, v106, v107
    s_nop 1
    v_permlane16_swap_b32 v20, v22
    v_permlane16_swap_b32 v21, v23
    s_nop 1
    buffer_store_dwordx4 v[20:23], v17, s[24:27], s68 offen offset:896 sc0 sc1
K2B_next:
    v_cmp_ne_u32 vcc, 0, v4
    s_bfe_u32 s47, vcc_lo, 0x40004
    s_bitset1_b32 s66, s61
    s_andn2_b32 s47, s47, s66
    s_cbranch_scc0 K2A_bdone
    s_ff1_i32_b32 s61, s47
    s_waitcnt vmcnt(0)
    s_branch K2B_piece
K2A_bdone:
    s_mov_b64 exec, 15
    v_cmp_ne_u32 vcc, 0, v9
    s_mov_b64 exec, -1
    s_mov_b32 s88, 0
    s_cbranch_vccz K2A_nomark
    s_mov_b32 s86, vcc_lo
    v_lshrrev_b32 v7, 4, v1
    v_lshlrev_b32 v7, 10, v7
    v_and_b32 v8, 15, v1
    v_lshlrev_b32 v8, 2, v8
    v_add_u32 v7, v7, v8
    buffer_load_dword v4, v7, s[28:31], s81 offen sc0 sc1
    s_waitcnt vmcnt(0)
    v_cmp_eq_u32 vcc, 0, v4
    s_bfe_u32 s47, vcc_lo, 1048576
    s_cmp_eq_u32 s47, 0
    s_cselect_b32 s47, 1, 0
    s_and_b32 s47, s47, s86
    s_lshl_b32 s47, s47, 0
    s_or_b32 s88, s88, s47
    s_bfe_u32 s47, vcc_lo, 1048592
    s_cmp_eq_u32 s47, 0
    s_cselect_b32 s47, 2, 0
    s_and_b32 s47, s47, s86
    s_lshl_b32 s47, s47, 3
    s_or_b32 s88, s88, s47
    s_bfe_u32 s47, vcc_hi, 1048576
    s_cmp_eq_u32 s47, 0
    s_cselect_b32 s47, 4, 0
    s_and_b32 s47, s47, s86
    s_lshl_b32 s47, s47, 6
    s_or_b32 s88, s88, s47
    s_bfe_u32 s47, vcc_hi, 1048592
    s_cmp_eq_u32 s47, 0
    s_cselect_b32 s47, 8, 0
    s_and_b32 s47, s47, s86
    s_lshl_b32 s47, s47, 9
    s_or_b32 s88, s88, s47
    s_lshl_b32 s88, s88, s80
K2A_nomark:
    v_mov_b32 v8, s88
    v_mov_b32 v15, 155704
    s_mov_b64 exec, 1
    ds_or_b32 v13, v8 offset:4
    ds_add_u32 v15, v3
    s_mov_b64 exec, -1
K2_spinx:
    ds_read_b32 v8, v15
    s_add_u32 s55, s55, 1
    s_waitcnt lgkmcnt(0)
    v_readfirstlane_b32 s47, v8
    s_bitcmp1_b32 s55, 23
    s_cbranch_scc1 K2_done
    s_and_b32 s47, s47, 0xff
    s_cmp_ge_u32 s47, 4
    s_cbranch_scc1 K2_spunx
    s_sleep 1
    s_branch K2_spinx
K2_spunx:
    ds_read_b32 v9, v13 offset:4
    s_waitcnt lgkmcnt(0)
    v_readfirstlane_b32 s88, v9
    s_mov_b32 s77, 0
    s_mov_b32 s76, 0
    s_cmp_eq_u32 s88, 0
    s_cbranch_scc1 K2_done
    v_mov_b32 v15, 155696
K2_spinx2:
    ds_read_b32 v8, v15
    s_add_u32 s55, s55, 1
    s_waitcnt lgkmcnt(0)
    v_readfirstlane_b32 s47, v8
    s_bitcmp1_b32 s55, 23
    s_cbranch_scc1 K2_done
    s_and_b32 s47, s47, 0xff
    s_cmp_ge_u32 s47, 4
    s_cbranch_scc1 K2_spunx2
    s_sleep 1
    s_branch K2_spinx2
K2_spunx2:
    v_mov_b32 v13, 155708
K2A_slow:
    s_andn2_b32 s47, s88, s76
    s_ff1_i32_b32 s71, s47
    s_lshr_b32 s74, s71, 2
    s_lshl_b32 s74, s74, 2
    s_add_u32 s74, s74, s32
    s_and_b32 s75, s71, 3
    s_lshl_b32 s73, s34, 2
    s_add_u32 s75, s75, s73
    s_lshl_b32 s72, s74, 15
    s_add_u32 s72, s72, 12582912
    s_cmp_ge_u32 s74, 14
    s_cbranch_scc1 K2A_nowob
    buffer_load_dwordx4 v[16:19], v10, s[28:31], s72 offen offset:0
    buffer_load_dwordx4 v[20:23], v10, s[28:31], s72 offen offset:1024
    buffer_load_dwordx4 v[24:27], v10, s[28:31], s72 offen offset:2048
    buffer_load_dwordx4 v[28:31], v10, s[28:31], s72 offen offset:3072
    s_add_u32 s72, s72, 4096
    buffer_load_dwordx4 v[32:35], v10, s[28:31], s72 offen offset:0
    buffer_load_dwordx4 v[36:39], v10, s[28:31], s72 offen offset:1024
    buffer_load_dwordx4 v[40:43], v10, s[28:31], s72 offen offset:2048
    buffer_load_dwordx4 v[44:47], v10, s[28:31], s72 offen offset:3072
    s_add_u32 s72, s72, 4096
    buffer_load_dwordx4 v[48:51], v10, s[28:31], s72 offen offset:0
    buffer_load_dwordx4 v[52:55], v10, s[28:31], s72 offen offset:1024
    buffer_load_dwordx4 v[56:59], v10, s[28:31], s72 offen offset:2048
    buffer_load_dwordx4 v[60:63], v10, s[28:31], s72 offen offset:3072
    s_add_u32 s72, s72, 4096
    buffer_load_dwordx4 v[64:67], v10, s[28:31], s72 offen offset:0
    buffer_load_dwordx4 v[68:71], v10, s[28:31], s72 offen offset:1024
    buffer_load_dwordx4 v[72:75], v10, s[28:31], s72 offen offset:2048
    buffer_load_dwordx4 v[76:79], v10, s[28:31], s72 offen offset:3072
    s_add_u32 s72, s72, 4096
    buffer_load_dwordx4 v[80:83], v10, s[28:31], s72 offen offset:0
    buffer_load_dwordx4 v[84:87], v10, s[28:31], s72 offen offset:1024
    buffer_load_dwordx4 v[88:91], v10, s[28:31], s72 offen offset:2048
    buffer_load_dwordx4 v[92:95], v10, s[28:31], s72 offen offset:3072
    s_add_u32 s72, s72, 4096
    buffer_load_dwordx4 v[112:115], v10, s[28:31], s72 offen offset:0
    buffer_load_dwordx4 v[116:119], v10, s[28:31], s72 offen offset:1024
    buffer_load_dwordx4 v[120:123], v10, s[28:31], s72 offen offset:2048
    buffer_load_dwordx4 v[124:127], v10, s[28:31], s72 offen offset:3072
    s_add_u32 s72, s72, 4096
    buffer_load_dwordx4 v[128:131], v10, s[28:31], s72 offen offset:0
    buffer_load_dwordx4 v[132:135], v10, s[28:31], s72 offen offset:1024
    buffer_load_dwordx4 v[136:139], v10, s[28:31], s72 offen offset:2048
    buffer_load_dwordx4 v[140:143], v10, s[28:31], s72 offen offset:3072
    s_add_u32 s72, s72, 4096
    buffer_load_dwordx4 v[144:147], v10, s[28:31], s72 offen offset:0
    buffer_load_dwordx4 v[148:151], v10, s[28:31], s72 offen offset:1024
    buffer_load_dwordx4 v[152:155], v10, s[28:31], s72 offen offset:2048
    buffer_load_dwordx4 v[156:159], v10, s[28:31], s72 offen offset:3072
    s_add_u32 s72, s72, 4096
K2A_nowob:
    s_lshl_b32 s73, s75, 15
    s_lshl_b32 s72, s32, 13
    s_add_u32 s73, s73, s72
    s_add_u32 s73, s73, 10485760
    v_and_b32 v224, 31, v1
    s_lshl_b32 s72, s75, 5
    v_add_u32 v224, s72, v224
    s_mov_b32 s72, 1792
    v_mul_lo_u32 v224, v224, s72
    v_lshrrev_b32 v225, 5, v1
    v_lshlrev_b32 v225, 4, v225
    v_add_u32 v224, v224, v225
    s_lshl_b32 s72, s74, 6
    v_add_u32 v224, s72, v224
    s_mov_b32 m0, s79
    s_add_u32 s72, s73, 4096
    buffer_load_dwordx4 v10, s[28:31], s73 offen offset:0 sc0 sc1 lds
    buffer_load_dwordx4 v10, s[28:31], s73 offen offset:1024 sc0 sc1 lds
    buffer_load_dwordx4 v10, s[28:31], s73 offen offset:2048 sc0 sc1 lds
    buffer_load_dwordx4 v10, s[28:31], s73 offen offset:3072 sc0 sc1 lds
    s_add_u32 m0, s79, 4096
    s_nop 0
    buffer_load_dwordx4 v10, s[28:31], s72 offen offset:0 sc0 sc1 lds
    buffer_load_dwordx4 v10, s[28:31], s72 offen offset:1024 sc0 sc1 lds
    buffer_load_dwordx4 v10, s[28:31], s72 offen offset:2048 sc0 sc1 lds
    buffer_load_dwordx4 v10, s[28:31], s72 offen offset:3072 sc0 sc1 lds
    s_add_u32 s77, s77, 4
    s_waitcnt vmcnt(0)
    s_mov_b64 exec, 1
    ds_add_u32 v13, v3
    s_mov_b64 exec, -1
K2_spiny:
    ds_read_b32 v8, v13
    s_add_u32 s55, s55, 1
    s_waitcnt lgkmcnt(0)
    v_readfirstlane_b32 s47, v8
    s_bitcmp1_b32 s55, 23
    s_cbranch_scc1 K2_done
    s_and_b32 s47, s47, 0xff
    s_cmp_ge_u32 s47, s77
    s_cbranch_scc1 K2_spuny
    s_sleep 1
    s_branch K2_spiny
K2_spuny:
    s_cmp_ge_u32 s74, 14
    s_cbranch_scc1 K2A_next
    ds_read_b128 v[160:163], v14 offset:0
    ds_read_b128 v[164:167], v14 offset:1024
    ds_read_b128 v[168:171], v14 offset:2048
    ds_read_b128 v[172:175], v14 offset:3072
    ds_read_b128 v[176:179], v14 offset:4096
    ds_read_b128 v[180:183], v14 offset:5120
    ds_read_b128 v[184:187], v14 offset:6144
    s_waitcnt lgkmcnt(6)
    v_mfma_f32_32x32x16_bf16 v[192:207], v[16:19], v[160:163], 0
    ds_read_b128 v[188:191], v14 offset:7168
    s_waitcnt lgkmcnt(6)
    v_mfma_f32_32x32x16_bf16 v[192:207], v[20:23], v[164:167], v[192:207]
    ds_read_b128 v[160:163], v14 offset:8192
    s_waitcnt lgkmcnt(6)
    v_mfma_f32_32x32x16_bf16 v[192:207], v[24:27], v[168:171], v[192:207]
    ds_read_b128 v[164:167], v14 offset:9216
    s_waitcnt lgkmcnt(6)
    v_mfma_f32_32x32x16_bf16 v[192:207], v[28:31], v[172:175], v[192:207]
    ds_read_b128 v[168:171], v14 offset:10240
    s_waitcnt lgkmcnt(6)
    v_mfma_f32_32x32x16_bf16 v[192:207], v[32:35], v[176:179], v[192:207]
    ds_read_b128 v[172:175], v14 offset:11264
    s_waitcnt lgkmcnt(6)
    v_mfma_f32_32x32x16_bf16 v[192:207], v[36:39], v[180:183], v[192:207]
    ds_read_b128 v[176:179], v14 offset:12288
    s_waitcnt lgkmcnt(6)
    v_mfma_f32_32x32x16_bf16 v[192:207], v[40:43], v[184:187], v[192:207]
    ds_read_b128 v[180:183], v14 offset:13312
    s_waitcnt lgkmcnt(6)
    v_mfma_f32_32x32x16_bf16 v[192:207], v[44:47], v[188:191], v[192:207]
    ds_read_b128 v[184:187], v14 offset:14336
    s_waitcnt lgkmcnt(6)
    v_mfma_f32_32x32x16_bf16 v[192:207], v[48:51], v[160:163], v[192:207]
    ds_read_b128 v[188:191], v14 offset:15360
    s_waitcnt lgkmcnt(6)
    v_mfma_f32_32x32x16_bf16 v[192:207], v[52:55], v[164:167], v[192:207]
    ds_read_b128 v[160:163], v14 offset:16384
    s_waitcnt lgkmcnt(6)
    v_mfma_f32_32x32x16_bf16 v[192:207], v[56:59], v[168:171], v[192:207]
    ds_read_b128 v[164:167], v14 offset:17408
    s_waitcnt lgkmcnt(6)
    v_mfma_f32_32x32x16_bf16 v[192:207], v[60:63], v[172:175], v[192:207]
    ds_read_b128 v[168:171], v14 offset:18432
    s_waitcnt lgkmcnt(6)
    v_mfma_f32_32x32x16_bf16 v[192:207], v[64:67], v[176:179], v[192:207]
    ds_read_b128 v[172:175], v14 offset:19456
    s_waitcnt lgkmcnt(6)
    v_mfma_f32_32x32x16_bf16 v[192:207], v[68:71], v[180:183], v[192:207]
    ds_read_b128 v[176:179], v14 offset:20480
    s_waitcnt lgkmcnt(6)
    v_mfma_f32_32x32x16_bf16 v[192:207], v[72:75], v[184:187], v[192:207]
    ds_read_b128 v[180:183], v14 offset:21504
    s_waitcnt lgkmcnt(6)
    v_mfma_f32_32x32x16_bf16 v[192:207], v[76:79], v[188:191], v[192:207]
    ds_read_b128 v[184:187], v14 offset:22528
    s_waitcnt lgkmcnt(6)
    v_mfma_f32_32x32x16_bf16 v[192:207], v[80:83], v[160:163], v[192:207]
    ds_read_b128 v[188:191], v14 offset:23552
    s_waitcnt lgkmcnt(6)
    v_mfma_f32_32x32x16_bf16 v[192:207], v[84:87], v[164:167], v[192:207]
    ds_read_b128 v[160:163], v14 offset:24576
    s_waitcnt lgkmcnt(6)
    v_mfma_f32_32x32x16_bf16 v[192:207], v[88:91], v[168:171], v[192:207]
    ds_read_b128 v[164:167], v14 offset:25600
    s_waitcnt lgkmcnt(6)
    v_mfma_f32_32x32x16_bf16 v[192:207], v[92:95], v[172:175], v[192:207]
    ds_read_b128 v[168:171], v14 offset:26624
    s_waitcnt lgkmcnt(6)
    v_mfma_f32_32x32x16_bf16 v[192:207], v[112:115], v[176:179], v[192:207]
    ds_read_b128 v[172:175], v14 offset:27648
    s_waitcnt lgkmcnt(6)
    v_mfma_f32_32x32x16_bf16 v[192:207], v[116:119], v[180:183], v[192:207]
    ds_read_b128 v[176:179], v14 offset:28672
    s_waitcnt lgkmcnt(6)
    v_mfma_f32_32x32x16_bf16 v[192:207], v[120:123], v[184:187], v[192:207]
    ds_read_b128 v[180:183], v14 offset:29696
    s_waitcnt lgkmcnt(6)
    v_mfma_f32_32x32x16_bf16 v[192:207], v[124:127], v[188:191], v[192:207]
    ds_read_b128 v[184:187], v14 offset:30720
    s_waitcnt lgkmcnt(6)
    v_mfma_f32_32x32x16_bf16 v[192:207], v[128:131], v[160:163], v[192:207]
    ds_read_b128 v[188:191], v14 offset:31744
    s_waitcnt lgkmcnt(6)
    v_mfma_f32_32x32x16_bf16 v[192:207], v[132:135], v[164:167], v[192:207]
    s_waitcnt lgkmcnt(5)
    v_mfma_f32_32x32x16_bf16 v[192:207], v[136:139], v[168:171], v[192:207]
    s_waitcnt lgkmcnt(4)
    v_mfma_f32_32x32x16_bf16 v[192:207], v[140:143], v[172:175], v[192:207]
    s_waitcnt lgkmcnt(3)
    v_mfma_f32_32x32x16_bf16 v[192:207], v[144:147], v[176:179], v[192:207]
    s_waitcnt lgkmcnt(2)
    v_mfma_f32_32x32x16_bf16 v[192:207], v[148:151], v[180:183], v[192:207]
    s_waitcnt lgkmcnt(1)
    v_mfma_f32_32x32x16_bf16 v[192:207], v[152:155], v[184:187], v[192:207]
    s_waitcnt lgkmcnt(0)
    v_mfma_f32_32x32x16_bf16 v[192:207], v[156:159], v[188:191], v[192:207]
    s_nop 15
    v_cvt_pk_bf16_f32 v208, v192, v193
    v_cvt_pk_bf16_f32 v209, v194, v195
    v_cvt_pk_bf16_f32 v210, v196, v197
    v_cvt_pk_bf16_f32 v211, v198, v199
    v_cvt_pk_bf16_f32 v212, v200, v201
    v_cvt_pk_bf16_f32 v213, v202, v203
    v_cvt_pk_bf16_f32 v214, v204, v205
    v_cvt_pk_bf16_f32 v215, v206, v207
    s_nop 1
    v_permlane32_swap_b32 v208, v210
    v_permlane32_swap_b32 v209, v211
    v_permlane32_swap_b32 v212, v214
    v_permlane32_swap_b32 v213, v215
    s_nop 1
    buffer_store_dwordx4 v[208:211], v224, s[24:27], 0 offen offset:0 sc0 sc1
    buffer_store_dwordx4 v[212:215], v224, s[24:27], 0 offen offset:32 sc0 sc1
K2A_next:
    s_bitset1_b32 s76, s71
    s_andn2_b32 s47, s88, s76
    s_cbranch_scc0 K2_done
    s_add_u32 s77, s77, 4
    s_mov_b64 exec, 1
    ds_add_u32 v13, v3
    s_mov_b64 exec, -1
K2_spinz:
    ds_read_b32 v8, v13
    s_add_u32 s55, s55, 1
    s_waitcnt lgkmcnt(0)
    v_readfirstlane_b32 s47, v8
    s_bitcmp1_b32 s55, 23
    s_cbranch_scc1 K2_done
    s_and_b32 s47, s47, 0xff
    s_cmp_ge_u32 s47, s77
    s_cbranch_scc1 K2_spunz
    s_sleep 1
    s_branch K2_spinz
K2_spunz:
    s_branch K2A_slow
K2A_recentre:
    s_nop 15
    s_nop 15
    v_mov_b32 v2, v188
    v_mov_b32 v3, v188
    s_nop 1
    v_permlane32_swap_b32 v2, v3
    s_nop 1
    v_log_f32 v2, v3
    s_nop 0
    v_add_f32 v2, 64.0, v2
    v_max_f32 v2, 0, v2
    v_min_f32 v2, 0x43700000, v2
    v_add_f32 v3, v11, v2
    v_sub_f32 v2, v3, v11
    v_mov_b32 v11, v3
    v_mul_f32 v4, -0.5, v2
    v_exp_f32 v4, v4
    v_sub_f32 v80, v80, v2
    v_sub_f32 v81, v81, v2
    v_sub_f32 v82, v82, v2
    v_sub_f32 v83, v83, v2
    v_sub_f32 v84, v84, v2
    v_sub_f32 v85, v85, v2
    v_sub_f32 v86, v86, v2
    v_sub_f32 v87, v87, v2
    v_sub_f32 v88, v88, v2
    v_sub_f32 v89, v89, v2
    v_sub_f32 v90, v90, v2
    v_sub_f32 v91, v91, v2
    v_sub_f32 v92, v92, v2
    v_sub_f32 v93, v93, v2
    v_sub_f32 v94, v94, v2
    v_sub_f32 v95, v95, v2
    v_mul_f32 v176, v176, v4
    v_mul_f32 v176, v176, v4
    v_mul_f32 v177, v177, v4
    v_mul_f32 v177, v177, v4
    v_mul_f32 v178, v178, v4
    v_mul_f32 v178, v178, v4
    v_mul_f32 v179, v179, v4
    v_mul_f32 v179, v179, v4
    v_mul_f32 v180, v180, v4
    v_mul_f32 v180, v180, v4
    v_mul_f32 v181, v181, v4
    v_mul_f32 v181, v181, v4
    v_mul_f32 v182, v182, v4
    v_mul_f32 v182, v182, v4
    v_mul_f32 v183, v183, v4
    v_mul_f32 v183, v183, v4
    v_mul_f32 v184, v184, v4
    v_mul_f32 v184, v184, v4
    v_mul_f32 v185, v185, v4
    v_mul_f32 v185, v185, v4
    v_mul_f32 v186, v186, v4
    v_mul_f32 v186, v186, v4
    v_mul_f32 v187, v187, v4
    v_mul_f32 v187, v187, v4
    v_mul_f32 v188, v188, v4
    v_mul_f32 v188, v188, v4
    v_mul_f32 v189, v189, v4
    v_mul_f32 v189, v189, v4
    v_mul_f32 v190, v190, v4
    v_mul_f32 v190, v190, v4
    v_mul_f32 v191, v191, v4
    v_mul_f32 v191, v191, v4
    v_sub_f32 v5, 0, v11
    v_cvt_pk_bf16_f32 v6, 0, v5
    v_sub_f32 v5, v5, v6
    v_cvt_pk_bf16_f32 v7, 0, v5
    v_sub_f32 v5, v5, v7
    v_cvt_pk_bf16_f32 v8, v5, 0
    v_lshrrev_b32 v6, 16, v6
    v_or_b32 v6, v6, v7
    v_cndmask_b32 v22, v22, v6, s[62:63]
    v_cndmask_b32 v23, v23, v8, s[62:63]
    v_mov_b32 v2, v204
    v_mov_b32 v3, v204
    s_nop 1
    v_permlane32_swap_b32 v2, v3
    s_nop 1
    v_log_f32 v2, v3
    s_nop 0
    v_add_f32 v2, 64.0, v2
    v_max_f32 v2, 0, v2
    v_min_f32 v2, 0x43700000, v2
    v_add_f32 v3, v12, v2
    v_sub_f32 v2, v3, v12
    v_mov_b32 v12, v3
    v_mul_f32 v4, -0.5, v2
    v_exp_f32 v4, v4
    v_sub_f32 v96, v96, v2
    v_sub_f32 v97, v97, v2
    v_sub_f32 v98, v98, v2
    v_sub_f32 v99, v99, v2
    v_sub_f32 v100, v100, v2
    v_sub_f32 v101, v101, v2
    v_sub_f32 v102, v102, v2
    v_sub_f32 v103, v103, v2
    v_sub_f32 v104, v104, v2
    v_sub_f32 v105, v105, v2
    v_sub_f32 v106, v106, v2
    v_sub_f32 v107, v107, v2
    v_sub_f32 v108, v108, v2
    v_sub_f32 v109, v109, v2
    v_sub_f32 v110, v110, v2
    v_sub_f32 v111, v111, v2
    v_mul_f32 v192, v192, v4
    v_mul_f32 v192, v192, v4
    v_mul_f32 v193, v193, v4
    v_mul_f32 v193, v193, v4
    v_mul_f32 v194, v194, v4
    v_mul_f32 v194, v194, v4
    v_mul_f32 v195, v195, v4
    v_mul_f32 v195, v195, v4
    v_mul_f32 v196, v196, v4
    v_mul_f32 v196, v196, v4
    v_mul_f32 v197, v197, v4
    v_mul_f32 v197, v197, v4
    v_mul_f32 v198, v198, v4
    v_mul_f32 v198, v198, v4
    v_mul_f32 v199, v199, v4
    v_mul_f32 v199, v199, v4
    v_mul_f32 v200, v200, v4
    v_mul_f32 v200, v200, v4
    v_mul_f32 v201, v201, v4
    v_mul_f32 v201, v201, v4
    v_mul_f32 v202, v202, v4
    v_mul_f32 v202, v202, v4
    v_mul_f32 v203, v203, v4
    v_mul_f32 v203, v203, v4
    v_mul_f32 v204, v204, v4
    v_mul_f32 v204, v204, v4
    v_mul_f32 v205, v205, v4
    v_mul_f32 v205, v205, v4
    v_mul_f32 v206, v206, v4
    v_mul_f32 v206, v206, v4
    v_mul_f32 v207, v207, v4
    v_mul_f32 v207, v207, v4
    v_sub_f32 v5, 0, v12
    v_cvt_pk_bf16_f32 v6, 0, v5
    v_sub_f32 v5, v5, v6
    v_cvt_pk_bf16_f32 v7, 0, v5
    v_sub_f32 v5, v5, v7
    v_cvt_pk_bf16_f32 v8, v5, 0
    v_lshrrev_b32 v6, 16, v6
    v_or_b32 v6, v6, v7
    v_cndmask_b32 v30, v30, v6, s[62:63]
    v_cndmask_b32 v31, v31, v8, s[62:63]
    v_mov_b32 v2, v220
    v_mov_b32 v3, v220
    s_nop 1
    v_permlane32_swap_b32 v2, v3
    s_nop 1
    v_log_f32 v2, v3
    s_nop 0
    v_add_f32 v2, 64.0, v2
    v_max_f32 v2, 0, v2
    v_min_f32 v2, 0x43700000, v2
    v_add_f32 v3, v13, v2
    v_sub_f32 v2, v3, v13
    v_mov_b32 v13, v3
    v_mul_f32 v4, -0.5, v2
    v_exp_f32 v4, v4
    v_sub_f32 v112, v112, v2
    v_sub_f32 v113, v113, v2
    v_sub_f32 v114, v114, v2
    v_sub_f32 v115, v115, v2
    v_sub_f32 v116, v116, v2
    v_sub_f32 v117, v117, v2
    v_sub_f32 v118, v118, v2
    v_sub_f32 v119, v119, v2
    v_sub_f32 v120, v120, v2
    v_sub_f32 v121, v121, v2
    v_sub_f32 v122, v122, v2
    v_sub_f32 v123, v123, v2
    v_sub_f32 v124, v124, v2
    v_sub_f32 v125, v125, v2
    v_sub_f32 v126, v126, v2
    v_sub_f32 v127, v127, v2
    v_mul_f32 v208, v208, v4
    v_mul_f32 v208, v208, v4
    v_mul_f32 v209, v209, v4
    v_mul_f32 v209, v209, v4
    v_mul_f32 v210, v210, v4
    v_mul_f32 v210, v210, v4
    v_mul_f32 v211, v211, v4
    v_mul_f32 v211, v211, v4
    v_mul_f32 v212, v212, v4
    v_mul_f32 v212, v212, v4
    v_mul_f32 v213, v213, v4
    v_mul_f32 v213, v213, v4
    v_mul_f32 v214, v214, v4
    v_mul_f32 v214, v214, v4
    v_mul_f32 v215, v215, v4
    v_mul_f32 v215, v215, v4
    v_mul_f32 v216, v216, v4
    v_mul_f32 v216, v216, v4
    v_mul_f32 v217, v217, v4
    v_mul_f32 v217, v217, v4
    v_mul_f32 v218, v218, v4
    v_mul_f32 v218, v218, v4
    v_mul_f32 v219, v219, v4
    v_mul_f32 v219, v219, v4
    v_mul_f32 v220, v220, v4
    v_mul_f32 v220, v220, v4
    v_mul_f32 v221, v221, v4
    v_mul_f32 v221, v221, v4
    v_mul_f32 v222, v222, v4
    v_mul_f32 v222, v222, v4
    v_mul_f32 v223, v223, v4
    v_mul_f32 v223, v223, v4
    v_sub_f32 v5, 0, v13
    v_cvt_pk_bf16_f32 v6, 0, v5
    v_sub_f32 v5, v5, v6
    v_cvt_pk_bf16_f32 v7, 0, v5
    v_sub_f32 v5, v5, v7
    v_cvt_pk_bf16_f32 v8, v5, 0
    v_lshrrev_b32 v6, 16, v6
    v_or_b32 v6, v6, v7
    v_cndmask_b32 v38, v38, v6, s[62:63]
    v_cndmask_b32 v39, v39, v8, s[62:63]
    v_exp_f32 v240, v112
    v_exp_f32 v241, v113
    v_exp_f32 v242, v114
    v_exp_f32 v243, v115
    v_exp_f32 v244, v116
    v_exp_f32 v245, v117
    v_exp_f32 v246, v118
    v_exp_f32 v247, v119
    s_nop 0
    v_cvt_pk_bf16_f32 v160, v240, v241
    v_cvt_pk_bf16_f32 v161, v242, v243
    v_cvt_pk_bf16_f32 v162, v244, v245
    v_cvt_pk_bf16_f32 v163, v246, v247
    v_exp_f32 v240, v120
    v_exp_f32 v241, v121
    v_exp_f32 v242, v122
    v_exp_f32 v243, v123
    v_exp_f32 v244, v124
    v_exp_f32 v245, v125
    v_exp_f32 v246, v126
    v_exp_f32 v247, v127
    s_nop 0
    v_cvt_pk_bf16_f32 v164, v240, v241
    v_cvt_pk_bf16_f32 v165, v242, v243
    v_cvt_pk_bf16_f32 v166, v244, v245
    v_cvt_pk_bf16_f32 v167, v246, v247
    v_mov_b32 v2, v236
    v_mov_b32 v3, v236
    s_nop 1
    v_permlane32_swap_b32 v2, v3
    s_nop 1
    v_log_f32 v2, v3
    s_nop 0
    v_add_f32 v2, 64.0, v2
    v_max_f32 v2, 0, v2
    v_min_f32 v2, 0x43700000, v2
    v_add_f32 v3, v14, v2
    v_sub_f32 v2, v3, v14
    v_mov_b32 v14, v3
    v_mul_f32 v4, -0.5, v2
    v_exp_f32 v4, v4
    v_sub_f32 v128, v128, v2
    v_sub_f32 v129, v129, v2
    v_sub_f32 v130, v130, v2
    v_sub_f32 v131, v131, v2
    v_sub_f32 v132, v132, v2
    v_sub_f32 v133, v133, v2
    v_sub_f32 v134, v134, v2
    v_sub_f32 v135, v135, v2
    v_sub_f32 v136, v136, v2
    v_sub_f32 v137, v137, v2
    v_sub_f32 v138, v138, v2
    v_sub_f32 v139, v139, v2
    v_sub_f32 v140, v140, v2
    v_sub_f32 v141, v141, v2
    v_sub_f32 v142, v142, v2
    v_sub_f32 v143, v143, v2
    v_mul_f32 v224, v224, v4
    v_mul_f32 v224, v224, v4
    v_mul_f32 v225, v225, v4
    v_mul_f32 v225, v225, v4
    v_mul_f32 v226, v226, v4
    v_mul_f32 v226, v226, v4
    v_mul_f32 v227, v227, v4
    v_mul_f32 v227, v227, v4
    v_mul_f32 v228, v228, v4
    v_mul_f32 v228, v228, v4
    v_mul_f32 v229, v229, v4
    v_mul_f32 v229, v229, v4
    v_mul_f32 v230, v230, v4
    v_mul_f32 v230, v230, v4
    v_mul_f32 v231, v231, v4
    v_mul_f32 v231, v231, v4
    v_mul_f32 v232, v232, v4
    v_mul_f32 v232, v232, v4
    v_mul_f32 v233, v233, v4
    v_mul_f32 v233, v233, v4
    v_mul_f32 v234, v234, v4
    v_mul_f32 v234, v234, v4
    v_mul_f32 v235, v235, v4
    v_mul_f32 v235, v235, v4
    v_mul_f32 v236, v236, v4
    v_mul_f32 v236, v236, v4
    v_mul_f32 v237, v237, v4
    v_mul_f32 v237, v237, v4
    v_mul_f32 v238, v238, v4
    v_mul_f32 v238, v238, v4
    v_mul_f32 v239, v239, v4
    v_mul_f32 v239, v239, v4
    v_sub_f32 v5, 0, v14
    v_cvt_pk_bf16_f32 v6, 0, v5
    v_sub_f32 v5, v5, v6
    v_cvt_pk_bf16_f32 v7, 0, v5
    v_sub_f32 v5, v5, v7
    v_cvt_pk_bf16_f32 v8, v5, 0
    v_lshrrev_b32 v6, 16, v6
    v_or_b32 v6, v6, v7
    v_cndmask_b32 v46, v46, v6, s[62:63]
    v_cndmask_b32 v47, v47, v8, s[62:63]
    v_exp_f32 v240, v128
    v_exp_f32 v241, v129
    v_exp_f32 v242, v130
    v_exp_f32 v243, v131
    v_exp_f32 v244, v132
    v_exp_f32 v245, v133
    v_exp_f32 v246, v134
    v_exp_f32 v247, v135
    s_nop 0
    v_cvt_pk_bf16_f32 v168, v240, v241
    v_cvt_pk_bf16_f32 v169, v242, v243
    v_cvt_pk_bf16_f32 v170, v244, v245
    v_cvt_pk_bf16_f32 v171, v246, v247
    v_exp_f32 v240, v136
    v_exp_f32 v241, v137
    v_exp_f32 v242, v138
    v_exp_f32 v243, v139
    v_exp_f32 v244, v140
    v_exp_f32 v245, v141
    v_exp_f32 v246, v142
    v_exp_f32 v247, v143
    s_nop 0
    v_cvt_pk_bf16_f32 v172, v240, v241
    v_cvt_pk_bf16_f32 v173, v242, v243
    v_cvt_pk_bf16_f32 v174, v244, v245
    v_cvt_pk_bf16_f32 v175, v246, v247
    s_nop 3
    s_branch K2A_back
K2A_fallback:
    s_mov_b32 s52, 1
    s_mov_b32 s42, s50
    s_mov_b32 s44, 16
    v_mov_b32 v6, 0xff800000
    v_mov_b32 v7, 0xff800000
    v_mov_b32 v8, 0xff800000
    v_mov_b32 v9, 0xff800000
    s_waitcnt vmcnt(0)
K2A_fbloop:
    buffer_load_dwordx4 v[48:51], v10, s[28:31], s42 offen
    buffer_load_dwordx4 v[52:55], v10, s[28:31], s42 offen offset:1024
    s_add_u32 s42, s42, 2048
    s_waitcnt vmcnt(0)
    v_mfma_f32_32x32x16_bf16 v[80:95], v[48:51], v[16:19], 0
    v_mfma_f32_32x32x16_bf16 v[80:95], v[52:55], v[20:23], v[80:95]
    v_mfma_f32_32x32x16_bf16 v[96:111], v[48:51], v[24:27], 0
    v_mfma_f32_32x32x16_bf16 v[96:111], v[52:55], v[28:31], v[96:111]
    v_mfma_f32_32x32x16_bf16 v[112:127], v[48:51], v[32:35], 0
    v_mfma_f32_32x32x16_bf16 v[112:127], v[52:55], v[36:39], v[112:127]
    v_mfma_f32_32x32x16_bf16 v[128:143], v[48:51], v[40:43], 0
    v_mfma_f32_32x32x16_bf16 v[128:143], v[52:55], v[44:47], v[128:143]
    s_nop 15
    s_nop 3
    v_max3_f32 v6, v6, v80, v81
    v_max3_f32 v6, v6, v82, v83
    v_max3_f32 v6, v6, v84, v85
    v_max3_f32 v6, v6, v86, v87
    v_max3_f32 v6, v6, v88, v89
    v_max3_f32 v6, v6, v90, v91
    v_max3_f32 v6, v6, v92, v93
    v_max3_f32 v6, v6, v94, v95
    v_max3_f32 v7, v7, v96, v97
    v_max3_f32 v7, v7, v98, v99
    v_max3_f32 v7, v7, v100, v101
    v_max3_f32 v7, v7, v102, v103
    v_max3_f32 v7, v7, v104, v105
    v_max3_f32 v7, v7, v106, v107
    v_max3_f32 v7, v7, v108, v109
    v_max3_f32 v7, v7, v110, v111
    v_max3_f32 v8, v8, v112, v113
    v_max3_f32 v8, v8, v114, v115
    v_max3_f32 v8, v8, v116, v117
    v_max3_f32 v8, v8, v118, v119
    v_max3_f32 v8, v8, v120, v121
    v_max3_f32 v8, v8, v122, v123
    v_max3_f32 v8, v8, v124, v125
    v_max3_f32 v8, v8, v126, v127
    v_max3_f32 v9, v9, v128, v129
    v_max3_f32 v9, v9, v130, v131
    v_max3_f32 v9, v9, v132, v133
    v_max3_f32 v9, v9, v134, v135
    v_max3_f32 v9, v9, v136, v137
    v_max3_f32 v9, v9, v138, v139
    v_max3_f32 v9, v9, v140, v141
    v_max3_f32 v9, v9, v142, v143
    s_sub_u32 s44, s44, 1
    s_cmp_lg_u32 s44, 0
    s_cbranch_scc1 K2A_fbloop
    v_mov_b32 v2, v6
    s_nop 1
    v_permlane32_swap_b32 v6, v2
    s_nop 1
    v_max_f32 v6, v6, v2
    v_add_f32 v11, v11, v6
    v_sub_f32 v2, 0, v11
    v_cvt_pk_bf16_f32 v3, 0, v2
    v_sub_f32 v2, v2, v3
    v_cvt_pk_bf16_f32 v4, 0, v2
    v_sub_f32 v2, v2, v4
    v_cvt_pk_bf16_f32 v5, v2, 0
    v_lshrrev_b32 v3, 16, v3
    v_or_b32 v3, v3, v4
    v_cndmask_b32 v22, v22, v3, s[62:63]
    v_cndmask_b32 v23, v23, v5, s[62:63]
    v_mov_b32 v2, v7
    s_nop 1
    v_permlane32_swap_b32 v7, v2
    s_nop 1
    v_max_f32 v7, v7, v2
    v_add_f32 v12, v12, v7
    v_sub_f32 v2, 0, v12
    v_cvt_pk_bf16_f32 v3, 0, v2
    v_sub_f32 v2, v2, v3
    v_cvt_pk_bf16_f32 v4, 0, v2
    v_sub_f32 v2, v2, v4
    v_cvt_pk_bf16_f32 v5, v2, 0
    v_lshrrev_b32 v3, 16, v3
    v_or_b32 v3, v3, v4
    v_cndmask_b32 v30, v30, v3, s[62:63]
    v_cndmask_b32 v31, v31, v5, s[62:63]
    v_mov_b32 v2, v8
    s_nop 1
    v_permlane32_swap_b32 v8, v2
    s_nop 1
    v_max_f32 v8, v8, v2
    v_add_f32 v13, v13, v8
    v_sub_f32 v2, 0, v13
    v_cvt_pk_bf16_f32 v3, 0, v2
    v_sub_f32 v2, v2, v3
    v_cvt_pk_bf16_f32 v4, 0, v2
    v_sub_f32 v2, v2, v4
    v_cvt_pk_bf16_f32 v5, v2, 0
    v_lshrrev_b32 v3, 16, v3
    v_or_b32 v3, v3, v4
    v_cndmask_b32 v38, v38, v3, s[62:63]
    v_cndmask_b32 v39, v39, v5, s[62:63]
    v_mov_b32 v2, v9
    s_nop 1
    v_permlane32_swap_b32 v9, v2
    s_nop 1
    v_max_f32 v9, v9, v2
    v_add_f32 v14, v14, v9
    v_sub_f32 v2, 0, v14
    v_cvt_pk_bf16_f32 v3, 0, v2
    v_sub_f32 v2, v2, v3
    v_cvt_pk_bf16_f32 v4, 0, v2
    v_sub_f32 v2, v2, v4
    v_cvt_pk_bf16_f32 v5, v2, 0
    v_lshrrev_b32 v3, 16, v3
    v_or_b32 v3, v3, v4
    v_cndmask_b32 v46, v46, v3, s[62:63]
    v_cndmask_b32 v47, v47, v5, s[62:63]
    s_nop 3
    s_branch K2A_restart
K2_gemm:
    s_bfe_u32 s33, s2, 0x10001
    s_and_b32 s34, s2, 1
    s_bfe_u32 s35, s2, 0x10002
    s_lshl_b32 s35, s35, 3
    s_lshr_b32 s37, s2, 5
    s_add_u32 s35, s35, s37
    s_bfe_u32 s36, s2, 0x20003
    s_sub_u32 s54, s32, 4
    s_cmp_eq_u32 s33, 0
    s_cselect_b32 s38, s4, s6
    s_cselect_b32 s39, s5, s7
    s_mov_b32 s20, s38
    s_and_b32 s21, s39, 0xffff
    s_mov_b32 s22, 8388608
    s_mov_b32 s23, 0x00020000
    s_lshl_b32 s37, s35, 7
    s_lshl_b32 s38, s54, 5
    s_add_u32 s37, s37, s38
    v_lshrrev_b32 v2, 3, v1
    v_add_u32 v2, s37, v2
    s_mov_b32 s60, 4096
    v_mul_lo_u32 v2, v2, s60
    v_lshrrev_b32 v3, 4, v1
    v_and_b32 v4, 7, v1
    v_xor_b32 v5, v4, v3
    v_lshlrev_b32 v5, 4, v5
    v_add_u32 v10, v2, v5
    v_add_u32 v3, 4, v3
    v_xor_b32 v5, v4, v3
    v_lshlrev_b32 v5, 4, v5
    v_add_u32 v11, v2, v5
    v_add_u32 v11, 32768, v11
    v_lshlrev_b32 v12, 4, v1
    s_lshl_b32 s44, s34, 11
    s_add_u32 s45, s44, 63488
    v_subrev_u32 v11, 1024, v11
    s_lshl_b32 s42, s33, 2
    s_add_u32 s42, s42, s36
    s_lshl_b32 s42, s42, 5
    s_lshl_b32 s43, s34, 4
    s_add_u32 s42, s42, s43
    s_mul_i32 s42, s42, 14336
    s_lshl_b32 s53, s54, 2
    s_min_u32 s53, s53, 10
    s_lshl_b32 s53, s53, 10
    s_add_u32 s42, s42, s53
    s_add_u32 s42, s42, 6291456
    s_add_u32 s53, s53, 16384
    s_lshl_b32 s52, s54, 12
    s_add_u32 s44, s44, 256
    s_add_u32 s45, s45, 256
    s_barrier
    v_mov_b32 v2, 155768
    ds_read_b32 v9, v2
    s_waitcnt lgkmcnt(0)
    v_readfirstlane_b32 s48, v9
    s_cmp_lg_u32 s48, 0
    s_cbranch_scc1 M_help
    s_add_u32 m0, s53, 0
    s_nop 0
    buffer_load_dwordx4 v12, s[28:31], s42 offen offset:0 lds
    buffer_load_dwordx4 v12, s[28:31], s42 offen offset:1024 lds
    buffer_load_dwordx4 v12, s[28:31], s42 offen offset:2048 lds
    buffer_load_dwordx4 v12, s[28:31], s42 offen offset:3072 lds
    s_add_u32 s42, s42, 14336
    s_add_u32 m0, s53, 30720
    s_nop 0
    buffer_load_dwordx4 v12, s[28:31], s42 offen offset:0 lds
    buffer_load_dwordx4 v12, s[28:31], s42 offen offset:1024 lds
    buffer_load_dwordx4 v12, s[28:31], s42 offen offset:2048 lds
    buffer_load_dwordx4 v12, s[28:31], s42 offen offset:3072 lds
    s_add_u32 s42, s42, 14336
    s_sleep 16
    s_add_u32 m0, s52, 61440
    s_nop 0
    buffer_load_dwordx4 v10, s[20:23], s44 offen offset:0 lds
    buffer_load_dwordx4 v11, s[20:23], s44 offen offset:1024 lds
    buffer_load_dwordx4 v10, s[20:23], s45 offen offset:2048 lds
    buffer_load_dwordx4 v11, s[20:23], s45 offen offset:3072 lds
    s_add_u32 s44, s44, 128
    s_add_u32 s45, s45, 128
    s_add_u32 m0, s53, 61440
    s_nop 0
    buffer_load_dwordx4 v12, s[28:31], s42 offen offset:0 lds
    buffer_load_dwordx4 v12, s[28:31], s42 offen offset:1024 lds
    buffer_load_dwordx4 v12, s[28:31], s42 offen offset:2048 lds
    buffer_load_dwordx4 v12, s[28:31], s42 offen offset:3072 lds
    s_add_u32 s42, s42, 14336
    v_and_b32 v108, 31, v1
    v_add_u32 v108, s37, v108
    v_lshlrev_b32 v108, 12, v108
    v_lshrrev_b32 v109, 5, v1
    v_lshlrev_b32 v109, 7, v109
    v_add_u32 v108, v108, v109
    s_lshl_b32 s49, s34, 11
    s_bfe_u32 s48, s2, 0x30004
    s_bfe_u32 s47, s2, 0x10002
    s_lshl_b32 s47, s47, 3
    s_add_u32 s48, s48, s47
    s_sub_u32 s48, s48, s35
    s_lshl_b32 s48, s48, 19
    v_add_u32 v108, s48, v108
    s_lshr_b32 s47, s2, 7
    s_lshl_b32 s47, s47, 1
    s_bfe_u32 s48, s2, 0x10003
    s_add_u32 s47, s47, s48
    s_lshl_b32 s47, s47, 2
    s_lshr_b32 s47, 8496, s47
    s_and_b32 s47, s47, 15
    s_lshl_b32 s48, s47, 8
    s_add_u32 s49, s49, s48
    s_lshl_b32 s48, s47, 2
    s_lshr_b32 s51, 30001, s48
    s_and_b32 s51, s51, 15
    s_and_b32 s56, s2, 7
    s_lshl_b32 s56, s56, 1
    s_lshr_b32 s57, s2, 7
    s_add_u32 s56, s56, s57
    s_and_b32 s50, s56, 3
    s_bfe_u32 s57, s2, 0x40003
    s_lshl_b32 s57, s57, 2
    s_add_u32 s50, s50, s57
    s_andn2_b32 s57, s56, 3
    s_add_u32 s57, s57, s54
    s_min_u32 s56, s57, 13
    s_lshl_b32 s56, s56, 15
    s_add_u32 s56, s56, 12582912
    buffer_load_dwordx4 v[184:187], v12, s[28:31], s56 offen offset:0
    buffer_load_dwordx4 v[188:191], v12, s[28:31], s56 offen offset:1024
    buffer_load_dwordx4 v[192:195], v12, s[28:31], s56 offen offset:2048
    buffer_load_dwordx4 v[196:199], v12, s[28:31], s56 offen offset:3072
    s_add_u32 s56, s56, 4096
    buffer_load_dwordx4 v[200:203], v12, s[28:31], s56 offen offset:0
    buffer_load_dwordx4 v[204:207], v12, s[28:31], s56 offen offset:1024
    buffer_load_dwordx4 v[208:211], v12, s[28:31], s56 offen offset:2048
    buffer_load_dwordx4 v[212:215], v12, s[28:31], s56 offen offset:3072
    s_add_u32 s56, s56, 4096
    buffer_load_dwordx4 v[216:219], v12, s[28:31], s56 offen offset:0
    buffer_load_dwordx4 v[220:223], v12, s[28:31], s56 offen offset:1024
    buffer_load_dwordx4 v[224:227], v12, s[28:31], s56 offen offset:2048
    buffer_load_dwordx4 v[228:231], v12, s[28:31], s56 offen offset:3072
    s_add_u32 s56, s56, 4096
    buffer_load_dwordx4 v[232:235], v12, s[28:31], s56 offen offset:0
    buffer_load_dwordx4 v[236:239], v12, s[28:31], s56 offen offset:1024
    buffer_load_dwordx4 v[240:243], v12, s[28:31], s56 offen offset:2048
    buffer_load_dwordx4 v[244:247], v12, s[28:31], s56 offen offset:3072
    s_add_u32 s56, s56, 4096
    buffer_load_dwordx4 v[112:115], v12, s[28:31], s56 offen offset:0
    buffer_load_dwordx4 v[116:119], v12, s[28:31], s56 offen offset:1024
    buffer_load_dwordx4 v[120:123], v12, s[28:31], s56 offen offset:2048
    buffer_load_dwordx4 v[124:127], v12, s[28:31], s56 offen offset:3072
    s_add_u32 s56, s56, 4096
    buffer_load_dwordx4 v[20:23], v12, s[28:31], s56 offen offset:0
    buffer_load_dwordx4 v[24:27], v12, s[28:31], s56 offen offset:1024
    v_mov_b32 v128, 0
    v_mov_b32 v129, 0
    v_mov_b32 v130, 0
    v_mov_b32 v131, 0
    v_mov_b32 v132, 0
    v_mov_b32 v133, 0
    v_mov_b32 v134, 0
    v_mov_b32 v135, 0
    v_mov_b32 v136, 0
    v_mov_b32 v137, 0
    v_mov_b32 v138, 0
    v_mov_b32 v139, 0
    v_mov_b32 v140, 0
    v_mov_b32 v141, 0
    v_mov_b32 v142, 0
    v_mov_b32 v143, 0
    v_mov_b32 v144, 0
    v_mov_b32 v145, 0
    v_mov_b32 v146, 0
    v_mov_b32 v147, 0
    v_mov_b32 v148, 0
    v_mov_b32 v149, 0
    v_mov_b32 v150, 0
    v_mov_b32 v151, 0
    v_mov_b32 v152, 0
    v_mov_b32 v153, 0
    v_mov_b32 v154, 0
    v_mov_b32 v155, 0
    v_mov_b32 v156, 0
    v_mov_b32 v157, 0
    v_mov_b32 v158, 0
    v_mov_b32 v159, 0
    v_mov_b32 v160, 0
    v_mov_b32 v161, 0
    v_mov_b32 v162, 0
    v_mov_b32 v163, 0
    v_mov_b32 v164, 0
    v_mov_b32 v165, 0
    v_mov_b32 v166, 0
    v_mov_b32 v167, 0
    v_mov_b32 v168, 0
    v_mov_b32 v169, 0
    v_mov_b32 v170, 0
    v_mov_b32 v171, 0
    v_mov_b32 v172, 0
    v_mov_b32 v173, 0
    v_mov_b32 v174, 0
    v_mov_b32 v175, 0
    v_mov_b32 v176, 0
    v_mov_b32 v177, 0
    v_mov_b32 v178, 0
    v_mov_b32 v179, 0
    v_mov_b32 v180, 0
    v_mov_b32 v181, 0
    v_mov_b32 v182, 0
    v_mov_b32 v183, 0
    v_and_b32 v2, 15, v1
    v_lshrrev_b32 v3, 1, v2
    v_lshrrev_b32 v4, 4, v1
    v_xor_b32 v3, v3, v4
    v_lshlrev_b32 v3, 4, v3
    v_lshlrev_b32 v5, 7, v2
    v_add_u32 v3, v3, v5
    v_add_u32 v16, s52, v3
    v_xor_b32 v3, 64, v3
    v_add_u32 v17, s52, v3
    v_add_u32 v18, 61440, v16
    v_add_u32 v19, 61440, v17
    v_add_u32 v254, 122880, v16
    v_add_u32 v255, 122880, v17
    v_add_u32 v28, 16384, v12
    v_add_u32 v29, 77824, v12
    v_mov_b32 v13, 155648
    v_mov_b32 v14, 1
    v_mov_b32 v31, 155680
    s_lshl_b32 s46, s35, 2
    s_add_u32 s46, s46, s54
    s_mul_i32 s46, s46, 28
    s_mul_i32 s47, s36, 7
    s_add_u32 s46, s46, s47
    s_lshl_b32 s46, s46, 2
    s_and_b32 s47, s2, 3
    s_add_u32 s46, s46, s47
    s_lshl_b32 s46, s46, 10
    s_add_u32 s46, s46, 16777216
    s_waitcnt vmcnt(34)
    s_mov_b64 exec, 1
    ds_add_u32 v13, v14
    s_mov_b64 exec, -1
K2G_spinp:
    ds_read_b32 v15, v13
    s_add_u32 s55, s55, 1
    s_waitcnt lgkmcnt(0)
    v_readfirstlane_b32 s48, v15
    s_bitcmp1_b32 s55, 22
    s_cbranch_scc1 K2G_spunp
    s_cmp_ge_u32 s48, 4
    s_cbranch_scc1 K2G_spunp
    s_sleep 1
    s_branch K2G_spinp
K2G_spunp:
    ds_read_b128 v[32:35], v254 offset:0
    ds_read_b128 v[40:43], v28 offset:0
    ds_read_b128 v[36:39], v254 offset:2048
    ds_read_b128 v[44:47], v28 offset:2048
    ds_read_b128 v[48:51], v28 offset:4096
    ds_read_b128 v[52:55], v28 offset:6144
    ds_read_b128 v[56:59], v28 offset:8192
    ds_read_b128 v[60:63], v28 offset:10240
    ds_read_b128 v[64:67], v28 offset:12288
    s_waitcnt vmcnt(30)
    s_mov_b64 exec, 1
    ds_add_u32 v13, v14
    s_mov_b64 exec, -1
    s_waitcnt lgkmcnt(9)
    s_waitcnt lgkmcnt(8)
    v_mfma_f32_16x16x32_bf16 v[128:131], v[40:43], v[32:35], v[128:131]
    ds_read_b128 v[72:75], v255 offset:0
    s_waitcnt lgkmcnt(8)
    v_mfma_f32_16x16x32_bf16 v[132:135], v[40:43], v[36:39], v[132:135]
    ds_read_b128 v[80:83], v28 offset:1024
    s_waitcnt lgkmcnt(8)
    v_mfma_f32_16x16x32_bf16 v[136:139], v[44:47], v[32:35], v[136:139]
    ds_read_b128 v[76:79], v255 offset:2048
    v_mfma_f32_16x16x32_bf16 v[140:143], v[44:47], v[36:39], v[140:143]
    ds_read_b128 v[84:87], v28 offset:3072
    s_waitcnt lgkmcnt(9)
    v_mfma_f32_16x16x32_bf16 v[144:147], v[48:51], v[32:35], v[144:147]
    ds_read_b128 v[88:91], v28 offset:5120
    v_mfma_f32_16x16x32_bf16 v[148:151], v[48:51], v[36:39], v[148:151]
    ds_read_b128 v[92:95], v28 offset:7168
    s_waitcnt lgkmcnt(10)
    v_mfma_f32_16x16x32_bf16 v[152:155], v[52:55], v[32:35], v[152:155]
    ds_read_b128 v[96:99], v28 offset:9216
    v_mfma_f32_16x16x32_bf16 v[156:159], v[52:55], v[36:39], v[156:159]
    ds_read_b128 v[100:103], v28 offset:11264
    s_waitcnt lgkmcnt(11)
    v_mfma_f32_16x16x32_bf16 v[160:163], v[56:59], v[32:35], v[160:163]
    ds_read_b128 v[104:107], v28 offset:13312
    s_add_u32 m0, s52, 92160
    s_nop 0
    buffer_load_dwordx4 v10, s[20:23], s44 offen offset:0 lds
    v_mfma_f32_16x16x32_bf16 v[164:167], v[56:59], v[36:39], v[164:167]
    buffer_load_dwordx4 v11, s[20:23], s44 offen offset:1024 lds
    s_waitcnt lgkmcnt(11)
    v_mfma_f32_16x16x32_bf16 v[168:171], v[60:63], v[32:35], v[168:171]
    buffer_load_dwordx4 v10, s[20:23], s45 offen offset:2048 lds
    v_mfma_f32_16x16x32_bf16 v[172:175], v[60:63], v[36:39], v[172:175]
    buffer_load_dwordx4 v11, s[20:23], s45 offen offset:3072 lds
    ds_read_b32 v15, v13
    s_waitcnt lgkmcnt(11)
    v_mfma_f32_16x16x32_bf16 v[176:179], v[64:67], v[32:35], v[176:179]
    s_add_u32 m0, s53, 92160
    s_nop 0
    buffer_load_dwordx4 v12, s[28:31], s42 offen offset:0 lds
    v_mfma_f32_16x16x32_bf16 v[180:183], v[64:67], v[36:39], v[180:183]
    buffer_load_dwordx4 v12, s[28:31], s42 offen offset:1024 lds
    s_waitcnt lgkmcnt(0)
    s_mov_b64 exec, 1
    ds_add_u32 v31, v14
    s_mov_b64 exec, -1
    v_readfirstlane_b32 s48, v15
    s_cmp_ge_u32 s48, 8
    s_cbranch_scc1 K2G_spuna0
K2G_spina0:
    ds_read_b32 v15, v13
    s_add_u32 s55, s55, 1
    s_waitcnt lgkmcnt(0)
    v_readfirstlane_b32 s48, v15
    s_bitcmp1_b32 s55, 22
    s_cbranch_scc1 K2G_spuna0
    s_cmp_ge_u32 s48, 8
    s_cbranch_scc1 K2G_spuna0
    s_sleep 1
    s_branch K2G_spina0
K2G_spuna0:
    v_mfma_f32_16x16x32_bf16 v[128:131], v[80:83], v[72:75], v[128:131]
    ds_read_b128 v[32:35], v254 offset:16384
    v_mfma_f32_16x16x32_bf16 v[132:135], v[80:83], v[76:79], v[132:135]
    ds_read_b128 v[40:43], v28 offset:30720
    v_mfma_f32_16x16x32_bf16 v[136:139], v[84:87], v[72:75], v[136:139]
    ds_read_b128 v[36:39], v254 offset:18432
    v_mfma_f32_16x16x32_bf16 v[140:143], v[84:87], v[76:79], v[140:143]
    ds_read_b128 v[44:47], v28 offset:32768
    v_mfma_f32_16x16x32_bf16 v[144:147], v[88:91], v[72:75], v[144:147]
    ds_read_b128 v[48:51], v28 offset:34816
    v_mfma_f32_16x16x32_bf16 v[148:151], v[88:91], v[76:79], v[148:151]
    ds_read_b128 v[52:55], v28 offset:36864
    v_mfma_f32_16x16x32_bf16 v[152:155], v[92:95], v[72:75], v[152:155]
    ds_read_b128 v[56:59], v28 offset:38912
    v_mfma_f32_16x16x32_bf16 v[156:159], v[92:95], v[76:79], v[156:159]
    ds_read_b128 v[60:63], v28 offset:40960
    v_mfma_f32_16x16x32_bf16 v[160:163], v[96:99], v[72:75], v[160:163]
    ds_read_b128 v[64:67], v28 offset:43008
    buffer_load_dwordx4 v12, s[28:31], s42 offen offset:2048 lds
    v_mfma_f32_16x16x32_bf16 v[164:167], v[96:99], v[76:79], v[164:167]
    buffer_load_dwordx4 v12, s[28:31], s42 offen offset:3072 lds
    s_add_u32 s44, s44, 128
    s_add_u32 s45, s45, 128
    s_add_u32 s42, s42, 14336
    v_mfma_f32_16x16x32_bf16 v[168:171], v[100:103], v[72:75], v[168:171]
    v_mfma_f32_16x16x32_bf16 v[172:175], v[100:103], v[76:79], v[172:175]
    ds_read_b32 v9, v31
    v_mfma_f32_16x16x32_bf16 v[176:179], v[104:107], v[72:75], v[176:179]
    v_mfma_f32_16x16x32_bf16 v[180:183], v[104:107], v[76:79], v[180:183]
    s_waitcnt vmcnt(30)
    s_mov_b64 exec, 1
    ds_add_u32 v13, v14
    s_mov_b64 exec, -1
    s_waitcnt lgkmcnt(1)
    v_readfirstlane_b32 s48, v9
    s_cmp_ge_u32 s48, 4
    s_cbranch_scc1 K2G_spunb1
K2G_spinb1:
    ds_read_b32 v15, v31
    s_add_u32 s55, s55, 1
    s_waitcnt lgkmcnt(0)
    v_readfirstlane_b32 s48, v15
    s_bitcmp1_b32 s55, 22
    s_cbranch_scc1 K2G_spunb1
    s_cmp_ge_u32 s48, 4
    s_cbranch_scc1 K2G_spunb1
    s_sleep 1
    s_branch K2G_spinb1
K2G_spunb1:
    v_mfma_f32_16x16x32_bf16 v[128:131], v[40:43], v[32:35], v[128:131]
    ds_read_b128 v[72:75], v255 offset:16384
    v_mfma_f32_16x16x32_bf16 v[132:135], v[40:43], v[36:39], v[132:135]
    ds_read_b128 v[80:83], v28 offset:31744
    v_mfma_f32_16x16x32_bf16 v[136:139], v[44:47], v[32:35], v[136:139]
    ds_read_b128 v[76:79], v255 offset:18432
    v_mfma_f32_16x16x32_bf16 v[140:143], v[44:47], v[36:39], v[140:143]
    ds_read_b128 v[84:87], v28 offset:33792
    v_mfma_f32_16x16x32_bf16 v[144:147], v[48:51], v[32:35], v[144:147]
    ds_read_b128 v[88:91], v28 offset:35840
    v_mfma_f32_16x16x32_bf16 v[148:151], v[48:51], v[36:39], v[148:151]
    ds_read_b128 v[92:95], v28 offset:37888
    v_mfma_f32_16x16x32_bf16 v[152:155], v[52:55], v[32:35], v[152:155]
    ds_read_b128 v[96:99], v28 offset:39936
    v_mfma_f32_16x16x32_bf16 v[156:159], v[52:55], v[36:39], v[156:159]
    ds_read_b128 v[100:103], v28 offset:41984
    v_mfma_f32_16x16x32_bf16 v[160:163], v[56:59], v[32:35], v[160:163]
    ds_read_b128 v[104:107], v28 offset:44032
    s_add_u32 m0, s52, 0
    s_nop 0
    buffer_load_dwordx4 v10, s[20:23], s44 offen offset:0 lds
    v_mfma_f32_16x16x32_bf16 v[164:167], v[56:59], v[36:39], v[164:167]
    buffer_load_dwordx4 v11, s[20:23], s44 offen offset:1024 lds
    v_mfma_f32_16x16x32_bf16 v[168:171], v[60:63], v[32:35], v[168:171]
    buffer_load_dwordx4 v10, s[20:23], s45 offen offset:2048 lds
    v_mfma_f32_16x16x32_bf16 v[172:175], v[60:63], v[36:39], v[172:175]
    buffer_load_dwordx4 v11, s[20:23], s45 offen offset:3072 lds
    ds_read_b32 v15, v13
    v_mfma_f32_16x16x32_bf16 v[176:179], v[64:67], v[32:35], v[176:179]
    s_add_u32 m0, s53, 0
    s_nop 0
    buffer_load_dwordx4 v12, s[28:31], s42 offen offset:0 lds
    v_mfma_f32_16x16x32_bf16 v[180:183], v[64:67], v[36:39], v[180:183]
    buffer_load_dwordx4 v12, s[28:31], s42 offen offset:1024 lds
    s_waitcnt lgkmcnt(0)
    s_mov_b64 exec, 1
    ds_add_u32 v31, v14
    s_mov_b64 exec, -1
    v_readfirstlane_b32 s48, v15
    s_cmp_ge_u32 s48, 12
    s_cbranch_scc1 K2G_spuna1
K2G_spina1:
    ds_read_b32 v15, v13
    s_add_u32 s55, s55, 1
    s_waitcnt lgkmcnt(0)
    v_readfirstlane_b32 s48, v15
    s_bitcmp1_b32 s55, 22
    s_cbranch_scc1 K2G_spuna1
    s_cmp_ge_u32 s48, 12
    s_cbranch_scc1 K2G_spuna1
    s_sleep 1
    s_branch K2G_spina1
K2G_spuna1:
    v_mfma_f32_16x16x32_bf16 v[128:131], v[80:83], v[72:75], v[128:131]
    ds_read_b128 v[32:35], v18 offset:0
    v_mfma_f32_16x16x32_bf16 v[132:135], v[80:83], v[76:79], v[132:135]
    ds_read_b128 v[40:43], v29 offset:0
    v_mfma_f32_16x16x32_bf16 v[136:139], v[84:87], v[72:75], v[136:139]
    ds_read_b128 v[36:39], v18 offset:2048
    v_mfma_f32_16x16x32_bf16 v[140:143], v[84:87], v[76:79], v[140:143]
    ds_read_b128 v[44:47], v29 offset:2048
    v_mfma_f32_16x16x32_bf16 v[144:147], v[88:91], v[72:75], v[144:147]
    ds_read_b128 v[48:51], v29 offset:4096
    v_mfma_f32_16x16x32_bf16 v[148:151], v[88:91], v[76:79], v[148:151]
    ds_read_b128 v[52:55], v29 offset:6144
    v_mfma_f32_16x16x32_bf16 v[152:155], v[92:95], v[72:75], v[152:155]
    ds_read_b128 v[56:59], v29 offset:8192
    v_mfma_f32_16x16x32_bf16 v[156:159], v[92:95], v[76:79], v[156:159]
    ds_read_b128 v[60:63], v29 offset:10240
    v_mfma_f32_16x16x32_bf16 v[160:163], v[96:99], v[72:75], v[160:163]
    ds_read_b128 v[64:67], v29 offset:12288
    buffer_load_dwordx4 v12, s[28:31], s42 offen offset:2048 lds
    v_mfma_f32_16x16x32_bf16 v[164:167], v[96:99], v[76:79], v[164:167]
    buffer_load_dwordx4 v12, s[28:31], s42 offen offset:3072 lds
    s_add_u32 s44, s44, 128
    s_add_u32 s45, s45, 128
    s_add_u32 s42, s42, 14336
    v_mfma_f32_16x16x32_bf16 v[168:171], v[100:103], v[72:75], v[168:171]
    s_cmp_eq_u32 s51, 1
    s_cselect_b32 s48, 0, 0x800000
    v_add_u32 v109, s48, v108
    buffer_load_dword v110, v109, s[20:23], s49 offen offset:1024
    v_mfma_f32_16x16x32_bf16 v[172:175], v[100:103], v[76:79], v[172:175]
    ds_read_b32 v9, v31
    v_mfma_f32_16x16x32_bf16 v[176:179], v[104:107], v[72:75], v[176:179]
    v_mfma_f32_16x16x32_bf16 v[180:183], v[104:107], v[76:79], v[180:183]
    s_waitcnt vmcnt(9)
    s_mov_b64 exec, 1
    ds_add_u32 v13, v14
    s_mov_b64 exec, -1
    s_waitcnt lgkmcnt(1)
    v_readfirstlane_b32 s48, v9
    s_cmp_ge_u32 s48, 8
    s_cbranch_scc1 K2G_spunb2
K2G_spinb2:
    ds_read_b32 v15, v31
    s_add_u32 s55, s55, 1
    s_waitcnt lgkmcnt(0)
    v_readfirstlane_b32 s48, v15
    s_bitcmp1_b32 s55, 22
    s_cbranch_scc1 K2G_spunb2
    s_cmp_ge_u32 s48, 8
    s_cbranch_scc1 K2G_spunb2
    s_sleep 1
    s_branch K2G_spinb2
K2G_spunb2:
    v_mfma_f32_16x16x32_bf16 v[128:131], v[40:43], v[32:35], v[128:131]
    ds_read_b128 v[72:75], v19 offset:0
    v_mfma_f32_16x16x32_bf16 v[132:135], v[40:43], v[36:39], v[132:135]
    ds_read_b128 v[80:83], v29 offset:1024
    v_mfma_f32_16x16x32_bf16 v[136:139], v[44:47], v[32:35], v[136:139]
    ds_read_b128 v[76:79], v19 offset:2048
    v_mfma_f32_16x16x32_bf16 v[140:143], v[44:47], v[36:39], v[140:143]
    ds_read_b128 v[84:87], v29 offset:3072
    v_mfma_f32_16x16x32_bf16 v[144:147], v[48:51], v[32:35], v[144:147]
    ds_read_b128 v[88:91], v29 offset:5120
    v_mfma_f32_16x16x32_bf16 v[148:151], v[48:51], v[36:39], v[148:151]
    ds_read_b128 v[92:95], v29 offset:7168
    v_mfma_f32_16x16x32_bf16 v[152:155], v[52:55], v[32:35], v[152:155]
    ds_read_b128 v[96:99], v29 offset:9216
    v_mfma_f32_16x16x32_bf16 v[156:159], v[52:55], v[36:39], v[156:159]
    ds_read_b128 v[100:103], v29 offset:11264
    v_mfma_f32_16x16x32_bf16 v[160:163], v[56:59], v[32:35], v[160:163]
    ds_read_b128 v[104:107], v29 offset:13312
    s_add_u32 m0, s52, 30720
    s_nop 0
    buffer_load_dwordx4 v10, s[20:23], s44 offen offset:0 lds
    v_mfma_f32_16x16x32_bf16 v[164:167], v[56:59], v[36:39], v[164:167]
    buffer_load_dwordx4 v11, s[20:23], s44 offen offset:1024 lds
    v_mfma_f32_16x16x32_bf16 v[168:171], v[60:63], v[32:35], v[168:171]
    buffer_load_dwordx4 v10, s[20:23], s45 offen offset:2048 lds
    v_mfma_f32_16x16x32_bf16 v[172:175], v[60:63], v[36:39], v[172:175]
    buffer_load_dwordx4 v11, s[20:23], s45 offen offset:3072 lds
    ds_read_b32 v15, v13
    v_mfma_f32_16x16x32_bf16 v[176:179], v[64:67], v[32:35], v[176:179]
    s_add_u32 m0, s53, 30720
    s_nop 0
    buffer_load_dwordx4 v12, s[28:31], s42 offen offset:0 lds
    v_mfma_f32_16x16x32_bf16 v[180:183], v[64:67], v[36:39], v[180:183]
    buffer_load_dwordx4 v12, s[28:31], s42 offen offset:1024 lds
    s_waitcnt lgkmcnt(0)
    s_mov_b64 exec, 1
    ds_add_u32 v31, v14
    s_mov_b64 exec, -1
    v_readfirstlane_b32 s48, v15
    s_cmp_ge_u32 s48, 16
    s_cbranch_scc1 K2G_spuna2
K2G_spina2:
    ds_read_b32 v15, v13
    s_add_u32 s55, s55, 1
    s_waitcnt lgkmcnt(0)
    v_readfirstlane_b32 s48, v15
    s_bitcmp1_b32 s55, 22
    s_cbranch_scc1 K2G_spuna2
    s_cmp_ge_u32 s48, 16
    s_cbranch_scc1 K2G_spuna2
    s_sleep 1
    s_branch K2G_spina2
K2G_spuna2:
    v_mfma_f32_16x16x32_bf16 v[128:131], v[80:83], v[72:75], v[128:131]
    ds_read_b128 v[32:35], v18 offset:30720
    v_mfma_f32_16x16x32_bf16 v[132:135], v[80:83], v[76:79], v[132:135]
    ds_read_b128 v[40:43], v29 offset:30720
    v_mfma_f32_16x16x32_bf16 v[136:139], v[84:87], v[72:75], v[136:139]
    ds_read_b128 v[36:39], v18 offset:32768
    v_mfma_f32_16x16x32_bf16 v[140:143], v[84:87], v[76:79], v[140:143]
    ds_read_b128 v[44:47], v29 offset:32768
    v_mfma_f32_16x16x32_bf16 v[144:147], v[88:91], v[72:75], v[144:147]
    ds_read_b128 v[48:51], v29 offset:34816
    v_mfma_f32_16x16x32_bf16 v[148:151], v[88:91], v[76:79], v[148:151]
    ds_read_b128 v[52:55], v29 offset:36864
    v_mfma_f32_16x16x32_bf16 v[152:155], v[92:95], v[72:75], v[152:155]
    ds_read_b128 v[56:59], v29 offset:38912
    v_mfma_f32_16x16x32_bf16 v[156:159], v[92:95], v[76:79], v[156:159]
    ds_read_b128 v[60:63], v29 offset:40960
    v_mfma_f32_16x16x32_bf16 v[160:163], v[96:99], v[72:75], v[160:163]
    ds_read_b128 v[64:67], v29 offset:43008
    buffer_load_dwordx4 v12, s[28:31], s42 offen offset:2048 lds
    v_mfma_f32_16x16x32_bf16 v[164:167], v[96:99], v[76:79], v[164:167]
    buffer_load_dwordx4 v12, s[28:31], s42 offen offset:3072 lds
    s_add_u32 s44, s44, 128
    s_add_u32 s45, s45, 128
    s_add_u32 s42, s42, 14336
    v_mfma_f32_16x16x32_bf16 v[168:171], v[100:103], v[72:75], v[168:171]
    v_mfma_f32_16x16x32_bf16 v[172:175], v[100:103], v[76:79], v[172:175]
    ds_read_b32 v9, v31
    v_mfma_f32_16x16x32_bf16 v[176:179], v[104:107], v[72:75], v[176:179]
    v_mfma_f32_16x16x32_bf16 v[180:183], v[104:107], v[76:79], v[180:183]
    s_waitcnt vmcnt(9)
    s_mov_b64 exec, 1
    ds_add_u32 v13, v14
    s_mov_b64 exec, -1
    s_waitcnt lgkmcnt(1)
    v_readfirstlane_b32 s48, v9
    s_cmp_ge_u32 s48, 12
    s_cbranch_scc1 K2G_spunb3
K2G_spinb3:
    ds_read_b32 v15, v31
    s_add_u32 s55, s55, 1
    s_waitcnt lgkmcnt(0)
    v_readfirstlane_b32 s48, v15
    s_bitcmp1_b32 s55, 22
    s_cbranch_scc1 K2G_spunb3
    s_cmp_ge_u32 s48, 12
    s_cbranch_scc1 K2G_spunb3
    s_sleep 1
    s_branch K2G_spinb3
K2G_spunb3:
    v_mfma_f32_16x16x32_bf16 v[128:131], v[40:43], v[32:35], v[128:131]
    ds_read_b128 v[72:75], v19 offset:30720
    v_mfma_f32_16x16x32_bf16 v[132:135], v[40:43], v[36:39], v[132:135]
    ds_read_b128 v[80:83], v29 offset:31744
    v_mfma_f32_16x16x32_bf16 v[136:139], v[44:47], v[32:35], v[136:139]
    ds_read_b128 v[76:79], v19 offset:32768
    v_mfma_f32_16x16x32_bf16 v[140:143], v[44:47], v[36:39], v[140:143]
    ds_read_b128 v[84:87], v29 offset:33792
    v_mfma_f32_16x16x32_bf16 v[144:147], v[48:51], v[32:35], v[144:147]
    ds_read_b128 v[88:91], v29 offset:35840
    v_mfma_f32_16x16x32_bf16 v[148:151], v[48:51], v[36:39], v[148:151]
    ds_read_b128 v[92:95], v29 offset:37888
    v_mfma_f32_16x16x32_bf16 v[152:155], v[52:55], v[32:35], v[152:155]
    ds_read_b128 v[96:99], v29 offset:39936
    v_mfma_f32_16x16x32_bf16 v[156:159], v[52:55], v[36:39], v[156:159]
    ds_read_b128 v[100:103], v29 offset:41984
    v_mfma_f32_16x16x32_bf16 v[160:163], v[56:59], v[32:35], v[160:163]
    ds_read_b128 v[104:107], v29 offset:44032
    s_add_u32 m0, s52, 61440
    s_nop 0
    buffer_load_dwordx4 v10, s[20:23], s44 offen offset:0 lds
    v_mfma_f32_16x16x32_bf16 v[164:167], v[56:59], v[36:39], v[164:167]
    buffer_load_dwordx4 v11, s[20:23], s44 offen offset:1024 lds
    v_mfma_f32_16x16x32_bf16 v[168:171], v[60:63], v[32:35], v[168:171]
    buffer_load_dwordx4 v10, s[20:23], s45 offen offset:2048 lds
    v_mfma_f32_16x16x32_bf16 v[172:175], v[60:63], v[36:39], v[172:175]
    buffer_load_dwordx4 v11, s[20:23], s45 offen offset:3072 lds
    ds_read_b32 v15, v13
    v_mfma_f32_16x16x32_bf16 v[176:179], v[64:67], v[32:35], v[176:179]
    s_add_u32 m0, s53, 61440
    s_nop 0
    buffer_load_dwordx4 v12, s[28:31], s42 offen offset:0 lds
    v_mfma_f32_16x16x32_bf16 v[180:183], v[64:67], v[36:39], v[180:183]
    buffer_load_dwordx4 v12, s[28:31], s42 offen offset:1024 lds
    s_waitcnt lgkmcnt(0)
    s_mov_b64 exec, 1
    ds_add_u32 v31, v14
    s_mov_b64 exec, -1
    v_readfirstlane_b32 s48, v15
    s_cmp_ge_u32 s48, 20
    s_cbranch_scc1 K2G_spuna3
K2G_spina3:
    ds_read_b32 v15, v13
    s_add_u32 s55, s55, 1
    s_waitcnt lgkmcnt(0)
    v_readfirstlane_b32 s48, v15
    s_bitcmp1_b32 s55, 22
    s_cbranch_scc1 K2G_spuna3
    s_cmp_ge_u32 s48, 20
    s_cbranch_scc1 K2G_spuna3
    s_sleep 1
    s_branch K2G_spina3
K2G_spuna3:
    v_mfma_f32_16x16x32_bf16 v[128:131], v[80:83], v[72:75], v[128:131]
    ds_read_b128 v[32:35], v16 offset:0
    v_mfma_f32_16x16x32_bf16 v[132:135], v[80:83], v[76:79], v[132:135]
    ds_read_b128 v[40:43], v28 offset:0
    v_mfma_f32_16x16x32_bf16 v[136:139], v[84:87], v[72:75], v[136:139]
    ds_read_b128 v[36:39], v16 offset:2048
    v_mfma_f32_16x16x32_bf16 v[140:143], v[84:87], v[76:79], v[140:143]
    ds_read_b128 v[44:47], v28 offset:2048
    v_mfma_f32_16x16x32_bf16 v[144:147], v[88:91], v[72:75], v[144:147]
    ds_read_b128 v[48:51], v28 offset:4096
    v_mfma_f32_16x16x32_bf16 v[148:151], v[88:91], v[76:79], v[148:151]
    ds_read_b128 v[52:55], v28 offset:6144
    v_mfma_f32_16x16x32_bf16 v[152:155], v[92:95], v[72:75], v[152:155]
    ds_read_b128 v[56:59], v28 offset:8192
    v_mfma_f32_16x16x32_bf16 v[156:159], v[92:95], v[76:79], v[156:159]
    ds_read_b128 v[60:63], v28 offset:10240
    v_mfma_f32_16x16x32_bf16 v[160:163], v[96:99], v[72:75], v[160:163]
    ds_read_b128 v[64:67], v28 offset:12288
    buffer_load_dwordx4 v12, s[28:31], s42 offen offset:2048 lds
    v_mfma_f32_16x16x32_bf16 v[164:167], v[96:99], v[76:79], v[164:167]
    buffer_load_dwordx4 v12, s[28:31], s42 offen offset:3072 lds
    s_add_u32 s44, s44, 128
    s_add_u32 s45, s45, 128
    s_add_u32 s42, s42, 14336
    v_mfma_f32_16x16x32_bf16 v[168:171], v[100:103], v[72:75], v[168:171]
    s_cmp_eq_u32 s51, 3
    s_cselect_b32 s48, 0, 0x800000
    v_add_u32 v109, s48, v108
    buffer_load_dword v110, v109, s[20:23], s49 offen offset:1024
    v_mfma_f32_16x16x32_bf16 v[172:175], v[100:103], v[76:79], v[172:175]
    ds_read_b32 v9, v31
    v_mfma_f32_16x16x32_bf16 v[176:179], v[104:107], v[72:75], v[176:179]
    v_mfma_f32_16x16x32_bf16 v[180:183], v[104:107], v[76:79], v[180:183]
    s_waitcnt vmcnt(9)
    s_mov_b64 exec, 1
    ds_add_u32 v13, v14
    s_mov_b64 exec, -1
    s_waitcnt lgkmcnt(1)
    v_readfirstlane_b32 s48, v9
    s_cmp_ge_u32 s48, 16
    s_cbranch_scc1 K2G_spunb4
K2G_spinb4:
    ds_read_b32 v15, v31
    s_add_u32 s55, s55, 1
    s_waitcnt lgkmcnt(0)
    v_readfirstlane_b32 s48, v15
    s_bitcmp1_b32 s55, 22
    s_cbranch_scc1 K2G_spunb4
    s_cmp_ge_u32 s48, 16
    s_cbranch_scc1 K2G_spunb4
    s_sleep 1
    s_branch K2G_spinb4
K2G_spunb4:
    v_mfma_f32_16x16x32_bf16 v[128:131], v[40:43], v[32:35], v[128:131]
    ds_read_b128 v[72:75], v17 offset:0
    v_mfma_f32_16x16x32_bf16 v[132:135], v[40:43], v[36:39], v[132:135]
    ds_read_b128 v[80:83], v28 offset:1024
    v_mfma_f32_16x16x32_bf16 v[136:139], v[44:47], v[32:35], v[136:139]
    ds_read_b128 v[76:79], v17 offset:2048
    v_mfma_f32_16x16x32_bf16 v[140:143], v[44:47], v[36:39], v[140:143]
    ds_read_b128 v[84:87], v28 offset:3072
    v_mfma_f32_16x16x32_bf16 v[144:147], v[48:51], v[32:35], v[144:147]
    ds_read_b128 v[88:91], v28 offset:5120
    v_mfma_f32_16x16x32_bf16 v[148:151], v[48:51], v[36:39], v[148:151]
    ds_read_b128 v[92:95], v28 offset:7168
    v_mfma_f32_16x16x32_bf16 v[152:155], v[52:55], v[32:35], v[152:155]
    ds_read_b128 v[96:99], v28 offset:9216
    v_mfma_f32_16x16x32_bf16 v[156:159], v[52:55], v[36:39], v[156:159]
    ds_read_b128 v[100:103], v28 offset:11264
    v_mfma_f32_16x16x32_bf16 v[160:163], v[56:59], v[32:35], v[160:163]
    ds_read_b128 v[104:107], v28 offset:13312
    s_add_u32 m0, s52, 92160
    s_nop 0
    buffer_load_dwordx4 v10, s[20:23], s44 offen offset:0 lds
    v_mfma_f32_16x16x32_bf16 v[164:167], v[56:59], v[36:39], v[164:167]
    buffer_load_dwordx4 v11, s[20:23], s44 offen offset:1024 lds
    v_mfma_f32_16x16x32_bf16 v[168:171], v[60:63], v[32:35], v[168:171]
    buffer_load_dwordx4 v10, s[20:23], s45 offen offset:2048 lds
    v_mfma_f32_16x16x32_bf16 v[172:175], v[60:63], v[36:39], v[172:175]
    buffer_load_dwordx4 v11, s[20:23], s45 offen offset:3072 lds
    ds_read_b32 v15, v13
    v_mfma_f32_16x16x32_bf16 v[176:179], v[64:67], v[32:35], v[176:179]
    s_add_u32 m0, s53, 92160
    s_nop 0
    buffer_load_dwordx4 v12, s[28:31], s42 offen offset:0 lds
    v_mfma_f32_16x16x32_bf16 v[180:183], v[64:67], v[36:39], v[180:183]
    buffer_load_dwordx4 v12, s[28:31], s42 offen offset:1024 lds
    s_waitcnt lgkmcnt(0)
    s_mov_b64 exec, 1
    ds_add_u32 v31, v14
    s_mov_b64 exec, -1
    v_readfirstlane_b32 s48, v15
    s_cmp_ge_u32 s48, 24
    s_cbranch_scc1 K2G_spuna4
K2G_spina4:
    ds_read_b32 v15, v13
    s_add_u32 s55, s55, 1
    s_waitcnt lgkmcnt(0)
    v_readfirstlane_b32 s48, v15
    s_bitcmp1_b32 s55, 22
    s_cbranch_scc1 K2G_spuna4
    s_cmp_ge_u32 s48, 24
    s_cbranch_scc1 K2G_spuna4
    s_sleep 1
    s_branch K2G_spina4
K2G_spuna4:
    v_mfma_f32_16x16x32_bf16 v[128:131], v[80:83], v[72:75], v[128:131]
    ds_read_b128 v[32:35], v16 offset:30720
    v_mfma_f32_16x16x32_bf16 v[132:135], v[80:83], v[76:79], v[132:135]
    ds_read_b128 v[40:43], v28 offset:30720
    v_mfma_f32_16x16x32_bf16 v[136:139], v[84:87], v[72:75], v[136:139]
    ds_read_b128 v[36:39], v16 offset:32768
    v_mfma_f32_16x16x32_bf16 v[140:143], v[84:87], v[76:79], v[140:143]
    ds_read_b128 v[44:47], v28 offset:32768
    v_mfma_f32_16x16x32_bf16 v[144:147], v[88:91], v[72:75], v[144:147]
    ds_read_b128 v[48:51], v28 offset:34816
    v_mfma_f32_16x16x32_bf16 v[148:151], v[88:91], v[76:79], v[148:151]
    ds_read_b128 v[52:55], v28 offset:36864
    v_mfma_f32_16x16x32_bf16 v[152:155], v[92:95], v[72:75], v[152:155]
    ds_read_b128 v[56:59], v28 offset:38912
    v_mfma_f32_16x16x32_bf16 v[156:159], v[92:95], v[76:79], v[156:159]
    ds_read_b128 v[60:63], v28 offset:40960
    v_mfma_f32_16x16x32_bf16 v[160:163], v[96:99], v[72:75], v[160:163]
    ds_read_b128 v[64:67], v28 offset:43008
    buffer_load_dwordx4 v12, s[28:31], s42 offen offset:2048 lds
    v_mfma_f32_16x16x32_bf16 v[164:167], v[96:99], v[76:79], v[164:167]
    buffer_load_dwordx4 v12, s[28:31], s42 offen offset:3072 lds
    s_add_u32 s44, s44, 128
    s_add_u32 s45, s45, 128
    s_add_u32 s42, s42, 14336
    v_mfma_f32_16x16x32_bf16 v[168:171], v[100:103], v[72:75], v[168:171]
    v_mfma_f32_16x16x32_bf16 v[172:175], v[100:103], v[76:79], v[172:175]
    ds_read_b32 v9, v31
    v_mfma_f32_16x16x32_bf16 v[176:179], v[104:107], v[72:75], v[176:179]
    v_mfma_f32_16x16x32_bf16 v[180:183], v[104:107], v[76:79], v[180:183]
    s_waitcnt vmcnt(9)
    s_mov_b64 exec, 1
    ds_add_u32 v13, v14
    s_mov_b64 exec, -1
    s_waitcnt lgkmcnt(1)
    v_readfirstlane_b32 s48, v9
    s_cmp_ge_u32 s48, 20
    s_cbranch_scc1 K2G_spunb5
K2G_spinb5:
    ds_read_b32 v15, v31
    s_add_u32 s55, s55, 1
    s_waitcnt lgkmcnt(0)
    v_readfirstlane_b32 s48, v15
    s_bitcmp1_b32 s55, 22
    s_cbranch_scc1 K2G_spunb5
    s_cmp_ge_u32 s48, 20
    s_cbranch_scc1 K2G_spunb5
    s_sleep 1
    s_branch K2G_spinb5
K2G_spunb5:
    v_mfma_f32_16x16x32_bf16 v[128:131], v[40:43], v[32:35], v[128:131]
    ds_read_b128 v[72:75], v17 offset:30720
    v_mfma_f32_16x16x32_bf16 v[132:135], v[40:43], v[36:39], v[132:135]
    ds_read_b128 v[80:83], v28 offset:31744
    v_mfma_f32_16x16x32_bf16 v[136:139], v[44:47], v[32:35], v[136:139]
    ds_read_b128 v[76:79], v17 offset:32768
    v_mfma_f32_16x16x32_bf16 v[140:143], v[44:47], v[36:39], v[140:143]
    ds_read_b128 v[84:87], v28 offset:33792
    v_mfma_f32_16x16x32_bf16 v[144:147], v[48:51], v[32:35], v[144:147]
    ds_read_b128 v[88:91], v28 offset:35840
    v_mfma_f32_16x16x32_bf16 v[148:151], v[48:51], v[36:39], v[148:151]
    ds_read_b128 v[92:95], v28 offset:37888
    v_mfma_f32_16x16x32_bf16 v[152:155], v[52:55], v[32:35], v[152:155]
    ds_read_b128 v[96:99], v28 offset:39936
    v_mfma_f32_16x16x32_bf16 v[156:159], v[52:55], v[36:39], v[156:159]
    ds_read_b128 v[100:103], v28 offset:41984
    v_mfma_f32_16x16x32_bf16 v[160:163], v[56:59], v[32:35], v[160:163]
    ds_read_b128 v[104:107], v28 offset:44032
    s_add_u32 m0, s52, 0
    s_nop 0
    buffer_load_dwordx4 v10, s[20:23], s44 offen offset:0 lds
    v_mfma_f32_16x16x32_bf16 v[164:167], v[56:59], v[36:39], v[164:167]
    buffer_load_dwordx4 v11, s[20:23], s44 offen offset:1024 lds
    v_mfma_f32_16x16x32_bf16 v[168:171], v[60:63], v[32:35], v[168:171]
    buffer_load_dwordx4 v10, s[20:23], s45 offen offset:2048 lds
    v_mfma_f32_16x16x32_bf16 v[172:175], v[60:63], v[36:39], v[172:175]
    buffer_load_dwordx4 v11, s[20:23], s45 offen offset:3072 lds
    ds_read_b32 v15, v13
    v_mfma_f32_16x16x32_bf16 v[176:179], v[64:67], v[32:35], v[176:179]
    s_add_u32 m0, s53, 0
    s_nop 0
    buffer_load_dwordx4 v12, s[28:31], s42 offen offset:0 lds
    v_mfma_f32_16x16x32_bf16 v[180:183], v[64:67], v[36:39], v[180:183]
    buffer_load_dwordx4 v12, s[28:31], s42 offen offset:1024 lds
    s_waitcnt lgkmcnt(0)
    s_mov_b64 exec, 1
    ds_add_u32 v31, v14
    s_mov_b64 exec, -1
    v_readfirstlane_b32 s48, v15
    s_cmp_ge_u32 s48, 28
    s_cbranch_scc1 K2G_spuna5
K2G_spina5:
    ds_read_b32 v15, v13
    s_add_u32 s55, s55, 1
    s_waitcnt lgkmcnt(0)
    v_readfirstlane_b32 s48, v15
    s_bitcmp1_b32 s55, 22
    s_cbranch_scc1 K2G_spuna5
    s_cmp_ge_u32 s48, 28
    s_cbranch_scc1 K2G_spuna5
    s_sleep 1
    s_branch K2G_spina5
K2G_spuna5:
    v_mfma_f32_16x16x32_bf16 v[128:131], v[80:83], v[72:75], v[128:131]
    ds_read_b128 v[32:35], v18 offset:0
    v_mfma_f32_16x16x32_bf16 v[132:135], v[80:83], v[76:79], v[132:135]
    ds_read_b128 v[40:43], v29 offset:0
    v_mfma_f32_16x16x32_bf16 v[136:139], v[84:87], v[72:75], v[136:139]
    ds_read_b128 v[36:39], v18 offset:2048
    v_mfma_f32_16x16x32_bf16 v[140:143], v[84:87], v[76:79], v[140:143]
    ds_read_b128 v[44:47], v29 offset:2048
    v_mfma_f32_16x16x32_bf16 v[144:147], v[88:91], v[72:75], v[144:147]
    ds_read_b128 v[48:51], v29 offset:4096
    v_mfma_f32_16x16x32_bf16 v[148:151], v[88:91], v[76:79], v[148:151]
    ds_read_b128 v[52:55], v29 offset:6144
    v_mfma_f32_16x16x32_bf16 v[152:155], v[92:95], v[72:75], v[152:155]
    ds_read_b128 v[56:59], v29 offset:8192
    v_mfma_f32_16x16x32_bf16 v[156:159], v[92:95], v[76:79], v[156:159]
    ds_read_b128 v[60:63], v29 offset:10240
    v_mfma_f32_16x16x32_bf16 v[160:163], v[96:99], v[72:75], v[160:163]
    ds_read_b128 v[64:67], v29 offset:12288
    buffer_load_dwordx4 v12, s[28:31], s42 offen offset:2048 lds
    v_mfma_f32_16x16x32_bf16 v[164:167], v[96:99], v[76:79], v[164:167]
    buffer_load_dwordx4 v12, s[28:31], s42 offen offset:3072 lds
    s_add_u32 s44, s44, 128
    s_add_u32 s45, s45, 128
    s_add_u32 s42, s42, 14336
    v_mfma_f32_16x16x32_bf16 v[168:171], v[100:103], v[72:75], v[168:171]
    s_cmp_eq_u32 s51, 5
    s_cselect_b32 s48, 0, 0x800000
    v_add_u32 v109, s48, v108
    buffer_load_dword v110, v109, s[20:23], s49 offen offset:1024
    v_mfma_f32_16x16x32_bf16 v[172:175], v[100:103], v[76:79], v[172:175]
    ds_read_b32 v9, v31
    v_mfma_f32_16x16x32_bf16 v[176:179], v[104:107], v[72:75], v[176:179]
    v_mfma_f32_16x16x32_bf16 v[180:183], v[104:107], v[76:79], v[180:183]
    s_waitcnt vmcnt(9)
    s_mov_b64 exec, 1
    ds_add_u32 v13, v14
    s_mov_b64 exec, -1
    s_waitcnt lgkmcnt(1)
    v_readfirstlane_b32 s48, v9
    s_cmp_ge_u32 s48, 24
    s_cbranch_scc1 K2G_spunb6
K2G_spinb6:
    ds_read_b32 v15, v31
    s_add_u32 s55, s55, 1
    s_waitcnt lgkmcnt(0)
    v_readfirstlane_b32 s48, v15
    s_bitcmp1_b32 s55, 22
    s_cbranch_scc1 K2G_spunb6
    s_cmp_ge_u32 s48, 24
    s_cbranch_scc1 K2G_spunb6
    s_sleep 1
    s_branch K2G_spinb6
K2G_spunb6:
    v_mfma_f32_16x16x32_bf16 v[128:131], v[40:43], v[32:35], v[128:131]
    ds_read_b128 v[72:75], v19 offset:0
    v_mfma_f32_16x16x32_bf16 v[132:135], v[40:43], v[36:39], v[132:135]
    ds_read_b128 v[80:83], v29 offset:1024
    v_mfma_f32_16x16x32_bf16 v[136:139], v[44:47], v[32:35], v[136:139]
    ds_read_b128 v[76:79], v19 offset:2048
    v_mfma_f32_16x16x32_bf16 v[140:143], v[44:47], v[36:39], v[140:143]
    ds_read_b128 v[84:87], v29 offset:3072
    v_mfma_f32_16x16x32_bf16 v[144:147], v[48:51], v[32:35], v[144:147]
    ds_read_b128 v[88:91], v29 offset:5120
    v_mfma_f32_16x16x32_bf16 v[148:151], v[48:51], v[36:39], v[148:151]
    ds_read_b128 v[92:95], v29 offset:7168
    v_mfma_f32_16x16x32_bf16 v[152:155], v[52:55], v[32:35], v[152:155]
    ds_read_b128 v[96:99], v29 offset:9216
    v_mfma_f32_16x16x32_bf16 v[156:159], v[52:55], v[36:39], v[156:159]
    ds_read_b128 v[100:103], v29 offset:11264
    v_mfma_f32_16x16x32_bf16 v[160:163], v[56:59], v[32:35], v[160:163]
    ds_read_b128 v[104:107], v29 offset:13312
    s_add_u32 m0, s52, 30720
    s_nop 0
    buffer_load_dwordx4 v10, s[20:23], s44 offen offset:0 lds
    v_mfma_f32_16x16x32_bf16 v[164:167], v[56:59], v[36:39], v[164:167]
    buffer_load_dwordx4 v11, s[20:23], s44 offen offset:1024 lds
    v_mfma_f32_16x16x32_bf16 v[168:171], v[60:63], v[32:35], v[168:171]
    buffer_load_dwordx4 v10, s[20:23], s45 offen offset:2048 lds
    v_mfma_f32_16x16x32_bf16 v[172:175], v[60:63], v[36:39], v[172:175]
    buffer_load_dwordx4 v11, s[20:23], s45 offen offset:3072 lds
    ds_read_b32 v15, v13
    v_mfma_f32_16x16x32_bf16 v[176:179], v[64:67], v[32:35], v[176:179]
    s_add_u32 m0, s53, 30720
    s_nop 0
    buffer_load_dwordx4 v12, s[28:31], s42 offen offset:0 lds
    v_mfma_f32_16x16x32_bf16 v[180:183], v[64:67], v[36:39], v[180:183]
    buffer_load_dwordx4 v12, s[28:31], s42 offen offset:1024 lds
    s_waitcnt lgkmcnt(0)
    s_mov_b64 exec, 1
    ds_add_u32 v31, v14
    s_mov_b64 exec, -1
    v_readfirstlane_b32 s48, v15
    s_cmp_ge_u32 s48, 32
    s_cbranch_scc1 K2G_spuna6
K2G_spina6:
    ds_read_b32 v15, v13
    s_add_u32 s55, s55, 1
    s_waitcnt lgkmcnt(0)
    v_readfirstlane_b32 s48, v15
    s_bitcmp1_b32 s55, 22
    s_cbranch_scc1 K2G_spuna6
    s_cmp_ge_u32 s48, 32
    s_cbranch_scc1 K2G_spuna6
    s_sleep 1
    s_branch K2G_spina6
K2G_spuna6:
    v_mfma_f32_16x16x32_bf16 v[128:131], v[80:83], v[72:75], v[128:131]
    ds_read_b128 v[32:35], v18 offset:30720
    v_mfma_f32_16x16x32_bf16 v[132:135], v[80:83], v[76:79], v[132:135]
    ds_read_b128 v[40:43], v29 offset:30720
    v_mfma_f32_16x16x32_bf16 v[136:139], v[84:87], v[72:75], v[136:139]
    ds_read_b128 v[36:39], v18 offset:32768
    v_mfma_f32_16x16x32_bf16 v[140:143], v[84:87], v[76:79], v[140:143]
    ds_read_b128 v[44:47], v29 offset:32768
    v_mfma_f32_16x16x32_bf16 v[144:147], v[88:91], v[72:75], v[144:147]
    ds_read_b128 v[48:51], v29 offset:34816
    v_mfma_f32_16x16x32_bf16 v[148:151], v[88:91], v[76:79], v[148:151]
    ds_read_b128 v[52:55], v29 offset:36864
    v_mfma_f32_16x16x32_bf16 v[152:155], v[92:95], v[72:75], v[152:155]
    ds_read_b128 v[56:59], v29 offset:38912
    v_mfma_f32_16x16x32_bf16 v[156:159], v[92:95], v[76:79], v[156:159]
    ds_read_b128 v[60:63], v29 offset:40960
    v_mfma_f32_16x16x32_bf16 v[160:163], v[96:99], v[72:75], v[160:163]
    ds_read_b128 v[64:67], v29 offset:43008
    buffer_load_dwordx4 v12, s[28:31], s42 offen offset:2048 lds
    v_mfma_f32_16x16x32_bf16 v[164:167], v[96:99], v[76:79], v[164:167]
    buffer_load_dwordx4 v12, s[28:31], s42 offen offset:3072 lds
    s_add_u32 s44, s44, 128
    s_add_u32 s45, s45, 128
    s_add_u32 s42, s42, 14336
    v_mfma_f32_16x16x32_bf16 v[168:171], v[100:103], v[72:75], v[168:171]
    v_mfma_f32_16x16x32_bf16 v[172:175], v[100:103], v[76:79], v[172:175]
    ds_read_b32 v9, v31
    v_mfma_f32_16x16x32_bf16 v[176:179], v[104:107], v[72:75], v[176:179]
    v_mfma_f32_16x16x32_bf16 v[180:183], v[104:107], v[76:79], v[180:183]
    s_waitcnt vmcnt(9)
    s_mov_b64 exec, 1
    ds_add_u32 v13, v14
    s_mov_b64 exec, -1
    s_waitcnt lgkmcnt(1)
    v_readfirstlane_b32 s48, v9
    s_cmp_ge_u32 s48, 28
    s_cbranch_scc1 K2G_spunb7
K2G_spinb7:
    ds_read_b32 v15, v31
    s_add_u32 s55, s55, 1
    s_waitcnt lgkmcnt(0)
    v_readfirstlane_b32 s48, v15
    s_bitcmp1_b32 s55, 22
    s_cbranch_scc1 K2G_spunb7
    s_cmp_ge_u32 s48, 28
    s_cbranch_scc1 K2G_spunb7
    s_sleep 1
    s_branch K2G_spinb7
K2G_spunb7:
    v_mfma_f32_16x16x32_bf16 v[128:131], v[40:43], v[32:35], v[128:131]
    ds_read_b128 v[72:75], v19 offset:30720
    v_mfma_f32_16x16x32_bf16 v[132:135], v[40:43], v[36:39], v[132:135]
    ds_read_b128 v[80:83], v29 offset:31744
    v_mfma_f32_16x16x32_bf16 v[136:139], v[44:47], v[32:35], v[136:139]
    ds_read_b128 v[76:79], v19 offset:32768
    v_mfma_f32_16x16x32_bf16 v[140:143], v[44:47], v[36:39], v[140:143]
    ds_read_b128 v[84:87], v29 offset:33792
    v_mfma_f32_16x16x32_bf16 v[144:147], v[48:51], v[32:35], v[144:147]
    ds_read_b128 v[88:91], v29 offset:35840
    v_mfma_f32_16x16x32_bf16 v[148:151], v[48:51], v[36:39], v[148:151]
    ds_read_b128 v[92:95], v29 offset:37888
    v_mfma_f32_16x16x32_bf16 v[152:155], v[52:55], v[32:35], v[152:155]
    ds_read_b128 v[96:99], v29 offset:39936
    v_mfma_f32_16x16x32_bf16 v[156:159], v[52:55], v[36:39], v[156:159]
    ds_read_b128 v[100:103], v29 offset:41984
    v_mfma_f32_16x16x32_bf16 v[160:163], v[56:59], v[32:35], v[160:163]
    ds_read_b128 v[104:107], v29 offset:44032
    s_add_u32 m0, s52, 61440
    s_nop 0
    buffer_load_dwordx4 v10, s[20:23], s44 offen offset:0 lds
    v_mfma_f32_16x16x32_bf16 v[164:167], v[56:59], v[36:39], v[164:167]
    buffer_load_dwordx4 v11, s[20:23], s44 offen offset:1024 lds
    v_mfma_f32_16x16x32_bf16 v[168:171], v[60:63], v[32:35], v[168:171]
    buffer_load_dwordx4 v10, s[20:23], s45 offen offset:2048 lds
    v_mfma_f32_16x16x32_bf16 v[172:175], v[60:63], v[36:39], v[172:175]
    buffer_load_dwordx4 v11, s[20:23], s45 offen offset:3072 lds
    ds_read_b32 v15, v13
    v_mfma_f32_16x16x32_bf16 v[176:179], v[64:67], v[32:35], v[176:179]
    s_add_u32 m0, s53, 61440
    s_nop 0
    buffer_load_dwordx4 v12, s[28:31], s42 offen offset:0 lds
    v_mfma_f32_16x16x32_bf16 v[180:183], v[64:67], v[36:39], v[180:183]
    buffer_load_dwordx4 v12, s[28:31], s42 offen offset:1024 lds
    s_waitcnt lgkmcnt(0)
    s_mov_b64 exec, 1
    ds_add_u32 v31, v14
    s_mov_b64 exec, -1
    v_readfirstlane_b32 s48, v15
    s_cmp_ge_u32 s48, 36
    s_cbranch_scc1 K2G_spuna7
K2G_spina7:
    ds_read_b32 v15, v13
    s_add_u32 s55, s55, 1
    s_waitcnt lgkmcnt(0)
    v_readfirstlane_b32 s48, v15
    s_bitcmp1_b32 s55, 22
    s_cbranch_scc1 K2G_spuna7
    s_cmp_ge_u32 s48, 36
    s_cbranch_scc1 K2G_spuna7
    s_sleep 1
    s_branch K2G_spina7
K2G_spuna7:
    v_mfma_f32_16x16x32_bf16 v[128:131], v[80:83], v[72:75], v[128:131]
    ds_read_b128 v[32:35], v16 offset:0
    v_mfma_f32_16x16x32_bf16 v[132:135], v[80:83], v[76:79], v[132:135]
    ds_read_b128 v[40:43], v28 offset:0
    v_mfma_f32_16x16x32_bf16 v[136:139], v[84:87], v[72:75], v[136:139]
    ds_read_b128 v[36:39], v16 offset:2048
    v_mfma_f32_16x16x32_bf16 v[140:143], v[84:87], v[76:79], v[140:143]
    ds_read_b128 v[44:47], v28 offset:2048
    v_mfma_f32_16x16x32_bf16 v[144:147], v[88:91], v[72:75], v[144:147]
    ds_read_b128 v[48:51], v28 offset:4096
    v_mfma_f32_16x16x32_bf16 v[148:151], v[88:91], v[76:79], v[148:151]
    ds_read_b128 v[52:55], v28 offset:6144
    v_mfma_f32_16x16x32_bf16 v[152:155], v[92:95], v[72:75], v[152:155]
    ds_read_b128 v[56:59], v28 offset:8192
    v_mfma_f32_16x16x32_bf16 v[156:159], v[92:95], v[76:79], v[156:159]
    ds_read_b128 v[60:63], v28 offset:10240
    v_mfma_f32_16x16x32_bf16 v[160:163], v[96:99], v[72:75], v[160:163]
    ds_read_b128 v[64:67], v28 offset:12288
    buffer_load_dwordx4 v12, s[28:31], s42 offen offset:2048 lds
    v_mfma_f32_16x16x32_bf16 v[164:167], v[96:99], v[76:79], v[164:167]
    buffer_load_dwordx4 v12, s[28:31], s42 offen offset:3072 lds
    s_add_u32 s44, s44, 128
    s_add_u32 s45, s45, 128
    s_add_u32 s42, s42, 14336
    v_mfma_f32_16x16x32_bf16 v[168:171], v[100:103], v[72:75], v[168:171]
    s_cmp_eq_u32 s51, 7
    s_cselect_b32 s48, 0, 0x800000
    v_add_u32 v109, s48, v108
    buffer_load_dword v110, v109, s[20:23], s49 offen offset:1024
    v_mfma_f32_16x16x32_bf16 v[172:175], v[100:103], v[76:79], v[172:175]
    ds_read_b32 v9, v31
    v_mfma_f32_16x16x32_bf16 v[176:179], v[104:107], v[72:75], v[176:179]
    v_mfma_f32_16x16x32_bf16 v[180:183], v[104:107], v[76:79], v[180:183]
    s_waitcnt vmcnt(9)
    s_mov_b64 exec, 1
    ds_add_u32 v13, v14
    s_mov_b64 exec, -1
    s_waitcnt lgkmcnt(1)
    v_readfirstlane_b32 s48, v9
    s_cmp_ge_u32 s48, 32
    s_cbranch_scc1 K2G_spunb8
K2G_spinb8:
    ds_read_b32 v15, v31
    s_add_u32 s55, s55, 1
    s_waitcnt lgkmcnt(0)
    v_readfirstlane_b32 s48, v15
    s_bitcmp1_b32 s55, 22
    s_cbranch_scc1 K2G_spunb8
    s_cmp_ge_u32 s48, 32
    s_cbranch_scc1 K2G_spunb8
    s_sleep 1
    s_branch K2G_spinb8
K2G_spunb8:
    v_mfma_f32_16x16x32_bf16 v[128:131], v[40:43], v[32:35], v[128:131]
    ds_read_b128 v[72:75], v17 offset:0
    v_mfma_f32_16x16x32_bf16 v[132:135], v[40:43], v[36:39], v[132:135]
    ds_read_b128 v[80:83], v28 offset:1024
    v_mfma_f32_16x16x32_bf16 v[136:139], v[44:47], v[32:35], v[136:139]
    ds_read_b128 v[76:79], v17 offset:2048
    v_mfma_f32_16x16x32_bf16 v[140:143], v[44:47], v[36:39], v[140:143]
    ds_read_b128 v[84:87], v28 offset:3072
    v_mfma_f32_16x16x32_bf16 v[144:147], v[48:51], v[32:35], v[144:147]
    ds_read_b128 v[88:91], v28 offset:5120
    v_mfma_f32_16x16x32_bf16 v[148:151], v[48:51], v[36:39], v[148:151]
    ds_read_b128 v[92:95], v28 offset:7168
    v_mfma_f32_16x16x32_bf16 v[152:155], v[52:55], v[32:35], v[152:155]
    ds_read_b128 v[96:99], v28 offset:9216
    v_mfma_f32_16x16x32_bf16 v[156:159], v[52:55], v[36:39], v[156:159]
    ds_read_b128 v[100:103], v28 offset:11264
    v_mfma_f32_16x16x32_bf16 v[160:163], v[56:59], v[32:35], v[160:163]
    ds_read_b128 v[104:107], v28 offset:13312
    s_add_u32 m0, s52, 92160
    s_nop 0
    buffer_load_dwordx4 v10, s[20:23], s44 offen offset:0 lds
    v_mfma_f32_16x16x32_bf16 v[164:167], v[56:59], v[36:39], v[164:167]
    buffer_load_dwordx4 v11, s[20:23], s44 offen offset:1024 lds
    v_mfma_f32_16x16x32_bf16 v[168:171], v[60:63], v[32:35], v[168:171]
    buffer_load_dwordx4 v10, s[20:23], s45 offen offset:2048 lds
    v_mfma_f32_16x16x32_bf16 v[172:175], v[60:63], v[36:39], v[172:175]
    buffer_load_dwordx4 v11, s[20:23], s45 offen offset:3072 lds
    ds_read_b32 v15, v13
    v_mfma_f32_16x16x32_bf16 v[176:179], v[64:67], v[32:35], v[176:179]
    s_add_u32 m0, s53, 92160
    s_nop 0
    buffer_load_dwordx4 v12, s[28:31], s42 offen offset:0 lds
    v_mfma_f32_16x16x32_bf16 v[180:183], v[64:67], v[36:39], v[180:183]
    buffer_load_dwordx4 v12, s[28:31], s42 offen offset:1024 lds
    s_waitcnt lgkmcnt(0)
    s_mov_b64 exec, 1
    ds_add_u32 v31, v14
    s_mov_b64 exec, -1
    v_readfirstlane_b32 s48, v15
    s_cmp_ge_u32 s48, 40
    s_cbranch_scc1 K2G_spuna8
K2G_spina8:
    ds_read_b32 v15, v13
    s_add_u32 s55, s55, 1
    s_waitcnt lgkmcnt(0)
    v_readfirstlane_b32 s48, v15
    s_bitcmp1_b32 s55, 22
    s_cbranch_scc1 K2G_spuna8
    s_cmp_ge_u32 s48, 40
    s_cbranch_scc1 K2G_spuna8
    s_sleep 1
    s_branch K2G_spina8
K2G_spuna8:
    v_mfma_f32_16x16x32_bf16 v[128:131], v[80:83], v[72:75], v[128:131]
    ds_read_b128 v[32:35], v16 offset:30720
    v_mfma_f32_16x16x32_bf16 v[132:135], v[80:83], v[76:79], v[132:135]
    ds_read_b128 v[40:43], v28 offset:30720
    v_mfma_f32_16x16x32_bf16 v[136:139], v[84:87], v[72:75], v[136:139]
    ds_read_b128 v[36:39], v16 offset:32768
    v_mfma_f32_16x16x32_bf16 v[140:143], v[84:87], v[76:79], v[140:143]
    ds_read_b128 v[44:47], v28 offset:32768
    v_mfma_f32_16x16x32_bf16 v[144:147], v[88:91], v[72:75], v[144:147]
    ds_read_b128 v[48:51], v28 offset:34816
    v_mfma_f32_16x16x32_bf16 v[148:151], v[88:91], v[76:79], v[148:151]
    ds_read_b128 v[52:55], v28 offset:36864
    v_mfma_f32_16x16x32_bf16 v[152:155], v[92:95], v[72:75], v[152:155]
    ds_read_b128 v[56:59], v28 offset:38912
    v_mfma_f32_16x16x32_bf16 v[156:159], v[92:95], v[76:79], v[156:159]
    ds_read_b128 v[60:63], v28 offset:40960
    v_mfma_f32_16x16x32_bf16 v[160:163], v[96:99], v[72:75], v[160:163]
    ds_read_b128 v[64:67], v28 offset:43008
    buffer_load_dwordx4 v12, s[28:31], s42 offen offset:2048 lds
    v_mfma_f32_16x16x32_bf16 v[164:167], v[96:99], v[76:79], v[164:167]
    buffer_load_dwordx4 v12, s[28:31], s42 offen offset:3072 lds
    s_add_u32 s44, s44, 128
    s_add_u32 s45, s45, 128
    s_add_u32 s42, s42, 14336
    v_mfma_f32_16x16x32_bf16 v[168:171], v[100:103], v[72:75], v[168:171]
    v_mfma_f32_16x16x32_bf16 v[172:175], v[100:103], v[76:79], v[172:175]
    ds_read_b32 v9, v31
    v_mfma_f32_16x16x32_bf16 v[176:179], v[104:107], v[72:75], v[176:179]
    v_mfma_f32_16x16x32_bf16 v[180:183], v[104:107], v[76:79], v[180:183]
    s_waitcnt vmcnt(9)
    s_mov_b64 exec, 1
    ds_add_u32 v13, v14
    s_mov_b64 exec, -1
    s_waitcnt lgkmcnt(1)
    v_readfirstlane_b32 s48, v9
    s_cmp_ge_u32 s48, 36
    s_cbranch_scc1 K2G_spunb9
K2G_spinb9:
    ds_read_b32 v15, v31
    s_add_u32 s55, s55, 1
    s_waitcnt lgkmcnt(0)
    v_readfirstlane_b32 s48, v15
    s_bitcmp1_b32 s55, 22
    s_cbranch_scc1 K2G_spunb9
    s_cmp_ge_u32 s48, 36
    s_cbranch_scc1 K2G_spunb9
    s_sleep 1
    s_branch K2G_spinb9
K2G_spunb9:
    v_mfma_f32_16x16x32_bf16 v[128:131], v[40:43], v[32:35], v[128:131]
    ds_read_b128 v[72:75], v17 offset:30720
    v_mfma_f32_16x16x32_bf16 v[132:135], v[40:43], v[36:39], v[132:135]
    ds_read_b128 v[80:83], v28 offset:31744
    v_mfma_f32_16x16x32_bf16 v[136:139], v[44:47], v[32:35], v[136:139]
    ds_read_b128 v[76:79], v17 offset:32768
    v_mfma_f32_16x16x32_bf16 v[140:143], v[44:47], v[36:39], v[140:143]
    ds_read_b128 v[84:87], v28 offset:33792
    v_mfma_f32_16x16x32_bf16 v[144:147], v[48:51], v[32:35], v[144:147]
    ds_read_b128 v[88:91], v28 offset:35840
    v_mfma_f32_16x16x32_bf16 v[148:151], v[48:51], v[36:39], v[148:151]
    ds_read_b128 v[92:95], v28 offset:37888
    v_mfma_f32_16x16x32_bf16 v[152:155], v[52:55], v[32:35], v[152:155]
    ds_read_b128 v[96:99], v28 offset:39936
    v_mfma_f32_16x16x32_bf16 v[156:159], v[52:55], v[36:39], v[156:159]
    ds_read_b128 v[100:103], v28 offset:41984
    v_mfma_f32_16x16x32_bf16 v[160:163], v[56:59], v[32:35], v[160:163]
    ds_read_b128 v[104:107], v28 offset:44032
    s_add_u32 m0, s52, 0
    s_nop 0
    buffer_load_dwordx4 v10, s[20:23], s44 offen offset:0 lds
    v_mfma_f32_16x16x32_bf16 v[164:167], v[56:59], v[36:39], v[164:167]
    buffer_load_dwordx4 v11, s[20:23], s44 offen offset:1024 lds
    v_mfma_f32_16x16x32_bf16 v[168:171], v[60:63], v[32:35], v[168:171]
    buffer_load_dwordx4 v10, s[20:23], s45 offen offset:2048 lds
    v_mfma_f32_16x16x32_bf16 v[172:175], v[60:63], v[36:39], v[172:175]
    buffer_load_dwordx4 v11, s[20:23], s45 offen offset:3072 lds
    ds_read_b32 v15, v13
    v_mfma_f32_16x16x32_bf16 v[176:179], v[64:67], v[32:35], v[176:179]
    s_add_u32 m0, s53, 0
    s_nop 0
    buffer_load_dwordx4 v12, s[28:31], s42 offen offset:0 lds
    v_mfma_f32_16x16x32_bf16 v[180:183], v[64:67], v[36:39], v[180:183]
    buffer_load_dwordx4 v12, s[28:31], s42 offen offset:1024 lds
    s_waitcnt lgkmcnt(0)
    s_mov_b64 exec, 1
    ds_add_u32 v31, v14
    s_mov_b64 exec, -1
    v_readfirstlane_b32 s48, v15
    s_cmp_ge_u32 s48, 44
    s_cbranch_scc1 K2G_spuna9
K2G_spina9:
    ds_read_b32 v15, v13
    s_add_u32 s55, s55, 1
    s_waitcnt lgkmcnt(0)
    v_readfirstlane_b32 s48, v15
    s_bitcmp1_b32 s55, 22
    s_cbranch_scc1 K2G_spuna9
    s_cmp_ge_u32 s48, 44
    s_cbranch_scc1 K2G_spuna9
    s_sleep 1
    s_branch K2G_spina9
K2G_spuna9:
    v_mfma_f32_16x16x32_bf16 v[128:131], v[80:83], v[72:75], v[128:131]
    ds_read_b128 v[32:35], v18 offset:0
    v_mfma_f32_16x16x32_bf16 v[132:135], v[80:83], v[76:79], v[132:135]
    ds_read_b128 v[40:43], v29 offset:0
    v_mfma_f32_16x16x32_bf16 v[136:139], v[84:87], v[72:75], v[136:139]
    ds_read_b128 v[36:39], v18 offset:2048
    v_mfma_f32_16x16x32_bf16 v[140:143], v[84:87], v[76:79], v[140:143]
    ds_read_b128 v[44:47], v29 offset:2048
    v_mfma_f32_16x16x32_bf16 v[144:147], v[88:91], v[72:75], v[144:147]
    ds_read_b128 v[48:51], v29 offset:4096
    v_mfma_f32_16x16x32_bf16 v[148:151], v[88:91], v[76:79], v[148:151]
    ds_read_b128 v[52:55], v29 offset:6144
    v_mfma_f32_16x16x32_bf16 v[152:155], v[92:95], v[72:75], v[152:155]
    ds_read_b128 v[56:59], v29 offset:8192
    v_mfma_f32_16x16x32_bf16 v[156:159], v[92:95], v[76:79], v[156:159]
    ds_read_b128 v[60:63], v29 offset:10240
    v_mfma_f32_16x16x32_bf16 v[160:163], v[96:99], v[72:75], v[160:163]
    ds_read_b128 v[64:67], v29 offset:12288
    buffer_load_dwordx4 v12, s[28:31], s42 offen offset:2048 lds
    v_mfma_f32_16x16x32_bf16 v[164:167], v[96:99], v[76:79], v[164:167]
    buffer_load_dwordx4 v12, s[28:31], s42 offen offset:3072 lds
    s_add_u32 s44, s44, 128
    s_add_u32 s45, s45, 128
    s_add_u32 s42, s42, 14336
    v_mfma_f32_16x16x32_bf16 v[168:171], v[100:103], v[72:75], v[168:171]
    v_mfma_f32_16x16x32_bf16 v[172:175], v[100:103], v[76:79], v[172:175]
    ds_read_b32 v9, v31
    v_mfma_f32_16x16x32_bf16 v[176:179], v[104:107], v[72:75], v[176:179]
    v_mfma_f32_16x16x32_bf16 v[180:183], v[104:107], v[76:79], v[180:183]
    s_waitcnt vmcnt(8)
    s_mov_b64 exec, 1
    ds_add_u32 v13, v14
    s_mov_b64 exec, -1
    s_waitcnt lgkmcnt(1)
    v_readfirstlane_b32 s48, v9
    s_cmp_ge_u32 s48, 40
    s_cbranch_scc1 K2G_spunb10
K2G_spinb10:
    ds_read_b32 v15, v31
    s_add_u32 s55, s55, 1
    s_waitcnt lgkmcnt(0)
    v_readfirstlane_b32 s48, v15
    s_bitcmp1_b32 s55, 22
    s_cbranch_scc1 K2G_spunb10
    s_cmp_ge_u32 s48, 40
    s_cbranch_scc1 K2G_spunb10
    s_sleep 1
    s_branch K2G_spinb10
K2G_spunb10:
    v_mfma_f32_16x16x32_bf16 v[128:131], v[40:43], v[32:35], v[128:131]
    ds_read_b128 v[72:75], v19 offset:0
    v_mfma_f32_16x16x32_bf16 v[132:135], v[40:43], v[36:39], v[132:135]
    ds_read_b128 v[80:83], v29 offset:1024
    v_mfma_f32_16x16x32_bf16 v[136:139], v[44:47], v[32:35], v[136:139]
    ds_read_b128 v[76:79], v19 offset:2048
    v_mfma_f32_16x16x32_bf16 v[140:143], v[44:47], v[36:39], v[140:143]
    ds_read_b128 v[84:87], v29 offset:3072
    v_mfma_f32_16x16x32_bf16 v[144:147], v[48:51], v[32:35], v[144:147]
    ds_read_b128 v[88:91], v29 offset:5120
    v_mfma_f32_16x16x32_bf16 v[148:151], v[48:51], v[36:39], v[148:151]
    ds_read_b128 v[92:95], v29 offset:7168
    v_mfma_f32_16x16x32_bf16 v[152:155], v[52:55], v[32:35], v[152:155]
    ds_read_b128 v[96:99], v29 offset:9216
    v_mfma_f32_16x16x32_bf16 v[156:159], v[52:55], v[36:39], v[156:159]
    ds_read_b128 v[100:103], v29 offset:11264
    v_mfma_f32_16x16x32_bf16 v[160:163], v[56:59], v[32:35], v[160:163]
    ds_read_b128 v[104:107], v29 offset:13312
    s_add_u32 m0, s52, 30720
    s_nop 0
    buffer_load_dwordx4 v10, s[20:23], s44 offen offset:0 lds
    v_mfma_f32_16x16x32_bf16 v[164:167], v[56:59], v[36:39], v[164:167]
    buffer_load_dwordx4 v11, s[20:23], s44 offen offset:1024 lds
    v_mfma_f32_16x16x32_bf16 v[168:171], v[60:63], v[32:35], v[168:171]
    buffer_load_dwordx4 v10, s[20:23], s45 offen offset:2048 lds
    v_mfma_f32_16x16x32_bf16 v[172:175], v[60:63], v[36:39], v[172:175]
    buffer_load_dwordx4 v11, s[20:23], s45 offen offset:3072 lds
    ds_read_b32 v15, v13
    v_mfma_f32_16x16x32_bf16 v[176:179], v[64:67], v[32:35], v[176:179]
    s_add_u32 m0, s53, 30720
    s_nop 0
    buffer_load_dwordx4 v12, s[28:31], s42 offen offset:0 lds
    v_mfma_f32_16x16x32_bf16 v[180:183], v[64:67], v[36:39], v[180:183]
    buffer_load_dwordx4 v12, s[28:31], s42 offen offset:1024 lds
    s_waitcnt lgkmcnt(0)
    s_mov_b64 exec, 1
    ds_add_u32 v31, v14
    s_mov_b64 exec, -1
    v_readfirstlane_b32 s48, v15
    s_cmp_ge_u32 s48, 48
    s_cbranch_scc1 K2G_spuna10
K2G_spina10:
    ds_read_b32 v15, v13
    s_add_u32 s55, s55, 1
    s_waitcnt lgkmcnt(0)
    v_readfirstlane_b32 s48, v15
    s_bitcmp1_b32 s55, 22
    s_cbranch_scc1 K2G_spuna10
    s_cmp_ge_u32 s48, 48
    s_cbranch_scc1 K2G_spuna10
    s_sleep 1
    s_branch K2G_spina10
K2G_spuna10:
    v_mfma_f32_16x16x32_bf16 v[128:131], v[80:83], v[72:75], v[128:131]
    ds_read_b128 v[32:35], v18 offset:30720
    v_mfma_f32_16x16x32_bf16 v[132:135], v[80:83], v[76:79], v[132:135]
    ds_read_b128 v[40:43], v29 offset:30720
    v_mfma_f32_16x16x32_bf16 v[136:139], v[84:87], v[72:75], v[136:139]
    ds_read_b128 v[36:39], v18 offset:32768
    v_mfma_f32_16x16x32_bf16 v[140:143], v[84:87], v[76:79], v[140:143]
    ds_read_b128 v[44:47], v29 offset:32768
    v_mfma_f32_16x16x32_bf16 v[144:147], v[88:91], v[72:75], v[144:147]
    ds_read_b128 v[48:51], v29 offset:34816
    v_mfma_f32_16x16x32_bf16 v[148:151], v[88:91], v[76:79], v[148:151]
    ds_read_b128 v[52:55], v29 offset:36864
    v_mfma_f32_16x16x32_bf16 v[152:155], v[92:95], v[72:75], v[152:155]
    ds_read_b128 v[56:59], v29 offset:38912
    v_mfma_f32_16x16x32_bf16 v[156:159], v[92:95], v[76:79], v[156:159]
    ds_read_b128 v[60:63], v29 offset:40960
    v_mfma_f32_16x16x32_bf16 v[160:163], v[96:99], v[72:75], v[160:163]
    ds_read_b128 v[64:67], v29 offset:43008
    buffer_load_dwordx4 v12, s[28:31], s42 offen offset:2048 lds
    v_mfma_f32_16x16x32_bf16 v[164:167], v[96:99], v[76:79], v[164:167]
    buffer_load_dwordx4 v12, s[28:31], s42 offen offset:3072 lds
    s_add_u32 s44, s44, 128
    s_add_u32 s45, s45, 128
    s_add_u32 s42, s42, 14336
    v_mfma_f32_16x16x32_bf16 v[168:171], v[100:103], v[72:75], v[168:171]
    v_mfma_f32_16x16x32_bf16 v[172:175], v[100:103], v[76:79], v[172:175]
    ds_read_b32 v9, v31
    v_mfma_f32_16x16x32_bf16 v[176:179], v[104:107], v[72:75], v[176:179]
    v_mfma_f32_16x16x32_bf16 v[180:183], v[104:107], v[76:79], v[180:183]
    s_waitcnt vmcnt(8)
    s_mov_b64 exec, 1
    ds_add_u32 v13, v14
    s_mov_b64 exec, -1
    s_waitcnt lgkmcnt(1)
    v_readfirstlane_b32 s48, v9
    s_cmp_ge_u32 s48, 44
    s_cbranch_scc1 K2G_spunb11
K2G_spinb11:
    ds_read_b32 v15, v31
    s_add_u32 s55, s55, 1
    s_waitcnt lgkmcnt(0)
    v_readfirstlane_b32 s48, v15
    s_bitcmp1_b32 s55, 22
    s_cbranch_scc1 K2G_spunb11
    s_cmp_ge_u32 s48, 44
    s_cbranch_scc1 K2G_spunb11
    s_sleep 1
    s_branch K2G_spinb11
K2G_spunb11:
    v_mfma_f32_16x16x32_bf16 v[128:131], v[40:43], v[32:35], v[128:131]
    ds_read_b128 v[72:75], v19 offset:30720
    v_mfma_f32_16x16x32_bf16 v[132:135], v[40:43], v[36:39], v[132:135]
    ds_read_b128 v[80:83], v29 offset:31744
    v_mfma_f32_16x16x32_bf16 v[136:139], v[44:47], v[32:35], v[136:139]
    ds_read_b128 v[76:79], v19 offset:32768
    v_mfma_f32_16x16x32_bf16 v[140:143], v[44:47], v[36:39], v[140:143]
    ds_read_b128 v[84:87], v29 offset:33792
    v_mfma_f32_16x16x32_bf16 v[144:147], v[48:51], v[32:35], v[144:147]
    ds_read_b128 v[88:91], v29 offset:35840
    v_mfma_f32_16x16x32_bf16 v[148:151], v[48:51], v[36:39], v[148:151]
    ds_read_b128 v[92:95], v29 offset:37888
    v_mfma_f32_16x16x32_bf16 v[152:155], v[52:55], v[32:35], v[152:155]
    ds_read_b128 v[96:99], v29 offset:39936
    v_mfma_f32_16x16x32_bf16 v[156:159], v[52:55], v[36:39], v[156:159]
    ds_read_b128 v[100:103], v29 offset:41984
    v_mfma_f32_16x16x32_bf16 v[160:163], v[56:59], v[32:35], v[160:163]
    ds_read_b128 v[104:107], v29 offset:44032
    s_add_u32 m0, s52, 61440
    s_nop 0
    buffer_load_dwordx4 v10, s[20:23], s44 offen offset:0 lds
    v_mfma_f32_16x16x32_bf16 v[164:167], v[56:59], v[36:39], v[164:167]
    buffer_load_dwordx4 v11, s[20:23], s44 offen offset:1024 lds
    v_mfma_f32_16x16x32_bf16 v[168:171], v[60:63], v[32:35], v[168:171]
    buffer_load_dwordx4 v10, s[20:23], s45 offen offset:2048 lds
    v_mfma_f32_16x16x32_bf16 v[172:175], v[60:63], v[36:39], v[172:175]
    buffer_load_dwordx4 v11, s[20:23], s45 offen offset:3072 lds
    ds_read_b32 v15, v13
    v_mfma_f32_16x16x32_bf16 v[176:179], v[64:67], v[32:35], v[176:179]
    s_add_u32 m0, s53, 61440
    s_nop 0
    buffer_load_dwordx4 v12, s[28:31], s42 offen offset:0 lds
    v_mfma_f32_16x16x32_bf16 v[180:183], v[64:67], v[36:39], v[180:183]
    buffer_load_dwordx4 v12, s[28:31], s42 offen offset:1024 lds
    s_waitcnt lgkmcnt(0)
    s_mov_b64 exec, 1
    ds_add_u32 v31, v14
    s_mov_b64 exec, -1
    v_readfirstlane_b32 s48, v15
    s_cmp_ge_u32 s48, 52
    s_cbranch_scc1 K2G_spuna11
K2G_spina11:
    ds_read_b32 v15, v13
    s_add_u32 s55, s55, 1
    s_waitcnt lgkmcnt(0)
    v_readfirstlane_b32 s48, v15
    s_bitcmp1_b32 s55, 22
    s_cbranch_scc1 K2G_spuna11
    s_cmp_ge_u32 s48, 52
    s_cbranch_scc1 K2G_spuna11
    s_sleep 1
    s_branch K2G_spina11
K2G_spuna11:
    v_mfma_f32_16x16x32_bf16 v[128:131], v[80:83], v[72:75], v[128:131]
    ds_read_b128 v[32:35], v16 offset:0
    v_mfma_f32_16x16x32_bf16 v[132:135], v[80:83], v[76:79], v[132:135]
    ds_read_b128 v[40:43], v28 offset:0
    v_mfma_f32_16x16x32_bf16 v[136:139], v[84:87], v[72:75], v[136:139]
    ds_read_b128 v[36:39], v16 offset:2048
    v_mfma_f32_16x16x32_bf16 v[140:143], v[84:87], v[76:79], v[140:143]
    ds_read_b128 v[44:47], v28 offset:2048
    v_mfma_f32_16x16x32_bf16 v[144:147], v[88:91], v[72:75], v[144:147]
    ds_read_b128 v[48:51], v28 offset:4096
    v_mfma_f32_16x16x32_bf16 v[148:151], v[88:91], v[76:79], v[148:151]
    ds_read_b128 v[52:55], v28 offset:6144
    v_mfma_f32_16x16x32_bf16 v[152:155], v[92:95], v[72:75], v[152:155]
    ds_read_b128 v[56:59], v28 offset:8192
    v_mfma_f32_16x16x32_bf16 v[156:159], v[92:95], v[76:79], v[156:159]
    ds_read_b128 v[60:63], v28 offset:10240
    v_mfma_f32_16x16x32_bf16 v[160:163], v[96:99], v[72:75], v[160:163]
    ds_read_b128 v[64:67], v28 offset:12288
    buffer_load_dwordx4 v12, s[28:31], s42 offen offset:2048 lds
    v_mfma_f32_16x16x32_bf16 v[164:167], v[96:99], v[76:79], v[164:167]
    buffer_load_dwordx4 v12, s[28:31], s42 offen offset:3072 lds
    s_add_u32 s44, s44, 128
    s_add_u32 s45, s45, 128
    s_add_u32 s42, s42, 14336
    v_mfma_f32_16x16x32_bf16 v[168:171], v[100:103], v[72:75], v[168:171]
    v_mfma_f32_16x16x32_bf16 v[172:175], v[100:103], v[76:79], v[172:175]
    ds_read_b32 v9, v31
    v_mfma_f32_16x16x32_bf16 v[176:179], v[104:107], v[72:75], v[176:179]
    v_mfma_f32_16x16x32_bf16 v[180:183], v[104:107], v[76:79], v[180:183]
    s_waitcnt vmcnt(8)
    s_mov_b64 exec, 1
    ds_add_u32 v13, v14
    s_mov_b64 exec, -1
    s_waitcnt lgkmcnt(1)
    v_readfirstlane_b32 s48, v9
    s_cmp_ge_u32 s48, 48
    s_cbranch_scc1 K2G_spunb12
K2G_spinb12:
    ds_read_b32 v15, v31
    s_add_u32 s55, s55, 1
    s_waitcnt lgkmcnt(0)
    v_readfirstlane_b32 s48, v15
    s_bitcmp1_b32 s55, 22
    s_cbranch_scc1 K2G_spunb12
    s_cmp_ge_u32 s48, 48
    s_cbranch_scc1 K2G_spunb12
    s_sleep 1
    s_branch K2G_spinb12
K2G_spunb12:
    v_mfma_f32_16x16x32_bf16 v[128:131], v[40:43], v[32:35], v[128:131]
    ds_read_b128 v[72:75], v17 offset:0
    v_mfma_f32_16x16x32_bf16 v[132:135], v[40:43], v[36:39], v[132:135]
    ds_read_b128 v[80:83], v28 offset:1024
    v_mfma_f32_16x16x32_bf16 v[136:139], v[44:47], v[32:35], v[136:139]
    ds_read_b128 v[76:79], v17 offset:2048
    v_mfma_f32_16x16x32_bf16 v[140:143], v[44:47], v[36:39], v[140:143]
    ds_read_b128 v[84:87], v28 offset:3072
    v_mfma_f32_16x16x32_bf16 v[144:147], v[48:51], v[32:35], v[144:147]
    ds_read_b128 v[88:91], v28 offset:5120
    v_mfma_f32_16x16x32_bf16 v[148:151], v[48:51], v[36:39], v[148:151]
    ds_read_b128 v[92:95], v28 offset:7168
    v_mfma_f32_16x16x32_bf16 v[152:155], v[52:55], v[32:35], v[152:155]
    ds_read_b128 v[96:99], v28 offset:9216
    v_mfma_f32_16x16x32_bf16 v[156:159], v[52:55], v[36:39], v[156:159]
    ds_read_b128 v[100:103], v28 offset:11264
    v_mfma_f32_16x16x32_bf16 v[160:163], v[56:59], v[32:35], v[160:163]
    ds_read_b128 v[104:107], v28 offset:13312
    s_add_u32 m0, s52, 92160
    s_nop 0
    buffer_load_dwordx4 v10, s[20:23], s44 offen offset:0 lds
    v_mfma_f32_16x16x32_bf16 v[164:167], v[56:59], v[36:39], v[164:167]
    buffer_load_dwordx4 v11, s[20:23], s44 offen offset:1024 lds
    v_mfma_f32_16x16x32_bf16 v[168:171], v[60:63], v[32:35], v[168:171]
    buffer_load_dwordx4 v10, s[20:23], s45 offen offset:2048 lds
    v_mfma_f32_16x16x32_bf16 v[172:175], v[60:63], v[36:39], v[172:175]
    buffer_load_dwordx4 v11, s[20:23], s45 offen offset:3072 lds
    ds_read_b32 v15, v13
    v_mfma_f32_16x16x32_bf16 v[176:179], v[64:67], v[32:35], v[176:179]
    s_add_u32 m0, s53, 92160
    s_nop 0
    buffer_load_dwordx4 v12, s[28:31], s42 offen offset:0 lds
    v_mfma_f32_16x16x32_bf16 v[180:183], v[64:67], v[36:39], v[180:183]
    buffer_load_dwordx4 v12, s[28:31], s42 offen offset:1024 lds
    s_waitcnt lgkmcnt(0)
    v_readfirstlane_b32 s48, v15
    s_cmp_ge_u32 s48, 56
    s_cbranch_scc1 K2G_spuna12
K2G_spina12:
    ds_read_b32 v15, v13
    s_add_u32 s55, s55, 1
    s_waitcnt lgkmcnt(0)
    v_readfirstlane_b32 s48, v15
    s_bitcmp1_b32 s55, 22
    s_cbranch_scc1 K2G_spuna12
    s_cmp_ge_u32 s48, 56
    s_cbranch_scc1 K2G_spuna12
    s_sleep 1
    s_branch K2G_spina12
K2G_spuna12:
    v_mfma_f32_16x16x32_bf16 v[128:131], v[80:83], v[72:75], v[128:131]
    ds_read_b128 v[32:35], v16 offset:30720
    v_mfma_f32_16x16x32_bf16 v[132:135], v[80:83], v[76:79], v[132:135]
    ds_read_b128 v[40:43], v28 offset:30720
    v_mfma_f32_16x16x32_bf16 v[136:139], v[84:87], v[72:75], v[136:139]
    ds_read_b128 v[36:39], v16 offset:32768
    v_mfma_f32_16x16x32_bf16 v[140:143], v[84:87], v[76:79], v[140:143]
    ds_read_b128 v[44:47], v28 offset:32768
    v_mfma_f32_16x16x32_bf16 v[144:147], v[88:91], v[72:75], v[144:147]
    ds_read_b128 v[48:51], v28 offset:34816
    v_mfma_f32_16x16x32_bf16 v[148:151], v[88:91], v[76:79], v[148:151]
    ds_read_b128 v[52:55], v28 offset:36864
    v_mfma_f32_16x16x32_bf16 v[152:155], v[92:95], v[72:75], v[152:155]
    ds_read_b128 v[56:59], v28 offset:38912
    v_mfma_f32_16x16x32_bf16 v[156:159], v[92:95], v[76:79], v[156:159]
    ds_read_b128 v[60:63], v28 offset:40960
    v_mfma_f32_16x16x32_bf16 v[160:163], v[96:99], v[72:75], v[160:163]
    ds_read_b128 v[64:67], v28 offset:43008
    buffer_load_dwordx4 v12, s[28:31], s42 offen offset:2048 lds
    v_mfma_f32_16x16x32_bf16 v[164:167], v[96:99], v[76:79], v[164:167]
    buffer_load_dwordx4 v12, s[28:31], s42 offen offset:3072 lds
    s_add_u32 s44, s44, 128
    s_add_u32 s45, s45, 128
    s_add_u32 s42, s42, 14336
    v_mfma_f32_16x16x32_bf16 v[168:171], v[100:103], v[72:75], v[168:171]
    v_mfma_f32_16x16x32_bf16 v[172:175], v[100:103], v[76:79], v[172:175]
    v_mfma_f32_16x16x32_bf16 v[176:179], v[104:107], v[72:75], v[176:179]
    v_mfma_f32_16x16x32_bf16 v[180:183], v[104:107], v[76:79], v[180:183]
    s_waitcnt vmcnt(8)
    s_mov_b64 exec, 1
    ds_add_u32 v13, v14
    s_mov_b64 exec, -1
    s_waitcnt lgkmcnt(9)
    s_waitcnt lgkmcnt(8)
    v_mfma_f32_16x16x32_bf16 v[128:131], v[40:43], v[32:35], v[128:131]
    ds_read_b128 v[72:75], v17 offset:30720
    s_waitcnt lgkmcnt(8)
    v_mfma_f32_16x16x32_bf16 v[132:135], v[40:43], v[36:39], v[132:135]
    ds_read_b128 v[80:83], v28 offset:31744
    s_waitcnt lgkmcnt(8)
    v_mfma_f32_16x16x32_bf16 v[136:139], v[44:47], v[32:35], v[136:139]
    ds_read_b128 v[76:79], v17 offset:32768
    v_mfma_f32_16x16x32_bf16 v[140:143], v[44:47], v[36:39], v[140:143]
    ds_read_b128 v[84:87], v28 offset:33792
    s_waitcnt lgkmcnt(9)
    v_mfma_f32_16x16x32_bf16 v[144:147], v[48:51], v[32:35], v[144:147]
    ds_read_b128 v[88:91], v28 offset:35840
    v_mfma_f32_16x16x32_bf16 v[148:151], v[48:51], v[36:39], v[148:151]
    ds_read_b128 v[92:95], v28 offset:37888
    s_waitcnt lgkmcnt(10)
    v_mfma_f32_16x16x32_bf16 v[152:155], v[52:55], v[32:35], v[152:155]
    ds_read_b128 v[96:99], v28 offset:39936
    v_mfma_f32_16x16x32_bf16 v[156:159], v[52:55], v[36:39], v[156:159]
    ds_read_b128 v[100:103], v28 offset:41984
    s_waitcnt lgkmcnt(11)
    v_mfma_f32_16x16x32_bf16 v[160:163], v[56:59], v[32:35], v[160:163]
    ds_read_b128 v[104:107], v28 offset:44032
    v_mfma_f32_16x16x32_bf16 v[164:167], v[56:59], v[36:39], v[164:167]
    s_waitcnt lgkmcnt(11)
    v_mfma_f32_16x16x32_bf16 v[168:171], v[60:63], v[32:35], v[168:171]
    v_mfma_f32_16x16x32_bf16 v[172:175], v[60:63], v[36:39], v[172:175]
    ds_read_b32 v15, v13
    s_waitcnt lgkmcnt(11)
    v_mfma_f32_16x16x32_bf16 v[176:179], v[64:67], v[32:35], v[176:179]
    v_mfma_f32_16x16x32_bf16 v[180:183], v[64:67], v[36:39], v[180:183]
    s_waitcnt lgkmcnt(0)
    v_readfirstlane_b32 s48, v15
    s_cmp_ge_u32 s48, 60
    s_cbranch_scc1 K2G_spuna13
K2G_spina13:
    ds_read_b32 v15, v13
    s_add_u32 s55, s55, 1
    s_waitcnt lgkmcnt(0)
    v_readfirstlane_b32 s48, v15
    s_bitcmp1_b32 s55, 22
    s_cbranch_scc1 K2G_spuna13
    s_cmp_ge_u32 s48, 60
    s_cbranch_scc1 K2G_spuna13
    s_sleep 1
    s_branch K2G_spina13
K2G_spuna13:
    v_mfma_f32_16x16x32_bf16 v[128:131], v[80:83], v[72:75], v[128:131]
    ds_read_b128 v[32:35], v18 offset:0
    v_mfma_f32_16x16x32_bf16 v[132:135], v[80:83], v[76:79], v[132:135]
    ds_read_b128 v[40:43], v29 offset:0
    v_mfma_f32_16x16x32_bf16 v[136:139], v[84:87], v[72:75], v[136:139]
    ds_read_b128 v[36:39], v18 offset:2048
    v_mfma_f32_16x16x32_bf16 v[140:143], v[84:87], v[76:79], v[140:143]
    ds_read_b128 v[44:47], v29 offset:2048
    v_mfma_f32_16x16x32_bf16 v[144:147], v[88:91], v[72:75], v[144:147]
    ds_read_b128 v[48:51], v29 offset:4096
    v_mfma_f32_16x16x32_bf16 v[148:151], v[88:91], v[76:79], v[148:151]
    ds_read_b128 v[52:55], v29 offset:6144
    v_mfma_f32_16x16x32_bf16 v[152:155], v[92:95], v[72:75], v[152:155]
    ds_read_b128 v[56:59], v29 offset:8192
    v_mfma_f32_16x16x32_bf16 v[156:159], v[92:95], v[76:79], v[156:159]
    ds_read_b128 v[60:63], v29 offset:10240
    v_mfma_f32_16x16x32_bf16 v[160:163], v[96:99], v[72:75], v[160:163]
    ds_read_b128 v[64:67], v29 offset:12288
    v_mfma_f32_16x16x32_bf16 v[164:167], v[96:99], v[76:79], v[164:167]
    v_mfma_f32_16x16x32_bf16 v[168:171], v[100:103], v[72:75], v[168:171]
    v_mfma_f32_16x16x32_bf16 v[172:175], v[100:103], v[76:79], v[172:175]
    v_mfma_f32_16x16x32_bf16 v[176:179], v[104:107], v[72:75], v[176:179]
    v_mfma_f32_16x16x32_bf16 v[180:183], v[104:107], v[76:79], v[180:183]
    s_waitcnt vmcnt(0)
    s_mov_b64 exec, 1
    ds_add_u32 v13, v14
    s_mov_b64 exec, -1
    s_waitcnt lgkmcnt(9)
    s_waitcnt lgkmcnt(8)
    v_mfma_f32_16x16x32_bf16 v[128:131], v[40:43], v[32:35], v[128:131]
    ds_read_b128 v[72:75], v19 offset:0
    s_waitcnt lgkmcnt(8)
    v_mfma_f32_16x16x32_bf16 v[132:135], v[40:43], v[36:39], v[132:135]
    ds_read_b128 v[80:83], v29 offset:1024
    s_waitcnt lgkmcnt(8)
    v_mfma_f32_16x16x32_bf16 v[136:139], v[44:47], v[32:35], v[136:139]
    ds_read_b128 v[76:79], v19 offset:2048
    v_mfma_f32_16x16x32_bf16 v[140:143], v[44:47], v[36:39], v[140:143]
    ds_read_b128 v[84:87], v29 offset:3072
    s_waitcnt lgkmcnt(9)
    v_mfma_f32_16x16x32_bf16 v[144:147], v[48:51], v[32:35], v[144:147]
    ds_read_b128 v[88:91], v29 offset:5120
    v_mfma_f32_16x16x32_bf16 v[148:151], v[48:51], v[36:39], v[148:151]
    ds_read_b128 v[92:95], v29 offset:7168
    s_waitcnt lgkmcnt(10)
    v_mfma_f32_16x16x32_bf16 v[152:155], v[52:55], v[32:35], v[152:155]
    ds_read_b128 v[96:99], v29 offset:9216
    v_mfma_f32_16x16x32_bf16 v[156:159], v[52:55], v[36:39], v[156:159]
    ds_read_b128 v[100:103], v29 offset:11264
    s_waitcnt lgkmcnt(11)
    v_mfma_f32_16x16x32_bf16 v[160:163], v[56:59], v[32:35], v[160:163]
    ds_read_b128 v[104:107], v29 offset:13312
    v_mfma_f32_16x16x32_bf16 v[164:167], v[56:59], v[36:39], v[164:167]
    s_waitcnt lgkmcnt(11)
    v_mfma_f32_16x16x32_bf16 v[168:171], v[60:63], v[32:35], v[168:171]
    v_mfma_f32_16x16x32_bf16 v[172:175], v[60:63], v[36:39], v[172:175]
    ds_read_b32 v15, v13
    s_waitcnt lgkmcnt(11)
    v_mfma_f32_16x16x32_bf16 v[176:179], v[64:67], v[32:35], v[176:179]
    v_mfma_f32_16x16x32_bf16 v[180:183], v[64:67], v[36:39], v[180:183]
    s_waitcnt lgkmcnt(0)
    v_readfirstlane_b32 s48, v15
    s_cmp_ge_u32 s48, 64
    s_cbranch_scc1 K2G_spuna14
K2G_spina14:
    ds_read_b32 v15, v13
    s_add_u32 s55, s55, 1
    s_waitcnt lgkmcnt(0)
    v_readfirstlane_b32 s48, v15
    s_bitcmp1_b32 s55, 22
    s_cbranch_scc1 K2G_spuna14
    s_cmp_ge_u32 s48, 64
    s_cbranch_scc1 K2G_spuna14
    s_sleep 1
    s_branch K2G_spina14
K2G_spuna14:
    v_mfma_f32_16x16x32_bf16 v[128:131], v[80:83], v[72:75], v[128:131]
    ds_read_b128 v[32:35], v18 offset:30720
    v_mfma_f32_16x16x32_bf16 v[132:135], v[80:83], v[76:79], v[132:135]
    ds_read_b128 v[40:43], v29 offset:30720
    v_mfma_f32_16x16x32_bf16 v[136:139], v[84:87], v[72:75], v[136:139]
    ds_read_b128 v[36:39], v18 offset:32768
    v_mfma_f32_16x16x32_bf16 v[140:143], v[84:87], v[76:79], v[140:143]
    ds_read_b128 v[44:47], v29 offset:32768
    v_mfma_f32_16x16x32_bf16 v[144:147], v[88:91], v[72:75], v[144:147]
    ds_read_b128 v[48:51], v29 offset:34816
    v_mfma_f32_16x16x32_bf16 v[148:151], v[88:91], v[76:79], v[148:151]
    ds_read_b128 v[52:55], v29 offset:36864
    v_mfma_f32_16x16x32_bf16 v[152:155], v[92:95], v[72:75], v[152:155]
    ds_read_b128 v[56:59], v29 offset:38912
    v_mfma_f32_16x16x32_bf16 v[156:159], v[92:95], v[76:79], v[156:159]
    ds_read_b128 v[60:63], v29 offset:40960
    v_mfma_f32_16x16x32_bf16 v[160:163], v[96:99], v[72:75], v[160:163]
    ds_read_b128 v[64:67], v29 offset:43008
    v_mfma_f32_16x16x32_bf16 v[164:167], v[96:99], v[76:79], v[164:167]
    v_mfma_f32_16x16x32_bf16 v[168:171], v[100:103], v[72:75], v[168:171]
    v_mfma_f32_16x16x32_bf16 v[172:175], v[100:103], v[76:79], v[172:175]
    v_mfma_f32_16x16x32_bf16 v[176:179], v[104:107], v[72:75], v[176:179]
    v_mfma_f32_16x16x32_bf16 v[180:183], v[104:107], v[76:79], v[180:183]
    s_waitcnt lgkmcnt(8)
    s_waitcnt lgkmcnt(7)
    v_mfma_f32_16x16x32_bf16 v[128:131], v[40:43], v[32:35], v[128:131]
    ds_read_b128 v[72:75], v19 offset:30720
    s_waitcnt lgkmcnt(7)
    v_mfma_f32_16x16x32_bf16 v[132:135], v[40:43], v[36:39], v[132:135]
    ds_read_b128 v[80:83], v29 offset:31744
    s_waitcnt lgkmcnt(7)
    v_mfma_f32_16x16x32_bf16 v[136:139], v[44:47], v[32:35], v[136:139]
    ds_read_b128 v[76:79], v19 offset:32768
    v_mfma_f32_16x16x32_bf16 v[140:143], v[44:47], v[36:39], v[140:143]
    ds_read_b128 v[84:87], v29 offset:33792
    s_waitcnt lgkmcnt(8)
    v_mfma_f32_16x16x32_bf16 v[144:147], v[48:51], v[32:35], v[144:147]
    ds_read_b128 v[88:91], v29 offset:35840
    v_mfma_f32_16x16x32_bf16 v[148:151], v[48:51], v[36:39], v[148:151]
    ds_read_b128 v[92:95], v29 offset:37888
    s_waitcnt lgkmcnt(9)
    v_mfma_f32_16x16x32_bf16 v[152:155], v[52:55], v[32:35], v[152:155]
    ds_read_b128 v[96:99], v29 offset:39936
    v_mfma_f32_16x16x32_bf16 v[156:159], v[52:55], v[36:39], v[156:159]
    ds_read_b128 v[100:103], v29 offset:41984
    s_waitcnt lgkmcnt(10)
    v_mfma_f32_16x16x32_bf16 v[160:163], v[56:59], v[32:35], v[160:163]
    ds_read_b128 v[104:107], v29 offset:44032
    v_mfma_f32_16x16x32_bf16 v[164:167], v[56:59], v[36:39], v[164:167]
    s_waitcnt lgkmcnt(10)
    v_mfma_f32_16x16x32_bf16 v[168:171], v[60:63], v[32:35], v[168:171]
    v_mfma_f32_16x16x32_bf16 v[172:175], v[60:63], v[36:39], v[172:175]
    s_waitcnt lgkmcnt(9)
    v_mfma_f32_16x16x32_bf16 v[176:179], v[64:67], v[32:35], v[176:179]
    v_mfma_f32_16x16x32_bf16 v[180:183], v[64:67], v[36:39], v[180:183]
    s_waitcnt lgkmcnt(8)
    s_waitcnt lgkmcnt(7)
    v_mfma_f32_16x16x32_bf16 v[128:131], v[80:83], v[72:75], v[128:131]
    s_waitcnt lgkmcnt(6)
    v_mfma_f32_16x16x32_bf16 v[132:135], v[80:83], v[76:79], v[132:135]
    s_waitcnt lgkmcnt(5)
    v_mfma_f32_16x16x32_bf16 v[136:139], v[84:87], v[72:75], v[136:139]
    v_mfma_f32_16x16x32_bf16 v[140:143], v[84:87], v[76:79], v[140:143]
    s_waitcnt lgkmcnt(4)
    v_mfma_f32_16x16x32_bf16 v[144:147], v[88:91], v[72:75], v[144:147]
    v_mfma_f32_16x16x32_bf16 v[148:151], v[88:91], v[76:79], v[148:151]
    s_waitcnt lgkmcnt(3)
    v_mfma_f32_16x16x32_bf16 v[152:155], v[92:95], v[72:75], v[152:155]
    v_mfma_f32_16x16x32_bf16 v[156:159], v[92:95], v[76:79], v[156:159]
    s_waitcnt lgkmcnt(2)
    v_mfma_f32_16x16x32_bf16 v[160:163], v[96:99], v[72:75], v[160:163]
    v_mfma_f32_16x16x32_bf16 v[164:167], v[96:99], v[76:79], v[164:167]
    s_waitcnt lgkmcnt(1)
    v_mfma_f32_16x16x32_bf16 v[168:171], v[100:103], v[72:75], v[168:171]
    v_mfma_f32_16x16x32_bf16 v[172:175], v[100:103], v[76:79], v[172:175]
    s_waitcnt lgkmcnt(0)
    v_mfma_f32_16x16x32_bf16 v[176:179], v[104:107], v[72:75], v[176:179]
    v_mfma_f32_16x16x32_bf16 v[180:183], v[104:107], v[76:79], v[180:183]
    s_nop 15
    s_and_b32 s47, s2, 3
    s_lshl_b32 s48, s54, 11
    v_add_u32 v9, s48, v12
    v_cvt_pk_bf16_f32 v32, v128, v129
    v_cvt_pk_bf16_f32 v33, v130, v131
    v_cvt_pk_bf16_f32 v34, v132, v133
    v_cvt_pk_bf16_f32 v35, v134, v135
    v_cvt_pk_bf16_f32 v36, v136, v137
    v_cvt_pk_bf16_f32 v37, v138, v139
    v_cvt_pk_bf16_f32 v38, v140, v141
    v_cvt_pk_bf16_f32 v39, v142, v143
    s_cmp_eq_u32 s47, 0
    s_cbranch_scc1 K2G_own0
    buffer_store_dwordx4 v[32:35], v12, s[28:31], s46 offen sc0 sc1
    s_add_u32 s46, s46, 4096
    buffer_store_dwordx4 v[36:39], v12, s[28:31], s46 offen sc0 sc1
    s_add_u32 s46, s46, 4096
    s_branch K2G_nxt0
K2G_own0:
    ds_write_b128 v9, v[32:35] offset:0
    ds_write_b128 v9, v[36:39] offset:1024
    s_add_u32 s46, s46, 8192
K2G_nxt0:
    v_cvt_pk_bf16_f32 v40, v144, v145
    v_cvt_pk_bf16_f32 v41, v146, v147
    v_cvt_pk_bf16_f32 v42, v148, v149
    v_cvt_pk_bf16_f32 v43, v150, v151
    v_cvt_pk_bf16_f32 v44, v152, v153
    v_cvt_pk_bf16_f32 v45, v154, v155
    v_cvt_pk_bf16_f32 v46, v156, v157
    v_cvt_pk_bf16_f32 v47, v158, v159
    s_cmp_eq_u32 s47, 1
    s_cbranch_scc1 K2G_own1
    buffer_store_dwordx4 v[40:43], v12, s[28:31], s46 offen sc0 sc1
    s_add_u32 s46, s46, 4096
    buffer_store_dwordx4 v[44:47], v12, s[28:31], s46 offen sc0 sc1
    s_add_u32 s46, s46, 4096
    s_branch K2G_nxt1
K2G_own1:
    ds_write_b128 v9, v[40:43] offset:0
    ds_write_b128 v9, v[44:47] offset:1024
    s_add_u32 s46, s46, 8192
K2G_nxt1:
    v_cvt_pk_bf16_f32 v48, v160, v161
    v_cvt_pk_bf16_f32 v49, v162, v163
    v_cvt_pk_bf16_f32 v50, v164, v165
    v_cvt_pk_bf16_f32 v51, v166, v167
    v_cvt_pk_bf16_f32 v52, v168, v169
    v_cvt_pk_bf16_f32 v53, v170, v171
    v_cvt_pk_bf16_f32 v54, v172, v173
    v_cvt_pk_bf16_f32 v55, v174, v175
    s_cmp_eq_u32 s47, 2
    s_cbranch_scc1 K2G_own2
    buffer_store_dwordx4 v[48:51], v12, s[28:31], s46 offen sc0 sc1
    s_add_u32 s46, s46, 4096
    buffer_store_dwordx4 v[52:55], v12, s[28:31], s46 offen sc0 sc1
    s_add_u32 s46, s46, 4096
    s_branch K2G_nxt2
K2G_own2:
    ds_write_b128 v9, v[48:51] offset:0
    ds_write_b128 v9, v[52:55] offset:1024
    s_add_u32 s46, s46, 8192
K2G_nxt2:
    v_cvt_pk_bf16_f32 v56, v176, v177
    v_cvt_pk_bf16_f32 v57, v178, v179
    v_cvt_pk_bf16_f32 v58, v180, v181
    v_cvt_pk_bf16_f32 v59, v182, v183
    s_cmp_eq_u32 s47, 3
    s_cbranch_scc1 K2G_own3
    buffer_store_dwordx4 v[56:59], v12, s[28:31], s46 offen sc0 sc1
    s_add_u32 s46, s46, 4096
    s_branch K2G_nxt3
K2G_own3:
    ds_write_b128 v9, v[56:59] offset:0
    s_add_u32 s46, s46, 8192
K2G_nxt3:
    s_lshl_b32 s70, s35, 2
    s_add_u32 s70, s70, s36
    s_lshl_b32 s70, s70, 2
    s_add_u32 s70, s70, s54
    s_lshl_b32 s70, s70, 8
    s_and_b32 s71, s2, 3
    s_lshl_b32 s71, s71, 2
    s_add_u32 s70, s70, s71
    s_add_u32 s70, s70, 14745600
    v_mov_b32 v2, 0
    v_mov_b32 v13, 155688
    v_add_u32 v15, 122880, v12
    v_and_b32 v6, 31, v1
    s_lshl_b32 s72, s50, 5
    v_add_u32 v6, s72, v6
    s_mov_b32 s72, 1792
    v_mul_lo_u32 v6, v6, s72
    v_lshrrev_b32 v7, 5, v1
    v_lshlrev_b32 v7, 4, v7
    v_add_u32 v6, v6, v7
    s_lshl_b32 s72, s57, 6
    v_add_u32 v6, s72, v6
    s_lshl_b32 s47, s54, 2
    s_add_u32 s47, s47, 155712
    v_mov_b32 v9, s47
    s_mov_b64 exec, 1
    s_waitcnt vmcnt(0)
    buffer_store_dword v14, v2, s[28:31], s70 offen sc0 sc1
    ds_write_b32 v9, v14
    s_mov_b64 exec, -1
    s_cmp_lt_u32 s57, 14
    s_cbranch_scc1 K2G_proj
K2G_noproj:
    s_mov_b64 exec, 1
    ds_add_u32 v13, v14 offset:8
    s_waitcnt lgkmcnt(0)
    s_endpgm
K2G_proj:
    buffer_load_dwordx4 v[60:63], v12, s[28:31], s56 offen offset:2048
    buffer_load_dwordx4 v[64:67], v12, s[28:31], s56 offen offset:3072
    s_add_u32 s56, s56, 4096
    buffer_load_dwordx4 v[68:71], v12, s[28:31], s56 offen offset:0
    buffer_load_dwordx4 v[72:75], v12, s[28:31], s56 offen offset:1024
    buffer_load_dwordx4 v[76:79], v12, s[28:31], s56 offen offset:2048
    buffer_load_dwordx4 v[80:83], v12, s[28:31], s56 offen offset:3072
    s_add_u32 s56, s56, 4096
    buffer_load_dwordx4 v[84:87], v12, s[28:31], s56 offen offset:0
    buffer_load_dwordx4 v[88:91], v12, s[28:31], s56 offen offset:1024
    buffer_load_dwordx4 v[92:95], v12, s[28:31], s56 offen offset:2048
    buffer_load_dwordx4 v[96:99], v12, s[28:31], s56 offen offset:3072
    s_add_u32 s56, s56, 4096
K2_sping:
    ds_read_b32 v8, v13
    s_add_u32 s55, s55, 1
    s_waitcnt lgkmcnt(0)
    v_readfirstlane_b32 s47, v8
    s_cmp_ge_u32 s47, 0x10000
    s_cbranch_scc1 K2G_noproj
    s_bitcmp1_b32 s55, 23
    s_cbranch_scc1 K2_done
    s_and_b32 s47, s47, 0xff
    s_cmp_ge_u32 s47, 4
    s_cbranch_scc1 K2_spung
    s_sleep 1
    s_branch K2_sping
K2_spung:
    ds_read_b128 v[128:131], v15 offset:0
    ds_read_b128 v[132:135], v15 offset:1024
    ds_read_b128 v[136:139], v15 offset:2048
    ds_read_b128 v[140:143], v15 offset:3072
    ds_read_b128 v[144:147], v15 offset:4096
    ds_read_b128 v[148:151], v15 offset:5120
    ds_read_b128 v[152:155], v15 offset:6144
    s_waitcnt lgkmcnt(6)
    v_mfma_f32_32x32x16_bf16 v[160:175], v[184:187], v[128:131], 0
    ds_read_b128 v[156:159], v15 offset:7168
    s_waitcnt lgkmcnt(6)
    v_mfma_f32_32x32x16_bf16 v[160:175], v[188:191], v[132:135], v[160:175]
    ds_read_b128 v[128:131], v15 offset:8192
    s_waitcnt lgkmcnt(6)
    v_mfma_f32_32x32x16_bf16 v[160:175], v[192:195], v[136:139], v[160:175]
    ds_read_b128 v[132:135], v15 offset:9216
    s_waitcnt lgkmcnt(6)
    v_mfma_f32_32x32x16_bf16 v[160:175], v[196:199], v[140:143], v[160:175]
    ds_read_b128 v[136:139], v15 offset:10240
    s_waitcnt lgkmcnt(6)
    v_mfma_f32_32x32x16_bf16 v[160:175], v[200:203], v[144:147], v[160:175]
    ds_read_b128 v[140:143], v15 offset:11264
    s_waitcnt lgkmcnt(6)
    v_mfma_f32_32x32x16_bf16 v[160:175], v[204:207], v[148:151], v[160:175]
    ds_read_b128 v[144:147], v15 offset:12288
    s_waitcnt lgkmcnt(6)
    v_mfma_f32_32x32x16_bf16 v[160:175], v[208:211], v[152:155], v[160:175]
    ds_read_b128 v[148:151], v15 offset:13312
    s_waitcnt lgkmcnt(6)
    v_mfma_f32_32x32x16_bf16 v[160:175], v[212:215], v[156:159], v[160:175]
    ds_read_b128 v[152:155], v15 offset:14336
    s_waitcnt lgkmcnt(6)
    v_mfma_f32_32x32x16_bf16 v[160:175], v[216:219], v[128:131], v[160:175]
    ds_read_b128 v[156:159], v15 offset:15360
    s_waitcnt lgkmcnt(6)
    v_mfma_f32_32x32x16_bf16 v[160:175], v[220:223], v[132:135], v[160:175]
    ds_read_b128 v[128:131], v15 offset:16384
    s_waitcnt lgkmcnt(6)
    v_mfma_f32_32x32x16_bf16 v[160:175], v[224:227], v[136:139], v[160:175]
    ds_read_b128 v[132:135], v15 offset:17408
    s_waitcnt lgkmcnt(6)
    v_mfma_f32_32x32x16_bf16 v[160:175], v[228:231], v[140:143], v[160:175]
    ds_read_b128 v[136:139], v15 offset:18432
    s_waitcnt lgkmcnt(6)
    v_mfma_f32_32x32x16_bf16 v[160:175], v[232:235], v[144:147], v[160:175]
    ds_read_b128 v[140:143], v15 offset:19456
    s_waitcnt lgkmcnt(6)
    v_mfma_f32_32x32x16_bf16 v[160:175], v[236:239], v[148:151], v[160:175]
    ds_read_b128 v[144:147], v15 offset:20480
    s_waitcnt lgkmcnt(6)
    v_mfma_f32_32x32x16_bf16 v[160:175], v[240:243], v[152:155], v[160:175]
    ds_read_b128 v[148:151], v15 offset:21504
    s_waitcnt lgkmcnt(6)
    v_mfma_f32_32x32x16_bf16 v[160:175], v[244:247], v[156:159], v[160:175]
    ds_read_b128 v[152:155], v15 offset:22528
    s_waitcnt lgkmcnt(6)
    v_mfma_f32_32x32x16_bf16 v[160:175], v[112:115], v[128:131], v[160:175]
    ds_read_b128 v[156:159], v15 offset:23552
    s_waitcnt lgkmcnt(6)
    v_mfma_f32_32x32x16_bf16 v[160:175], v[116:119], v[132:135], v[160:175]
    ds_read_b128 v[128:131], v15 offset:24576
    s_waitcnt lgkmcnt(6)
    v_mfma_f32_32x32x16_bf16 v[160:175], v[120:123], v[136:139], v[160:175]
    ds_read_b128 v[132:135], v15 offset:25600
    s_waitcnt lgkmcnt(6)
    v_mfma_f32_32x32x16_bf16 v[160:175], v[124:127], v[140:143], v[160:175]
    ds_read_b128 v[136:139], v15 offset:26624
    s_waitcnt lgkmcnt(6)
    v_mfma_f32_32x32x16_bf16 v[160:175], v[20:23], v[144:147], v[160:175]
    ds_read_b128 v[140:143], v15 offset:27648
    s_waitcnt lgkmcnt(6)
    v_mfma_f32_32x32x16_bf16 v[160:175], v[24:27], v[148:151], v[160:175]
    ds_read_b128 v[144:147], v15 offset:28672
    s_waitcnt lgkmcnt(6)
    s_waitcnt vmcnt(0)
    v_mfma_f32_32x32x16_bf16 v[160:175], v[60:63], v[152:155], v[160:175]
    ds_read_b128 v[148:151], v15 offset:29696
    s_waitcnt lgkmcnt(6)
    v_mfma_f32_32x32x16_bf16 v[160:175], v[64:67], v[156:159], v[160:175]
    ds_read_b128 v[152:155], v15 offset:30720
    s_waitcnt lgkmcnt(6)
    v_mfma_f32_32x32x16_bf16 v[160:175], v[68:71], v[128:131], v[160:175]
    ds_read_b128 v[156:159], v15 offset:31744
    s_waitcnt lgkmcnt(6)
    v_mfma_f32_32x32x16_bf16 v[160:175], v[72:75], v[132:135], v[160:175]
    s_waitcnt lgkmcnt(5)
    v_mfma_f32_32x32x16_bf16 v[160:175], v[76:79], v[136:139], v[160:175]
    s_waitcnt lgkmcnt(4)
    v_mfma_f32_32x32x16_bf16 v[160:175], v[80:83], v[140:143], v[160:175]
    s_waitcnt lgkmcnt(3)
    v_mfma_f32_32x32x16_bf16 v[160:175], v[84:87], v[144:147], v[160:175]
    s_waitcnt lgkmcnt(2)
    v_mfma_f32_32x32x16_bf16 v[160:175], v[88:91], v[148:151], v[160:175]
    s_waitcnt lgkmcnt(1)
    v_mfma_f32_32x32x16_bf16 v[160:175], v[92:95], v[152:155], v[160:175]
    s_waitcnt lgkmcnt(0)
    v_mfma_f32_32x32x16_bf16 v[160:175], v[96:99], v[156:159], v[160:175]
    s_mov_b64 exec, 1
    ds_add_u32 v13, v14 offset:8
    s_mov_b64 exec, -1
    s_nop 13
    v_cvt_pk_bf16_f32 v176, v160, v161
    v_cvt_pk_bf16_f32 v177, v162, v163
    v_cvt_pk_bf16_f32 v178, v164, v165
    v_cvt_pk_bf16_f32 v179, v166, v167
    v_cvt_pk_bf16_f32 v180, v168, v169
    v_cvt_pk_bf16_f32 v181, v170, v171
    v_cvt_pk_bf16_f32 v182, v172, v173
    v_cvt_pk_bf16_f32 v183, v174, v175
    s_nop 1
    v_permlane32_swap_b32 v176, v178
    v_permlane32_swap_b32 v177, v179
    v_permlane32_swap_b32 v180, v182
    v_permlane32_swap_b32 v181, v183
    s_nop 1
    buffer_store_dwordx4 v[176:179], v6, s[24:27], 0 offen offset:0 sc0 sc1
    buffer_store_dwordx4 v[180:183], v6, s[24:27], 0 offen offset:32 sc0 sc1
    s_waitcnt lgkmcnt(0)
    s_endpgm
K2_done:
    s_endpgm
.section .rodata,"a"
.p2align 6
.amdhsa_kernel k1_proj_kernel
  .amdhsa_next_free_vgpr 256
  .amdhsa_next_free_sgpr 102
  .amdhsa_accum_offset 256
  .amdhsa_group_segment_fixed_size 0
  .amdhsa_kernarg_size 88
  .amdhsa_user_sgpr_count 2
  .amdhsa_user_sgpr_kernarg_segment_ptr 1
  .amdhsa_system_sgpr_workgroup_id_x 1
.end_amdhsa_kernel
```
